```python
import torch

def _softmax(x, axis=-1):
    return torch.softmax(x, dim=axis)
def _gelu(x):
    return torch.nn.functional.gelu(x, approximate="tanh")
def _silu(x):
    return torch.nn.functional.silu(x)
def _sigmoid(x):
    return torch.sigmoid(x)
def _layernorm(x, axis=-1, eps=1e-5):
    m = x.mean(dim=axis, keepdim=True)
    v = x.var(dim=axis, keepdim=True, unbiased=False)
    return (x - m) / torch.sqrt(v + eps)
def _scatter_add(tgt, idx, src, axis=0):
    return tgt.clone().index_add_(axis, idx, src)
def _segment_sum(src, seg, n):
    out = torch.zeros((n,) + src.shape[1:], dtype=src.dtype)
    return out.index_add_(0, seg, src)
def _pad(x, pw):
    flat = tuple(v for pair in reversed(pw) for v in pair)
    return torch.nn.functional.pad(x, flat)

kernel_name = 'gated_mix__ssm_conv_s4__dense_activation_mish__prompt'

def setup_inputs():

    _w = (lambda a: (lambda t: t.to(torch.bfloat16) if t.is_floating_point() else t)(torch.as_tensor(a)))
    def _A_setup():
        B, L, D, N = 1, 2048, 576, 128
        A_re = -(lambda _x: torch.exp(torch.as_tensor(_x)))((lambda *s: torch.randn(*s, dtype=torch.bfloat16) * 6.4)(D, N))
        A_im = torch.pi * (lambda *s: torch.randn(*s, dtype=torch.bfloat16) * 0.05)(D, N)
        B_re = (lambda *s: torch.randn(*s, dtype=torch.bfloat16) * 0.1)(D, N)
        B_im = (lambda *s: torch.randn(*s, dtype=torch.bfloat16) * 0.1)(D, N)
        C_re = (lambda *s: torch.randn(*s, dtype=torch.bfloat16) * 0.1)(D, N)
        C_im = (lambda *s: torch.randn(*s, dtype=torch.bfloat16) * 0.1)(D, N)
        log_dt = (lambda *s: torch.randn(*s, dtype=torch.bfloat16) * 0.05)(D) * 0.5 - 4.0
        Dskip = (lambda *s: torch.randn(*s, dtype=torch.bfloat16) * 0.05)(D)
        return {
            "u": _w((lambda *s: torch.randn(*s, dtype=torch.bfloat16) * 0.05)(B, L, D)),
            "A_re": _w(A_re),
            "A_im": _w(A_im),
            "B_re": _w(B_re),
            "B_im": _w(B_im),
            "C_re": _w(C_re),
            "C_im": _w(C_im),
            "log_dt": _w(log_dt),
            "Dskip": _w(Dskip),
        }
    _A_in = _A_setup()

    def _B_setup():
        B, S, D, F = 1, 2048, 576, 4608
        return {
            "x": _w((lambda *s: torch.randn(*s, dtype=torch.bfloat16) * 0.05)(B, S, D)),
            "w1": _w((lambda *s: torch.randn(*s, dtype=torch.bfloat16) * 6.4)(D, F) * (D ** -0.5)),
            "b1": _w((lambda *s: torch.randn(*s, dtype=torch.bfloat16) * 0.05)(F)),
            "w2": _w((lambda *s: torch.randn(*s, dtype=torch.bfloat16) * 0.05)(F, D) * (F ** -0.5)),
        }
    _B_in = _B_setup()

    return {
        "A_u": _A_in["u"],
        "A_A_re": _A_in["A_re"],
        "A_A_im": _A_in["A_im"],
        "A_B_re": _A_in["B_re"],
        "A_B_im": _A_in["B_im"],
        "A_C_re": _A_in["C_re"],
        "A_C_im": _A_in["C_im"],
        "A_log_dt": _A_in["log_dt"],
        "A_Dskip": _A_in["Dskip"],
        "B_x": _B_in["x"],
        "B_w1": _B_in["w1"],
        "B_b1": _B_in["b1"],
        "B_w2": _B_in["w2"],
        "gate_w": _w((lambda *s: torch.randn(*s, dtype=torch.bfloat16) * 0.05)(576) * 16.0),
    }

def reference(A_u, A_A_re, A_A_im, A_B_re, A_B_im, A_C_re, A_C_im, A_log_dt, A_Dskip, B_x, B_w1, B_b1, B_w2, gate_w):
    def _A_ref(u, A_re, A_im, B_re, B_im, C_re, C_im, log_dt, Dskip):
        Bsz, L, D = u.shape
        dt = torch.exp(log_dt)[:, None]
        A = A_re + 1j * A_im
        Bc = B_re + 1j * B_im
        Cc = C_re + 1j * C_im
        logdA = dt * A
        dB = dt * Bc
        l = (lambda x, dt: x.to(dt))(torch.arange(L), A_re.dtype)
        P = torch.exp(logdA[:, :, None] * l[None, None, :])
        K = torch.einsum("dn,dnl,dn->dl", Cc, P, dB).real
        L2 = 2 * L
        Kp = _pad(K, ((0, 0), (0, L)))
        up = (lambda x, *d: x.permute(*d))(u, 0, 2, 1)
        up = _pad(up, ((0, 0), (0, 0), (0, L)))
        Kf = (lambda x, axes=(-2,-1): torch.fft.rfft2(x.float(), dim=axes))(Kp[:, None, :], axes=(-2, -1))
        Uf = (lambda x, axes=(-2,-1): torch.fft.rfft2(x.float(), dim=axes))(up[:, :, None, :], axes=(-2, -1))
        Yf = Uf * Kf[None, :, :, :]
        y = (lambda x, s, axes=(-2,-1): torch.fft.irfft2(x, s=s, dim=axes).to(torch.bfloat16))(Yf, (1, L2), axes=(-2, -1))[:, :, 0, :L]
        y = (lambda x, *d: x.permute(*d))(y, 0, 2, 1) + u * Dskip[None, None, :]
        return y

    def _B_ref(x, w1, b1, w2):
        h = torch.einsum("bsd,df->bsf", x, w1) + b1
        sp = torch.log1p(torch.exp(-torch.abs(h))) + torch.where(h > 0, h, torch.zeros_like(h))
        act = h * torch.tanh(sp)
        return torch.einsum("bsf,fd->bsd", act, w2)

    x = A_u
    g = _sigmoid((x * gate_w).sum(-1, keepdims=True))
    a = _A_ref(x, A_A_re, A_A_im, A_B_re, A_B_im, A_C_re, A_C_im, A_log_dt, A_Dskip)
    b = _B_ref(x, B_w1, B_b1, B_w2)
    return g * a + (1 - g) * b
```

```asm
; @launch grid=(256,1,1) block=(512,1,1) lds=163840
.amdgcn_target "amdgcn-amd-amdhsa--gfx950"
.text
.globl gated_mix__ssm_conv_s4__dense_activation_mish__prompt_kernel
.p2align 8
.type gated_mix__ssm_conv_s4__dense_activation_mish__prompt_kernel,@function
gated_mix__ssm_conv_s4__dense_activation_mish__prompt_kernel:
    s_cmp_ge_u32 s2, 256
    s_cbranch_scc1 L_exit
    s_load_dwordx2 s[40:41], s[0:1], 0
    s_load_dwordx8 s[60:67], s[0:1], 80
    s_load_dwordx4 s[68:71], s[0:1], 112
    s_load_dwordx2 s[72:73], s[0:1], 128
    v_lshrrev_b32 v1, 6, v0
    s_and_b32 s39, s2, 7
    v_readfirstlane_b32 s28, v1
    s_lshr_b32 s74, s2, 3
    s_cmp_lt_u32 s74, 24
    s_cbranch_scc1 L_mlp_pick
L_conv:
    s_load_dwordx2 s[42:43], s[0:1], 8
    s_load_dwordx4 s[44:47], s[0:1], 16
    s_load_dwordx8 s[48:55], s[0:1], 32
    s_load_dwordx2 s[56:57], s[0:1], 64
    s_getpc_b64 s[76:77]
L_conv_pc:
    v_lshlrev_b32 v2, 7, v0
    v_add_u32 v2, L_conv_rest-L_conv_pc, v2
    v_min_u32 v2, L_conv_end-L_conv_pc-4, v2
    global_load_dword v2, v2, s[76:77]
    s_lshl_b32 s29, s39, 3
    s_add_u32 s29, s29, s74
    s_sub_u32 s29, s29, 24
    s_sub_u32 s3, s74, 24
    s_lshl_b32 s3, s3, 9
    v_add_u32 v28, s3, v0
    v_and_b32 v0, 63, v0
    v_and_b32 v3, 15, v0
    v_lshrrev_b32 v4, 4, v0
    v_lshlrev_b32 v24, 2, v0
    s_mul_i32 s31, s29, 9
    s_add_u32 s3, s31, s28
    s_lshl_b32 s30, s3, 12
    s_add_u32 s30, s30, 28311552
    v_mov_b32 v125, s3
    s_add_u32 s3, s31, 8
    v_mov_b32 v127, s3
    v_lshl_add_u32 v124, v125, 8, v24
    v_lshlrev_b32 v125, 1, v125
    v_lshl_add_u32 v126, v127, 8, v24
    v_lshlrev_b32 v127, 1, v127
    s_waitcnt lgkmcnt(0)
    global_load_dword v36, v124, s[42:43]
    global_load_dword v37, v124, s[44:45]
    global_load_dword v38, v124, s[46:47]
    global_load_dword v39, v124, s[48:49]
    global_load_dword v40, v124, s[50:51]
    global_load_dword v41, v124, s[52:53]
    global_load_ushort v42, v125, s[54:55]
    global_load_ushort v43, v125, s[56:57]
    global_load_dword v44, v126, s[42:43]
    global_load_dword v45, v126, s[44:45]
    global_load_dword v46, v126, s[46:47]
    global_load_dword v47, v126, s[48:49]
    global_load_dword v48, v126, s[50:51]
    global_load_dword v49, v126, s[52:53]
    global_load_ushort v50, v127, s[54:55]
    global_load_ushort v51, v127, s[56:57]
    s_branch L_conv_rest
L_exit:
    s_endpgm
L_mlp_pick:
L_mlp:
    s_getpc_b64 s[76:77]
L_mlp_pc:
    v_and_b32 v21, 511, v0
    v_lshlrev_b32 v21, 7, v21
    v_min_u32 v21, L_mlp_end-L_mlp_pc-4, v21
    global_load_dword v21, v21, s[76:77]
    s_and_b32 s31, s39, 1
    s_lshl_b32 s31, s31, 3
    s_and_b32 s3, s74, 7
    s_add_u32 s31, s31, s3
    s_lshr_b32 s32, s39, 1
    s_mul_i32 s32, s32, 3
    s_lshr_b32 s38, s74, 3
    s_add_u32 s32, s32, s38
    s_and_b32 s29, s28, 3
    s_lshr_b32 s30, s28, 2
    s_lshl_b32 s33, s28, 11
    s_mul_i32 s38, s38, 3
    s_add_u32 s38, s38, s3
    s_cmp_ge_u32 s38, 9
    s_cselect_b32 s3, 9, 0
    s_sub_u32 s38, s38, s3
    s_add_u32 s37, s38, s30
    s_cmp_ge_u32 s37, 9
    s_cselect_b32 s37, 0, s37
    s_mul_i32 s42, s37, 589824
    s_lshl_b32 s38, s38, 7
    v_lshlrev_b32 v22, 1, v0
    v_and_b32 v0, 63, v0
    v_lshrrev_b32 v88, 3, v0
    s_lshl_b32 s3, s28, 4
    v_add_u32 v88, s3, v88
    v_and_b32 v89, 7, v0
    v_lshrrev_b32 v90, 4, v0
    v_xor_b32 v91, v89, v90
    v_mul_u32_u24 v92, 1152, v88
    v_lshl_add_u32 v38, v91, 4, v92
    v_xor_b32 v91, 4, v91
    v_lshl_add_u32 v39, v91, 4, v92
    v_add_u32 v39, 8192, v39
    v_and_b32 v90, 1, v90
    v_lshlrev_b32 v90, 2, v90
    v_xor_b32 v91, v89, v90
    v_and_b32 v88, 63, v88
    v_mul_u32_u24 v92, 9216, v88
    v_lshl_add_u32 v1, v91, 4, v92
    v_add_u32 v2, 72704, v1
    s_mul_i32 s35, s31, 147456
    s_mul_i32 s3, s32, 768
    s_waitcnt lgkmcnt(0)
    s_add_u32 s4, s40, s35
    s_addc_u32 s5, s41, 0
    s_mov_b32 s6, 147456
    s_mov_b32 s7, 0x20000
    s_add_u32 m0, s33, 0
    s_mov_b32 s35, s38
    buffer_load_dwordx4 v38, s[4:7], s35 offen lds
    buffer_load_dwordx4 v39, s[4:7], s35 offen offset:1024 lds
    s_add_u32 s38, s38, 128
    s_cmp_eq_u32 s38, 1152
    s_cselect_b32 s38, 0, s38
    s_add_u32 m0, s33, 16384
    s_mov_b32 s35, s38
    buffer_load_dwordx4 v38, s[4:7], s35 offen lds
    buffer_load_dwordx4 v39, s[4:7], s35 offen offset:1024 lds
    s_add_u32 s38, s38, 128
    s_cmp_eq_u32 s38, 1152
    s_cselect_b32 s38, 0, s38
    s_add_u32 s8, s60, s3
    s_addc_u32 s9, s61, 0
    s_mov_b32 s10, 0
    s_mov_b32 s11, 0x20000
    s_sub_u32 s10, 5308416, s3
    s_add_u32 m0, s33, 32768
    s_add_u32 s35, s42, 0
    buffer_load_dwordx4 v1, s[8:11], s35 offen lds
    buffer_load_dwordx4 v2, s[8:11], s35 offen offset:1024 lds
    s_add_u32 s24, s62, s3
    s_addc_u32 s25, s63, 0
    s_mov_b32 s26, 768
    s_mov_b32 s27, 0x20000
    buffer_load_ushort v22, v22, s[24:27], 0 offen
    s_add_u32 s43, s42, 589824
    s_cmp_eq_u32 s43, 5308416
    s_cselect_b32 s43, 0, s43
    s_add_u32 s44, s43, 589824
    s_cmp_eq_u32 s44, 5308416
    s_cselect_b32 s44, 0, s44
    s_add_u32 s45, s44, 589824
    s_cmp_eq_u32 s45, 5308416
    s_cselect_b32 s45, 0, s45
    s_add_u32 s46, s45, 589824
    s_cmp_eq_u32 s46, 5308416
    s_cselect_b32 s46, 0, s46
    s_add_u32 s47, s46, 589824
    s_cmp_eq_u32 s47, 5308416
    s_cselect_b32 s47, 0, s47
    s_add_u32 s48, s47, 589824
    s_cmp_eq_u32 s48, 5308416
    s_cselect_b32 s48, 0, s48
    s_add_u32 s49, s48, 589824
    s_cmp_eq_u32 s49, 5308416
    s_cselect_b32 s49, 0, s49
    s_add_u32 s50, s49, 589824
    s_cmp_eq_u32 s50, 5308416
    s_cselect_b32 s50, 0, s50
    s_lshl_b32 s57, s30, 7
    s_add_u32 s58, s57, 256
    s_add_u32 s59, s57, 512
    s_mul_i32 s34, s30, 73728
    s_mov_b32 s36, 0x3fb8aa3b
    v_lshrrev_b32 v91, 4, v0
    v_lshlrev_b32 v91, 1, v91
    v_xor_b32 v91, v89, v91
    v_mul_u32_u24 v92, 1152, v88
    v_lshl_add_u32 v3, v91, 4, v92
    v_add_u32 v4, 8192, v3
    v_lshlrev_b32 v20, 4, v0
    v_bfe_u32 v88, v0, 2, 2
    v_lshrrev_b32 v89, 5, v0
    v_lshrrev_b32 v90, 1, v88
    v_xor_b32 v90, s30, v90
    v_lshlrev_b32 v90, 6, v90
    v_bfe_u32 v91, v0, 4, 1
    v_lshl_add_u32 v90, v91, 5, v90
    v_and_b32 v91, 3, v0
    v_lshl_add_u32 v90, v91, 3, v90
    v_lshl_add_u32 v90, v88, 7, v90
    v_lshl_add_u32 v5, v89, 10, v90
    v_lshl_add_u32 v8, v89, 9, v90
    v_add_u32 v11, s33, v20
    s_lshl_b32 s3, s29, 11
    v_add_u32 v14, s3, v20
    v_bfe_u32 v90, v0, 4, 1
    v_lshrrev_b32 v91, 1, v88
    v_lshl_add_u32 v91, v90, 1, v91
    s_lshl_b32 s3, s30, 1
    v_xor_b32 v91, s3, v91
    v_lshl_add_u32 v108, v90, 2, v88
    v_lshl_add_u32 v108, v89, 4, v108
    v_lshlrev_b32 v108, 7, v108
    v_and_b32 v8, 3, v0
    v_lshl_add_u32 v108, v8, 3, v108
    v_lshl_add_u32 v8, v91, 5, v108
    v_xor_b32 v108, 32, v8
    v_and_b32 v91, 15, v0
    v_lshlrev_b32 v91, 4, v91
    v_lshrrev_b32 v14, 4, v0
    v_lshl_add_u32 v14, v14, 9, v91
    s_lshl_b32 s3, s29, 11
    v_add_u32 v14, s3, v14
    v_add_u32 v6, 0x10000, v5
    v_add_u32 v7, 0x20000, v5
    v_add_u32 v9, 0x10000, v8
    v_add_u32 v10, 0x20000, v8
    v_add_u32 v12, 0x10000, v11
    v_add_u32 v13, 0x20000, v11
    v_add_u32 v15, 0x10000, v14
    v_add_u32 v16, 0x20000, v14
    v_add_u32 v109, 0x10000, v108
    v_add_u32 v110, 0x20000, v108
    s_lshl_b32 s3, s30, 7
    s_add_u32 s3, s3, 147456
    v_lshl_add_u32 v17, v89, 4, s3
    v_and_b32 v88, 31, v0
    s_lshl_b32 s3, s29, 5
    v_add_u32 v88, s3, v88
    v_bfe_u32 v90, v88, 1, 3
    v_xor_b32 v89, v90, v89
    v_lshlrev_b32 v88, 7, v88
    v_xor_b32 v91, 0, v89
    v_lshl_add_u32 v24, v91, 4, v88
    v_add_u32 v25, 0x10000, v24
    v_add_u32 v26, 0x20000, v24
    v_xor_b32 v91, 2, v89
    v_lshl_add_u32 v27, v91, 4, v88
    v_add_u32 v28, 0x10000, v27
    v_add_u32 v29, 0x20000, v27
    v_xor_b32 v91, 4, v89
    v_lshl_add_u32 v30, v91, 4, v88
    v_add_u32 v31, 0x10000, v30
    v_add_u32 v32, 0x20000, v30
    v_xor_b32 v91, 6, v89
    v_lshl_add_u32 v33, v91, 4, v88
    v_add_u32 v34, 0x10000, v33
    v_add_u32 v35, 0x20000, v33
    s_lshl_b32 s3, s28, 8
    s_add_u32 s3, s3, 147456
    v_lshl_add_u32 v92, v0, 2, s3
    s_add_u32 m0, s33, 49152
    s_mov_b32 s35, s38
    buffer_load_dwordx4 v38, s[4:7], s35 offen lds
    buffer_load_dwordx4 v39, s[4:7], s35 offen offset:1024 lds
    s_add_u32 s38, s38, 128
    s_cmp_eq_u32 s38, 1152
    s_cselect_b32 s38, 0, s38
    s_add_u32 m0, s33, 65536
    s_mov_b32 s35, s38
    buffer_load_dwordx4 v38, s[4:7], s35 offen lds
    buffer_load_dwordx4 v39, s[4:7], s35 offen offset:1024 lds
    s_add_u32 s38, s38, 128
    s_cmp_eq_u32 s38, 1152
    s_cselect_b32 s38, 0, s38
    s_add_u32 m0, s33, 81920
    s_add_u32 s35, s44, 0
    buffer_load_dwordx4 v1, s[8:11], s35 offen lds
    buffer_load_dwordx4 v2, s[8:11], s35 offen offset:1024 lds
    s_mul_i32 s3, s32, 442368
    s_add_u32 s12, s64, s3
    s_addc_u32 s13, s65, 0
    s_mov_b32 s14, 442368
    s_mov_b32 s15, 0x20000
    s_mov_b32 s16, s72
    s_mov_b32 s17, s73
    s_mov_b32 s18, 33374208
    s_mov_b32 s19, 0x20000
    s_mov_b32 s20, s68
    s_mov_b32 s21, s69
    s_mov_b32 s22, 2359296
    s_mov_b32 s23, 0x20000
    s_mov_b32 s24, s70
    s_mov_b32 s25, s71
    s_mov_b32 s26, 256
    s_mov_b32 s27, 0x20000
    s_waitcnt vmcnt(6)
    v_lshlrev_b32 v22, 16, v22
    ds_write_b32 v92, v22
    s_waitcnt lgkmcnt(0)
    s_barrier
    ds_read_b128 v[56:59], v17 offset:0
    ds_read_b128 v[60:63], v17 offset:32
    ds_read_b128 v[64:67], v17 offset:64
    ds_read_b128 v[68:71], v17 offset:96
    ds_read_b64_tr_b16 v[40:41], v5 offset:32768
    ds_read_b64_tr_b16 v[42:43], v5 offset:33280
    ds_read_b128 v[112:115], v24 offset:0
    ds_read_b64_tr_b16 v[44:45], v5 offset:34816
    ds_read_b64_tr_b16 v[46:47], v5 offset:35328
    ds_read_b128 v[116:119], v27 offset:0
    ds_read_b64_tr_b16 v[48:49], v5 offset:36864
    ds_read_b64_tr_b16 v[50:51], v5 offset:37376
    ds_read_b128 v[120:123], v30 offset:0
    s_waitcnt lgkmcnt(6)
    v_mfma_f32_32x32x16_bf16 v[56:71], v[40:43], v[112:115], v[56:71]
    ds_read_b64_tr_b16 v[52:53], v5 offset:38912
    ds_read_b64_tr_b16 v[54:55], v5 offset:39424
    ds_read_b128 v[124:127], v33 offset:0
    s_add_u32 m0, s33, 98304
    s_mov_b32 s35, s38
    buffer_load_dwordx4 v38, s[4:7], s35 offen lds
    s_waitcnt lgkmcnt(6)
    v_mfma_f32_32x32x16_bf16 v[56:71], v[44:47], v[116:119], v[56:71]
    ds_read_b64_tr_b16 v[40:41], v5 offset:40960
    ds_read_b64_tr_b16 v[42:43], v5 offset:41472
    ds_read_b128 v[128:131], v24 offset:16384
    buffer_load_dwordx4 v39, s[4:7], s35 offen offset:1024 lds
    s_add_u32 s38, s38, 128
    s_cmp_eq_u32 s38, 1152
    s_cselect_b32 s38, 0, s38
    s_waitcnt lgkmcnt(6)
    v_mfma_f32_32x32x16_bf16 v[56:71], v[48:51], v[120:123], v[56:71]
    ds_read_b64_tr_b16 v[44:45], v5 offset:43008
    ds_read_b64_tr_b16 v[46:47], v5 offset:43520
    ds_read_b128 v[132:135], v27 offset:16384
    s_add_u32 m0, s33, 114688
    s_mov_b32 s35, s38
    buffer_load_dwordx4 v38, s[4:7], s35 offen lds
    s_waitcnt lgkmcnt(6)
    v_mfma_f32_32x32x16_bf16 v[56:71], v[52:55], v[124:127], v[56:71]
    ds_read_b64_tr_b16 v[48:49], v5 offset:45056
    ds_read_b64_tr_b16 v[50:51], v5 offset:45568
    ds_read_b128 v[136:139], v30 offset:16384
    buffer_load_dwordx4 v39, s[4:7], s35 offen offset:1024 lds
    s_add_u32 s38, s38, 128
    s_cmp_eq_u32 s38, 1152
    s_cselect_b32 s38, 0, s38
    s_waitcnt lgkmcnt(6)
    v_mfma_f32_32x32x16_bf16 v[56:71], v[40:43], v[128:131], v[56:71]
    ds_read_b64_tr_b16 v[52:53], v5 offset:47104
    ds_read_b64_tr_b16 v[54:55], v5 offset:47616
    ds_read_b128 v[140:143], v33 offset:16384
    s_add_u32 m0, s33, 131072
    s_add_u32 s35, s46, 0
    buffer_load_dwordx4 v1, s[8:11], s35 offen lds
    s_waitcnt lgkmcnt(6)
    v_mfma_f32_32x32x16_bf16 v[56:71], v[44:47], v[132:135], v[56:71]
    buffer_load_dwordx4 v2, s[8:11], s35 offen offset:1024 lds
    s_waitcnt lgkmcnt(3)
    v_mfma_f32_32x32x16_bf16 v[56:71], v[48:51], v[136:139], v[56:71]
    s_mul_i32 s37, s31, 12
    s_add_u32 s37, s37, s32
    s_lshl_b32 s37, s37, 3
    s_add_u32 s37, s37, s28
    s_mul_i32 s37, s37, 18432
    s_waitcnt lgkmcnt(0)
    v_mfma_f32_32x32x16_bf16 v[56:71], v[52:55], v[140:143], v[56:71]
    s_lshl_b32 s98, s31, 3
    s_add_u32 s98, s98, s28
    s_lshl_b32 s98, s98, 7
    s_add_u32 s98, s98, 30687232
    v_lshrrev_b32 v93, 5, v0
    s_waitcnt vmcnt(6)
    s_barrier
    ds_read_b64_tr_b16 v[40:41], v6 offset:16384
    ds_read_b64_tr_b16 v[42:43], v6 offset:16896
    ds_read_b128 v[144:147], v24 offset:49152
    ds_read_b64_tr_b16 v[44:45], v6 offset:18432
    ds_read_b64_tr_b16 v[46:47], v6 offset:18944
    ds_read_b128 v[148:151], v27 offset:49152
    ds_read_b64_tr_b16 v[48:49], v6 offset:20480
    ds_read_b64_tr_b16 v[50:51], v6 offset:20992
    ds_read_b128 v[152:155], v30 offset:49152
    s_waitcnt lgkmcnt(6)
    v_mfma_f32_32x32x16_bf16 v[56:71], v[40:43], v[144:147], v[56:71]
    v_and_b32 v94, 31, v0
    v_mul_u32_u24 v23, 147456, v93
    v_lshl_add_u32 v23, v94, 4, v23
    v_mul_u32_u24 v106, 786432, v93
    v_bfe_u32 v95, v0, 2, 3
    ds_read_b64_tr_b16 v[52:53], v6 offset:22528
    ds_read_b64_tr_b16 v[54:55], v6 offset:23040
    ds_read_b128 v[156:159], v33 offset:49152
    s_add_u32 m0, s33, 0
    s_mov_b32 s35, s38
    buffer_load_dwordx4 v38, s[4:7], s35 offen lds
    s_waitcnt lgkmcnt(6)
    v_mfma_f32_32x32x16_bf16 v[56:71], v[44:47], v[148:151], v[56:71]
    v_lshl_add_u32 v106, v95, 12, v106
    v_and_b32 v95, 3, v0
    v_lshl_add_u32 v106, v95, 4, v106
    v_lshlrev_b32 v19, 3, v95
    v_bfe_u32 v95, v0, 2, 2
    ds_read_b64_tr_b16 v[40:41], v6 offset:24576
    ds_read_b64_tr_b16 v[42:43], v6 offset:25088
    ds_read_b128 v[160:163], v25 offset:0
    buffer_load_dwordx4 v39, s[4:7], s35 offen offset:1024 lds
    s_add_u32 s38, s38, 128
    s_cmp_eq_u32 s38, 1152
    s_cselect_b32 s38, 0, s38
    s_waitcnt lgkmcnt(6)
    v_mfma_f32_32x32x16_bf16 v[56:71], v[48:51], v[152:155], v[56:71]
    v_lshl_add_u32 v19, v95, 6, v19
    v_bfe_u32 v95, v0, 4, 1
    v_lshl_add_u32 v19, v95, 5, v19
    v_lshl_add_u32 v19, v93, 8, v19
    v_add_u32 v19, s33, v19
    ds_read_b64_tr_b16 v[44:45], v6 offset:26624
    ds_read_b64_tr_b16 v[46:47], v6 offset:27136
    ds_read_b128 v[164:167], v28 offset:0
    s_add_u32 m0, s33, 16384
    s_mov_b32 s35, s38
    buffer_load_dwordx4 v38, s[4:7], s35 offen lds
    s_waitcnt lgkmcnt(6)
    v_mfma_f32_32x32x16_bf16 v[56:71], v[52:55], v[156:159], v[56:71]
    v_mul_u32_u24 v107, 144, v94
    v_lshl_add_u32 v107, v93, 3, v107
    s_lshl_b32 s96, s28, 4
    v_add_u32 v107, s96, v107
    v_lshlrev_b32 v104, 3, v94
    ds_read_b64_tr_b16 v[48:49], v6 offset:28672
    ds_read_b64_tr_b16 v[50:51], v6 offset:29184
    ds_read_b128 v[168:171], v31 offset:0
    buffer_load_dwordx4 v39, s[4:7], s35 offen offset:1024 lds
    s_add_u32 s38, s38, 128
    s_cmp_eq_u32 s38, 1152
    s_cselect_b32 s38, 0, s38
    s_waitcnt lgkmcnt(6)
    v_mfma_f32_32x32x16_bf16 v[56:71], v[40:43], v[160:163], v[56:71]
    s_and_b32 s76, s32, 3
    s_and_b32 s96, s28, 4
    s_add_u32 s96, s96, s76
    s_lshl_b32 s99, s31, 3
    s_add_u32 s99, s99, s96
    ds_read_b64_tr_b16 v[52:53], v6 offset:30720
    ds_read_b64_tr_b16 v[54:55], v6 offset:31232
    ds_read_b128 v[172:175], v34 offset:0
    s_add_u32 m0, s33, 32768
    s_add_u32 s35, s48, 0
    buffer_load_dwordx4 v1, s[8:11], s35 offen lds
    s_waitcnt lgkmcnt(6)
    v_mfma_f32_32x32x16_bf16 v[56:71], v[44:47], v[164:167], v[56:71]
    s_lshl_b32 s99, s99, 7
    s_add_u32 s99, s99, 30687232
    s_mul_i32 s39, s31, 96
    s_add_u32 s39, s39, s96
    s_mul_i32 s39, s39, 9
    buffer_load_dwordx4 v2, s[8:11], s35 offen offset:1024 lds
    s_waitcnt lgkmcnt(3)
    v_mfma_f32_32x32x16_bf16 v[56:71], v[48:51], v[168:171], v[56:71]
    s_lshr_b32 s74, s32, 2
    s_add_u32 s39, s39, s74
    s_lshl_b32 s39, s39, 2
    s_add_u32 s39, s39, s29
    s_lshl_b32 s39, s39, 9
    s_waitcnt lgkmcnt(0)
    v_mfma_f32_32x32x16_bf16 v[56:71], v[52:55], v[172:175], v[56:71]
    s_lshl_b32 s74, s74, 6
    s_lshl_b32 s96, s28, 3
    s_add_u32 s74, s74, s96
    s_lshl_b32 s96, s31, 2
    s_add_u32 s76, s76, s96
    s_waitcnt vmcnt(6)
    s_barrier
    ds_read_b64_tr_b16 v[40:41], v7 offset:0
    ds_read_b64_tr_b16 v[42:43], v7 offset:512
    ds_read_b128 v[176:179], v25 offset:32768
    ds_read_b64_tr_b16 v[44:45], v7 offset:2048
    ds_read_b64_tr_b16 v[46:47], v7 offset:2560
    ds_read_b128 v[180:183], v28 offset:32768
    ds_read_b64_tr_b16 v[48:49], v7 offset:4096
    ds_read_b64_tr_b16 v[50:51], v7 offset:4608
    ds_read_b128 v[184:187], v31 offset:32768
    s_waitcnt lgkmcnt(6)
    v_mfma_f32_32x32x16_bf16 v[56:71], v[40:43], v[176:179], v[56:71]
    s_lshl_b32 s76, s76, 5
    ds_read_b64_tr_b16 v[52:53], v7 offset:6144
    ds_read_b64_tr_b16 v[54:55], v7 offset:6656
    ds_read_b128 v[188:191], v34 offset:32768
    s_add_u32 m0, s33, 49152
    s_mov_b32 s35, s38
    buffer_load_dwordx4 v38, s[4:7], s35 offen lds
    s_waitcnt lgkmcnt(6)
    v_mfma_f32_32x32x16_bf16 v[56:71], v[44:47], v[180:183], v[56:71]
    ds_read_b64_tr_b16 v[40:41], v7 offset:8192
    ds_read_b64_tr_b16 v[42:43], v7 offset:8704
    ds_read_b128 v[192:195], v25 offset:49152
    buffer_load_dwordx4 v39, s[4:7], s35 offen offset:1024 lds
    s_waitcnt lgkmcnt(6)
    v_mfma_f32_32x32x16_bf16 v[56:71], v[48:51], v[184:187], v[56:71]
    ds_read_b64_tr_b16 v[44:45], v7 offset:10240
    ds_read_b64_tr_b16 v[46:47], v7 offset:10752
    ds_read_b128 v[196:199], v28 offset:49152
    s_add_u32 m0, s33, 65536
    s_add_u32 s35, s50, s57
    buffer_load_dwordx4 v1, s[8:11], s35 offen lds
    s_waitcnt lgkmcnt(6)
    v_mfma_f32_32x32x16_bf16 v[56:71], v[52:55], v[188:191], v[56:71]
    ds_read_b64_tr_b16 v[48:49], v7 offset:12288
    ds_read_b64_tr_b16 v[50:51], v7 offset:12800
    ds_read_b128 v[200:203], v31 offset:49152
    buffer_load_dwordx4 v2, s[8:11], s35 offen offset:1024 lds
    s_waitcnt lgkmcnt(6)
    v_mfma_f32_32x32x16_bf16 v[56:71], v[40:43], v[192:195], v[56:71]
    ds_read_b64_tr_b16 v[52:53], v7 offset:14336
    ds_read_b64_tr_b16 v[54:55], v7 offset:14848
    ds_read_b128 v[204:207], v34 offset:49152
    s_add_u32 m0, s33, 81920
    s_add_u32 s35, s43, 128
    buffer_load_dwordx4 v1, s[8:11], s35 offen lds
    s_waitcnt lgkmcnt(6)
    v_mfma_f32_32x32x16_bf16 v[56:71], v[44:47], v[196:199], v[56:71]
    buffer_load_dwordx4 v2, s[8:11], s35 offen offset:1024 lds
    s_waitcnt lgkmcnt(3)
    v_mfma_f32_32x32x16_bf16 v[56:71], v[48:51], v[200:203], v[56:71]
    s_waitcnt lgkmcnt(0)
    v_mfma_f32_32x32x16_bf16 v[56:71], v[52:55], v[204:207], v[56:71]
    s_waitcnt vmcnt(6)
    s_barrier
    ds_read_b64_tr_b16 v[40:41], v5 offset:32768
    ds_read_b64_tr_b16 v[42:43], v5 offset:33280
    ds_read_b128 v[208:211], v24 offset:0
    ds_read_b64_tr_b16 v[44:45], v5 offset:34816
    ds_read_b64_tr_b16 v[46:47], v5 offset:35328
    ds_read_b128 v[212:215], v27 offset:0
    ds_read_b64_tr_b16 v[48:49], v5 offset:36864
    ds_read_b64_tr_b16 v[50:51], v5 offset:37376
    ds_read_b128 v[216:219], v30 offset:0
    s_waitcnt lgkmcnt(6)
    v_mfma_f32_32x32x16_bf16 v[56:71], v[40:43], v[208:211], v[56:71]
    ds_read_b64_tr_b16 v[52:53], v5 offset:38912
    ds_read_b64_tr_b16 v[54:55], v5 offset:39424
    ds_read_b128 v[220:223], v33 offset:0
    s_add_u32 m0, s33, 98304
    s_add_u32 s35, s45, 128
    buffer_load_dwordx4 v1, s[8:11], s35 offen lds
    s_waitcnt lgkmcnt(6)
    v_mfma_f32_32x32x16_bf16 v[56:71], v[44:47], v[212:215], v[56:71]
    ds_read_b64_tr_b16 v[40:41], v5 offset:40960
    ds_read_b64_tr_b16 v[42:43], v5 offset:41472
    ds_read_b128 v[224:227], v24 offset:16384
    buffer_load_dwordx4 v2, s[8:11], s35 offen offset:1024 lds
    s_waitcnt lgkmcnt(6)
    v_mfma_f32_32x32x16_bf16 v[56:71], v[48:51], v[216:219], v[56:71]
    ds_read_b64_tr_b16 v[44:45], v5 offset:43008
    ds_read_b64_tr_b16 v[46:47], v5 offset:43520
    ds_read_b128 v[228:231], v27 offset:16384
    s_add_u32 m0, s33, 114688
    s_add_u32 s35, s47, 128
    buffer_load_dwordx4 v1, s[8:11], s35 offen lds
    s_waitcnt lgkmcnt(6)
    v_mfma_f32_32x32x16_bf16 v[56:71], v[52:55], v[220:223], v[56:71]
    ds_read_b64_tr_b16 v[48:49], v5 offset:45056
    ds_read_b64_tr_b16 v[50:51], v5 offset:45568
    ds_read_b128 v[232:235], v30 offset:16384
    buffer_load_dwordx4 v2, s[8:11], s35 offen offset:1024 lds
    s_waitcnt lgkmcnt(6)
    v_mfma_f32_32x32x16_bf16 v[56:71], v[40:43], v[224:227], v[56:71]
    ds_read_b64_tr_b16 v[52:53], v5 offset:47104
    ds_read_b64_tr_b16 v[54:55], v5 offset:47616
    ds_read_b128 v[236:239], v33 offset:16384
    ds_read_b128 v[72:75], v17 offset:256
    s_add_u32 m0, s33, 131072
    s_add_u32 s35, s49, 128
    buffer_load_dwordx4 v1, s[8:11], s35 offen lds
    s_waitcnt lgkmcnt(7)
    v_mfma_f32_32x32x16_bf16 v[56:71], v[44:47], v[228:231], v[56:71]
    ds_read_b128 v[76:79], v17 offset:288
    buffer_load_dwordx4 v2, s[8:11], s35 offen offset:1024 lds
    s_waitcnt lgkmcnt(5)
    v_mfma_f32_32x32x16_bf16 v[56:71], v[48:51], v[232:235], v[56:71]
    ds_read_b128 v[80:83], v17 offset:320
    s_waitcnt lgkmcnt(3)
    v_mfma_f32_32x32x16_bf16 v[56:71], v[52:55], v[236:239], v[56:71]
    ds_read_b128 v[84:87], v17 offset:352
    s_waitcnt vmcnt(6)
    s_barrier
    ds_read_b64_tr_b16 v[40:41], v6 offset:0
    ds_read_b64_tr_b16 v[42:43], v6 offset:512
    ds_read_b128 v[240:243], v24 offset:49152
    ds_read_b64_tr_b16 v[44:45], v6 offset:2048
    ds_read_b64_tr_b16 v[46:47], v6 offset:2560
    ds_read_b128 v[244:247], v27 offset:49152
    ds_read_b64_tr_b16 v[48:49], v6 offset:4096
    ds_read_b64_tr_b16 v[50:51], v6 offset:4608
    ds_read_b128 v[248:251], v30 offset:49152
    s_waitcnt lgkmcnt(6)
    v_mfma_f32_32x32x16_bf16 v[56:71], v[40:43], v[240:243], v[56:71]
    ds_read_b64_tr_b16 v[52:53], v6 offset:6144
    ds_read_b64_tr_b16 v[54:55], v6 offset:6656
    ds_read_b128 v[252:255], v33 offset:49152
    s_add_u32 m0, s33, 0
    s_add_u32 s35, s42, 256
    buffer_load_dwordx4 v1, s[8:11], s35 offen lds
    s_waitcnt lgkmcnt(6)
    v_mfma_f32_32x32x16_bf16 v[56:71], v[44:47], v[244:247], v[56:71]
    ds_read_b64_tr_b16 v[40:41], v6 offset:8192
    ds_read_b64_tr_b16 v[42:43], v6 offset:8704
    s_waitcnt lgkmcnt(5)
    v_mfma_f32_32x32x16_bf16 v[56:71], v[48:51], v[248:251], v[56:71]
    ds_read_b64_tr_b16 v[44:45], v6 offset:10240
    ds_read_b64_tr_b16 v[46:47], v6 offset:10752
    buffer_load_dwordx4 v2, s[8:11], s35 offen offset:1024 lds
    s_waitcnt lgkmcnt(4)
    v_mfma_f32_32x32x16_bf16 v[56:71], v[52:55], v[252:255], v[56:71]
    ds_read_b64_tr_b16 v[48:49], v6 offset:12288
    ds_read_b64_tr_b16 v[50:51], v6 offset:12800
    s_add_u32 m0, s33, 32768
    s_add_u32 s35, s44, 256
    s_waitcnt lgkmcnt(4)
    v_mfma_f32_32x32x16_bf16 v[72:87], v[40:43], v[112:115], v[72:87]
    ds_read_b64_tr_b16 v[52:53], v6 offset:14336
    ds_read_b64_tr_b16 v[54:55], v6 offset:14848
    buffer_load_dwordx4 v1, s[8:11], s35 offen lds
    s_waitcnt lgkmcnt(4)
    v_mfma_f32_32x32x16_bf16 v[72:87], v[44:47], v[116:119], v[72:87]
    ds_read_b64_tr_b16 v[40:41], v6 offset:16384
    ds_read_b64_tr_b16 v[42:43], v6 offset:16896
    s_waitcnt lgkmcnt(4)
    v_mfma_f32_32x32x16_bf16 v[72:87], v[48:51], v[120:123], v[72:87]
    s_waitcnt lgkmcnt(2)
    s_waitcnt vmcnt(7)
    s_barrier
    v_mfma_f32_32x32x16_bf16 v[72:87], v[52:55], v[124:127], v[72:87]
    v_mul_f32 v24, s36, v56
    ds_read_b64_tr_b16 v[44:45], v6 offset:18432
    ds_read_b64_tr_b16 v[46:47], v6 offset:18944
    ds_read_b64_tr_b16 v[48:49], v6 offset:20480
    ds_read_b64_tr_b16 v[50:51], v6 offset:20992
    buffer_load_dwordx4 v2, s[8:11], s35 offen offset:1024 lds
    s_waitcnt lgkmcnt(4)
    v_mfma_f32_32x32x16_bf16 v[72:87], v[40:43], v[128:131], v[72:87]
    v_exp_f32 v24, v24
    ds_read_b64_tr_b16 v[52:53], v6 offset:22528
    ds_read_b64_tr_b16 v[54:55], v6 offset:23040
    s_add_u32 m0, s33, 49152
    s_add_u32 s35, s46, 256
    buffer_load_dwordx4 v1, s[8:11], s35 offen lds
    s_waitcnt lgkmcnt(4)
    v_mfma_f32_32x32x16_bf16 v[72:87], v[44:47], v[132:135], v[72:87]
    v_mul_f32 v25, s36, v57
    v_fma_f32 v28, v24, -0.5, -1.0
    ds_read_b64_tr_b16 v[40:41], v6 offset:24576
    ds_read_b64_tr_b16 v[42:43], v6 offset:25088
    s_waitcnt lgkmcnt(4)
    v_mfma_f32_32x32x16_bf16 v[72:87], v[48:51], v[136:139], v[72:87]
    v_exp_f32 v25, v25
    v_fma_f32 v28, v24, v28, -1.0
    ds_read_b64_tr_b16 v[44:45], v6 offset:26624
    ds_read_b64_tr_b16 v[46:47], v6 offset:27136
    buffer_load_dwordx4 v2, s[8:11], s35 offen offset:1024 lds
    s_waitcnt lgkmcnt(4)
    v_mfma_f32_32x32x16_bf16 v[72:87], v[52:55], v[140:143], v[72:87]
    v_rcp_f32 v28, v28
    v_mul_f32 v26, s36, v58
    v_fma_f32 v29, v25, -0.5, -1.0
    ds_read_b64_tr_b16 v[48:49], v6 offset:28672
    ds_read_b64_tr_b16 v[50:51], v6 offset:29184
    s_add_u32 m0, s33, 65536
    s_add_u32 s35, s48, 256
    s_waitcnt lgkmcnt(4)
    v_mfma_f32_32x32x16_bf16 v[72:87], v[40:43], v[144:147], v[72:87]
    v_exp_f32 v26, v26
    v_fma_f32 v29, v25, v29, -1.0
    v_fmac_f32 v56, v56, v28
    ds_read_b64_tr_b16 v[52:53], v6 offset:30720
    ds_read_b64_tr_b16 v[54:55], v6 offset:31232
    s_waitcnt lgkmcnt(4)
    v_mfma_f32_32x32x16_bf16 v[72:87], v[44:47], v[148:151], v[72:87]
    v_rcp_f32 v29, v29
    v_mul_f32 v27, s36, v59
    v_fma_f32 v30, v26, -0.5, -1.0
    ds_read_b64_tr_b16 v[40:41], v6 offset:32768
    ds_read_b64_tr_b16 v[42:43], v6 offset:33280
    s_waitcnt lgkmcnt(4)
    v_mfma_f32_32x32x16_bf16 v[72:87], v[48:51], v[152:155], v[72:87]
    v_exp_f32 v27, v27
    v_fma_f32 v30, v26, v30, -1.0
    v_fmac_f32 v57, v57, v29
    ds_read_b64_tr_b16 v[44:45], v6 offset:34816
    ds_read_b64_tr_b16 v[46:47], v6 offset:35328
    buffer_load_dwordx4 v1, s[8:11], s35 offen lds
    s_waitcnt lgkmcnt(4)
    v_mfma_f32_32x32x16_bf16 v[72:87], v[52:55], v[156:159], v[72:87]
    v_rcp_f32 v30, v30
    v_mul_f32 v24, s36, v60
    v_fma_f32 v31, v27, -0.5, -1.0
    v_cvt_pk_bf16_f32 v32, v56, v57
    ds_read_b64_tr_b16 v[48:49], v6 offset:36864
    ds_read_b64_tr_b16 v[50:51], v6 offset:37376
    s_waitcnt lgkmcnt(4)
    v_mfma_f32_32x32x16_bf16 v[72:87], v[40:43], v[160:163], v[72:87]
    v_exp_f32 v24, v24
    v_fma_f32 v31, v27, v31, -1.0
    v_fmac_f32 v58, v58, v30
    ds_read_b64_tr_b16 v[52:53], v6 offset:38912
    ds_read_b64_tr_b16 v[54:55], v6 offset:39424
    s_waitcnt lgkmcnt(4)
    v_mfma_f32_32x32x16_bf16 v[72:87], v[44:47], v[164:167], v[72:87]
    v_rcp_f32 v31, v31
    v_mul_f32 v25, s36, v61
    v_fma_f32 v28, v24, -0.5, -1.0
    ds_read_b64_tr_b16 v[40:41], v6 offset:40960
    ds_read_b64_tr_b16 v[42:43], v6 offset:41472
    s_waitcnt lgkmcnt(4)
    v_mfma_f32_32x32x16_bf16 v[72:87], v[48:51], v[168:171], v[72:87]
    s_waitcnt lgkmcnt(2)
    s_waitcnt vmcnt(7)
    s_barrier
    v_mfma_f32_32x32x16_bf16 v[72:87], v[52:55], v[172:175], v[72:87]
    v_exp_f32 v25, v25
    v_fma_f32 v28, v24, v28, -1.0
    v_fmac_f32 v59, v59, v31
    ds_read_b64_tr_b16 v[44:45], v6 offset:43008
    ds_read_b64_tr_b16 v[46:47], v6 offset:43520
    ds_read_b64_tr_b16 v[48:49], v6 offset:45056
    ds_read_b64_tr_b16 v[50:51], v6 offset:45568
    buffer_load_dwordx4 v2, s[8:11], s35 offen offset:1024 lds
    s_waitcnt lgkmcnt(4)
    v_mfma_f32_32x32x16_bf16 v[72:87], v[40:43], v[176:179], v[72:87]
    v_rcp_f32 v28, v28
    v_mul_f32 v26, s36, v62
    v_fma_f32 v29, v25, -0.5, -1.0
    v_cvt_pk_bf16_f32 v33, v58, v59
    ds_read_b64_tr_b16 v[52:53], v6 offset:47104
    ds_read_b64_tr_b16 v[54:55], v6 offset:47616
    s_waitcnt lgkmcnt(4)
    v_mfma_f32_32x32x16_bf16 v[72:87], v[44:47], v[180:183], v[72:87]
    v_exp_f32 v26, v26
    v_fma_f32 v29, v25, v29, -1.0
    v_fmac_f32 v60, v60, v28
    ds_read_b64_tr_b16 v[40:41], v6 offset:49152
    ds_read_b64_tr_b16 v[42:43], v6 offset:49664
    s_add_u32 m0, s33, 81920
    s_add_u32 s35, s50, s58
    s_waitcnt lgkmcnt(4)
    v_mfma_f32_32x32x16_bf16 v[72:87], v[48:51], v[184:187], v[72:87]
    v_rcp_f32 v29, v29
    v_mul_f32 v27, s36, v63
    v_fma_f32 v30, v26, -0.5, -1.0
    ds_read_b64_tr_b16 v[44:45], v6 offset:51200
    ds_read_b64_tr_b16 v[46:47], v6 offset:51712
    buffer_load_dwordx4 v1, s[8:11], s35 offen lds
    s_waitcnt lgkmcnt(4)
    v_mfma_f32_32x32x16_bf16 v[72:87], v[52:55], v[188:191], v[72:87]
    v_exp_f32 v27, v27
    v_fma_f32 v30, v26, v30, -1.0
    v_fmac_f32 v61, v61, v29
    ds_read_b64_tr_b16 v[48:49], v6 offset:53248
    ds_read_b64_tr_b16 v[50:51], v6 offset:53760
    s_waitcnt lgkmcnt(4)
    v_mfma_f32_32x32x16_bf16 v[72:87], v[40:43], v[192:195], v[72:87]
    v_rcp_f32 v30, v30
    v_mul_f32 v24, s36, v64
    v_fma_f32 v31, v27, -0.5, -1.0
    v_cvt_pk_bf16_f32 v34, v60, v61
    ds_read_b64_tr_b16 v[52:53], v6 offset:55296
    ds_read_b64_tr_b16 v[54:55], v6 offset:55808
    s_waitcnt lgkmcnt(4)
    v_mfma_f32_32x32x16_bf16 v[72:87], v[44:47], v[196:199], v[72:87]
    v_exp_f32 v24, v24
    v_fma_f32 v31, v27, v31, -1.0
    v_fmac_f32 v62, v62, v30
    ds_read_b64_tr_b16 v[40:41], v6 offset:57344
    ds_read_b64_tr_b16 v[42:43], v6 offset:57856
    s_waitcnt lgkmcnt(4)
    v_mfma_f32_32x32x16_bf16 v[72:87], v[48:51], v[200:203], v[72:87]
    v_rcp_f32 v31, v31
    v_mul_f32 v25, s36, v65
    v_fma_f32 v28, v24, -0.5, -1.0
    ds_read_b64_tr_b16 v[44:45], v6 offset:59392
    ds_read_b64_tr_b16 v[46:47], v6 offset:59904
    buffer_load_dwordx4 v2, s[8:11], s35 offen offset:1024 lds
    s_waitcnt lgkmcnt(4)
    v_mfma_f32_32x32x16_bf16 v[72:87], v[52:55], v[204:207], v[72:87]
    v_exp_f32 v25, v25
    v_fma_f32 v28, v24, v28, -1.0
    v_fmac_f32 v63, v63, v31
    ds_read_b64_tr_b16 v[48:49], v6 offset:61440
    ds_read_b64_tr_b16 v[50:51], v6 offset:61952
    s_waitcnt lgkmcnt(4)
    v_mfma_f32_32x32x16_bf16 v[72:87], v[40:43], v[208:211], v[72:87]
    v_rcp_f32 v28, v28
    v_mul_f32 v26, s36, v66
    v_fma_f32 v29, v25, -0.5, -1.0
    v_cvt_pk_bf16_f32 v35, v62, v63
    ds_read_b64_tr_b16 v[52:53], v6 offset:63488
    ds_read_b64_tr_b16 v[54:55], v6 offset:64000
    ds_write_b128 v11, v[32:35] offset:16384
    s_waitcnt lgkmcnt(5)
    v_mfma_f32_32x32x16_bf16 v[72:87], v[44:47], v[212:215], v[72:87]
    v_exp_f32 v26, v26
    v_fma_f32 v29, v25, v29, -1.0
    v_fmac_f32 v64, v64, v28
    ds_read_b64_tr_b16 v[40:41], v7 offset:0
    ds_read_b64_tr_b16 v[42:43], v7 offset:512
    s_waitcnt lgkmcnt(5)
    v_mfma_f32_32x32x16_bf16 v[72:87], v[48:51], v[216:219], v[72:87]
    s_waitcnt lgkmcnt(3)
    s_waitcnt vmcnt(8)
    s_barrier
    v_mfma_f32_32x32x16_bf16 v[72:87], v[52:55], v[220:223], v[72:87]
    v_rcp_f32 v29, v29
    v_mul_f32 v27, s36, v67
    v_fma_f32 v30, v26, -0.5, -1.0
    ds_read_b64_tr_b16 v[44:45], v7 offset:2048
    ds_read_b64_tr_b16 v[46:47], v7 offset:2560
    ds_read_b64_tr_b16 v[48:49], v7 offset:4096
    ds_read_b64_tr_b16 v[50:51], v7 offset:4608
    s_add_u32 m0, s33, 114688
    s_add_u32 s35, s43, 384
    buffer_load_dwordx4 v1, s[8:11], s35 offen lds
    s_waitcnt lgkmcnt(4)
    v_mfma_f32_32x32x16_bf16 v[72:87], v[40:43], v[224:227], v[72:87]
    v_exp_f32 v27, v27
    v_fma_f32 v30, v26, v30, -1.0
    v_fmac_f32 v65, v65, v29
    ds_read_b64_tr_b16 v[52:53], v7 offset:6144
    ds_read_b64_tr_b16 v[54:55], v7 offset:6656
    ds_read_b128 v[88:91], v17 offset:512
    s_waitcnt lgkmcnt(5)
    v_mfma_f32_32x32x16_bf16 v[72:87], v[44:47], v[228:231], v[72:87]
    v_rcp_f32 v30, v30
    v_mul_f32 v24, s36, v68
    v_fma_f32 v31, v27, -0.5, -1.0
    v_cvt_pk_bf16_f32 v36, v64, v65
    ds_read_b64_tr_b16 v[40:41], v7 offset:8192
    ds_read_b64_tr_b16 v[42:43], v7 offset:8704
    ds_read_b128 v[92:95], v17 offset:544
    s_waitcnt lgkmcnt(6)
    v_mfma_f32_32x32x16_bf16 v[72:87], v[48:51], v[232:235], v[72:87]
    v_exp_f32 v24, v24
    v_fma_f32 v31, v27, v31, -1.0
    v_fmac_f32 v66, v66, v30
    ds_read_b64_tr_b16 v[44:45], v7 offset:10240
    ds_read_b64_tr_b16 v[46:47], v7 offset:10752
    ds_read_b128 v[96:99], v17 offset:576
    buffer_load_dwordx4 v2, s[8:11], s35 offen offset:1024 lds
    s_waitcnt lgkmcnt(7)
    v_mfma_f32_32x32x16_bf16 v[72:87], v[52:55], v[236:239], v[72:87]
    v_rcp_f32 v31, v31
    v_mul_f32 v25, s36, v69
    v_fma_f32 v28, v24, -0.5, -1.0
    ds_read_b64_tr_b16 v[48:49], v7 offset:12288
    ds_read_b64_tr_b16 v[50:51], v7 offset:12800
    ds_read_b128 v[100:103], v17 offset:608
    s_waitcnt lgkmcnt(7)
    v_mfma_f32_32x32x16_bf16 v[72:87], v[40:43], v[240:243], v[72:87]
    v_exp_f32 v25, v25
    v_fma_f32 v28, v24, v28, -1.0
    v_fmac_f32 v67, v67, v31
    ds_read_b64_tr_b16 v[52:53], v7 offset:14336
    ds_read_b64_tr_b16 v[54:55], v7 offset:14848
    s_waitcnt lgkmcnt(6)
    v_mfma_f32_32x32x16_bf16 v[72:87], v[44:47], v[244:247], v[72:87]
    v_rcp_f32 v28, v28
    v_mul_f32 v26, s36, v70
    v_fma_f32 v29, v25, -0.5, -1.0
    v_cvt_pk_bf16_f32 v37, v66, v67
    ds_read_b64_tr_b16 v[40:41], v5 offset:0
    ds_read_b64_tr_b16 v[42:43], v5 offset:512
    s_waitcnt lgkmcnt(5)
    v_mfma_f32_32x32x16_bf16 v[72:87], v[48:51], v[248:251], v[72:87]
    v_exp_f32 v26, v26
    v_fma_f32 v29, v25, v29, -1.0
    v_fmac_f32 v68, v68, v28
    ds_read_b64_tr_b16 v[44:45], v5 offset:2048
    ds_read_b64_tr_b16 v[46:47], v5 offset:2560
    s_waitcnt lgkmcnt(4)
    v_mfma_f32_32x32x16_bf16 v[72:87], v[52:55], v[252:255], v[72:87]
    v_rcp_f32 v29, v29
    v_mul_f32 v27, s36, v71
    v_fma_f32 v30, v26, -0.5, -1.0
    ds_read_b64_tr_b16 v[48:49], v5 offset:4096
    ds_read_b64_tr_b16 v[50:51], v5 offset:4608
    s_waitcnt lgkmcnt(4)
    v_mfma_f32_32x32x16_bf16 v[88:103], v[40:43], v[112:115], v[88:103]
    v_exp_f32 v27, v27
    v_fma_f32 v30, v26, v30, -1.0
    v_fmac_f32 v69, v69, v29
    ds_read_b64_tr_b16 v[52:53], v5 offset:6144
    ds_read_b64_tr_b16 v[54:55], v5 offset:6656
    s_waitcnt lgkmcnt(4)
    v_mfma_f32_32x32x16_bf16 v[88:103], v[44:47], v[116:119], v[88:103]
    ds_read_b64_tr_b16 v[40:41], v5 offset:8192
    ds_read_b64_tr_b16 v[42:43], v5 offset:8704
    s_waitcnt lgkmcnt(4)
    v_mfma_f32_32x32x16_bf16 v[88:103], v[48:51], v[120:123], v[88:103]
    s_waitcnt lgkmcnt(2)
    s_waitcnt vmcnt(6)
    s_barrier
    v_mfma_f32_32x32x16_bf16 v[88:103], v[52:55], v[124:127], v[88:103]
    v_rcp_f32 v30, v30
    v_mul_f32 v24, s36, v72
    v_fma_f32 v31, v27, -0.5, -1.0
    v_cvt_pk_bf16_f32 v38, v68, v69
    ds_read_b64_tr_b16 v[44:45], v5 offset:10240
    ds_read_b64_tr_b16 v[46:47], v5 offset:10752
    ds_read_b64_tr_b16 v[48:49], v5 offset:12288
    ds_read_b64_tr_b16 v[50:51], v5 offset:12800
    s_add_u32 m0, s33, 131072
    s_add_u32 s35, s45, 384
    buffer_load_dwordx4 v1, s[8:11], s35 offen lds
    s_waitcnt lgkmcnt(4)
    v_mfma_f32_32x32x16_bf16 v[88:103], v[40:43], v[128:131], v[88:103]
    v_exp_f32 v24, v24
    v_fma_f32 v31, v27, v31, -1.0
    v_fmac_f32 v70, v70, v30
    ds_read_b64_tr_b16 v[52:53], v5 offset:14336
    ds_read_b64_tr_b16 v[54:55], v5 offset:14848
    s_waitcnt lgkmcnt(4)
    v_mfma_f32_32x32x16_bf16 v[88:103], v[44:47], v[132:135], v[88:103]
    v_rcp_f32 v31, v31
    v_mul_f32 v25, s36, v73
    v_fma_f32 v28, v24, -0.5, -1.0
    ds_read_b64_tr_b16 v[40:41], v5 offset:32768
    ds_read_b64_tr_b16 v[42:43], v5 offset:33280
    s_waitcnt lgkmcnt(4)
    v_mfma_f32_32x32x16_bf16 v[88:103], v[48:51], v[136:139], v[88:103]
    v_exp_f32 v25, v25
    v_fma_f32 v28, v24, v28, -1.0
    v_fmac_f32 v71, v71, v31
    ds_read_b64_tr_b16 v[44:45], v5 offset:34816
    ds_read_b64_tr_b16 v[46:47], v5 offset:35328
    s_waitcnt lgkmcnt(4)
    v_mfma_f32_32x32x16_bf16 v[88:103], v[52:55], v[140:143], v[88:103]
    v_rcp_f32 v28, v28
    v_mul_f32 v26, s36, v74
    v_fma_f32 v29, v25, -0.5, -1.0
    v_cvt_pk_bf16_f32 v39, v70, v71
    ds_read_b64_tr_b16 v[48:49], v5 offset:36864
    ds_read_b64_tr_b16 v[50:51], v5 offset:37376
    ds_write_b128 v11, v[36:39] offset:17408
    buffer_load_dwordx4 v2, s[8:11], s35 offen offset:1024 lds
    s_waitcnt lgkmcnt(5)
    v_mfma_f32_32x32x16_bf16 v[88:103], v[40:43], v[144:147], v[88:103]
    v_exp_f32 v26, v26
    v_fma_f32 v29, v25, v29, -1.0
    v_fmac_f32 v72, v72, v28
    ds_read_b64_tr_b16 v[52:53], v5 offset:38912
    ds_read_b64_tr_b16 v[54:55], v5 offset:39424
    s_waitcnt lgkmcnt(5)
    v_mfma_f32_32x32x16_bf16 v[88:103], v[44:47], v[148:151], v[88:103]
    v_rcp_f32 v29, v29
    v_mul_f32 v27, s36, v75
    v_fma_f32 v30, v26, -0.5, -1.0
    ds_read_b64_tr_b16 v[40:41], v5 offset:40960
    ds_read_b64_tr_b16 v[42:43], v5 offset:41472
    s_waitcnt lgkmcnt(5)
    v_mfma_f32_32x32x16_bf16 v[88:103], v[48:51], v[152:155], v[88:103]
    v_exp_f32 v27, v27
    v_fma_f32 v30, v26, v30, -1.0
    v_fmac_f32 v73, v73, v29
    ds_read_b64_tr_b16 v[44:45], v5 offset:43008
    ds_read_b64_tr_b16 v[46:47], v5 offset:43520
    s_waitcnt lgkmcnt(4)
    v_mfma_f32_32x32x16_bf16 v[88:103], v[52:55], v[156:159], v[88:103]
    v_rcp_f32 v30, v30
    v_mul_f32 v24, s36, v76
    v_fma_f32 v31, v27, -0.5, -1.0
    v_cvt_pk_bf16_f32 v32, v72, v73
    ds_read_b64_tr_b16 v[48:49], v5 offset:45056
    ds_read_b64_tr_b16 v[50:51], v5 offset:45568
    s_waitcnt lgkmcnt(4)
    v_mfma_f32_32x32x16_bf16 v[88:103], v[40:43], v[160:163], v[88:103]
    v_exp_f32 v24, v24
    v_fma_f32 v31, v27, v31, -1.0
    v_fmac_f32 v74, v74, v30
    ds_read_b64_tr_b16 v[52:53], v5 offset:47104
    ds_read_b64_tr_b16 v[54:55], v5 offset:47616
    s_waitcnt lgkmcnt(4)
    v_mfma_f32_32x32x16_bf16 v[88:103], v[44:47], v[164:167], v[88:103]
    v_rcp_f32 v31, v31
    v_mul_f32 v25, s36, v77
    v_fma_f32 v28, v24, -0.5, -1.0
    ds_read_b64_tr_b16 v[40:41], v5 offset:49152
    ds_read_b64_tr_b16 v[42:43], v5 offset:49664
    s_waitcnt lgkmcnt(4)
    v_mfma_f32_32x32x16_bf16 v[88:103], v[48:51], v[168:171], v[88:103]
    s_waitcnt lgkmcnt(2)
    s_waitcnt vmcnt(6)
    s_barrier
    v_mfma_f32_32x32x16_bf16 v[88:103], v[52:55], v[172:175], v[88:103]
    v_exp_f32 v25, v25
    v_fma_f32 v28, v24, v28, -1.0
    v_fmac_f32 v75, v75, v31
    ds_read_b64_tr_b16 v[44:45], v5 offset:51200
    ds_read_b64_tr_b16 v[46:47], v5 offset:51712
    ds_read_b64_tr_b16 v[48:49], v5 offset:53248
    ds_read_b64_tr_b16 v[50:51], v5 offset:53760
    s_add_u32 m0, s33, 0
    s_add_u32 s35, s47, 384
    buffer_load_dwordx4 v1, s[8:11], s35 offen lds
    s_waitcnt lgkmcnt(4)
    v_mfma_f32_32x32x16_bf16 v[88:103], v[40:43], v[176:179], v[88:103]
    v_rcp_f32 v28, v28
    v_mul_f32 v26, s36, v78
    v_fma_f32 v29, v25, -0.5, -1.0
    v_cvt_pk_bf16_f32 v33, v74, v75
    ds_read_b64_tr_b16 v[52:53], v5 offset:55296
    ds_read_b64_tr_b16 v[54:55], v5 offset:55808
    s_waitcnt lgkmcnt(4)
    v_mfma_f32_32x32x16_bf16 v[88:103], v[44:47], v[180:183], v[88:103]
    v_exp_f32 v26, v26
    v_fma_f32 v29, v25, v29, -1.0
    v_fmac_f32 v76, v76, v28
    ds_read_b64_tr_b16 v[40:41], v5 offset:57344
    ds_read_b64_tr_b16 v[42:43], v5 offset:57856
    s_waitcnt lgkmcnt(4)
    v_mfma_f32_32x32x16_bf16 v[88:103], v[48:51], v[184:187], v[88:103]
    v_rcp_f32 v29, v29
    v_mul_f32 v27, s36, v79
    v_fma_f32 v30, v26, -0.5, -1.0
    ds_read_b64_tr_b16 v[44:45], v5 offset:59392
    ds_read_b64_tr_b16 v[46:47], v5 offset:59904
    s_waitcnt lgkmcnt(4)
    v_mfma_f32_32x32x16_bf16 v[88:103], v[52:55], v[188:191], v[88:103]
    v_exp_f32 v27, v27
    v_fma_f32 v30, v26, v30, -1.0
    v_fmac_f32 v77, v77, v29
    ds_read_b64_tr_b16 v[48:49], v5 offset:61440
    ds_read_b64_tr_b16 v[50:51], v5 offset:61952
    buffer_load_dwordx4 v2, s[8:11], s35 offen offset:1024 lds
    s_waitcnt lgkmcnt(4)
    v_mfma_f32_32x32x16_bf16 v[88:103], v[40:43], v[192:195], v[88:103]
    v_rcp_f32 v30, v30
    v_mul_f32 v24, s36, v80
    v_fma_f32 v31, v27, -0.5, -1.0
    v_cvt_pk_bf16_f32 v34, v76, v77
    ds_read_b64_tr_b16 v[52:53], v5 offset:63488
    ds_read_b64_tr_b16 v[54:55], v5 offset:64000
    s_waitcnt lgkmcnt(4)
    v_mfma_f32_32x32x16_bf16 v[88:103], v[44:47], v[196:199], v[88:103]
    v_exp_f32 v24, v24
    v_fma_f32 v31, v27, v31, -1.0
    v_fmac_f32 v78, v78, v30
    ds_read_b64_tr_b16 v[40:41], v6 offset:0
    ds_read_b64_tr_b16 v[42:43], v6 offset:512
    s_waitcnt lgkmcnt(4)
    v_mfma_f32_32x32x16_bf16 v[88:103], v[48:51], v[200:203], v[88:103]
    v_rcp_f32 v31, v31
    v_mul_f32 v25, s36, v81
    v_fma_f32 v28, v24, -0.5, -1.0
    ds_read_b64_tr_b16 v[44:45], v6 offset:2048
    ds_read_b64_tr_b16 v[46:47], v6 offset:2560
    s_add_u32 m0, s33, 32768
    s_add_u32 s35, s49, 384
    s_waitcnt lgkmcnt(4)
    v_mfma_f32_32x32x16_bf16 v[88:103], v[52:55], v[204:207], v[88:103]
    v_exp_f32 v25, v25
    v_fma_f32 v28, v24, v28, -1.0
    v_fmac_f32 v79, v79, v31
    ds_read_b64_tr_b16 v[48:49], v6 offset:4096
    ds_read_b64_tr_b16 v[50:51], v6 offset:4608
    buffer_load_dwordx4 v1, s[8:11], s35 offen lds
    s_waitcnt lgkmcnt(4)
    v_mfma_f32_32x32x16_bf16 v[88:103], v[40:43], v[208:211], v[88:103]
    v_rcp_f32 v28, v28
    v_mul_f32 v26, s36, v82
    v_fma_f32 v29, v25, -0.5, -1.0
    v_cvt_pk_bf16_f32 v35, v78, v79
    ds_read_b64_tr_b16 v[52:53], v6 offset:6144
    ds_read_b64_tr_b16 v[54:55], v6 offset:6656
    ds_write_b128 v12, v[32:35] offset:32768
    s_waitcnt lgkmcnt(5)
    v_mfma_f32_32x32x16_bf16 v[88:103], v[44:47], v[212:215], v[88:103]
    v_exp_f32 v26, v26
    v_fma_f32 v29, v25, v29, -1.0
    v_fmac_f32 v80, v80, v28
    ds_read_b64_tr_b16 v[40:41], v6 offset:8192
    ds_read_b64_tr_b16 v[42:43], v6 offset:8704
    s_waitcnt lgkmcnt(5)
    v_mfma_f32_32x32x16_bf16 v[88:103], v[48:51], v[216:219], v[88:103]
    s_waitcnt lgkmcnt(3)
    s_waitcnt vmcnt(5)
    s_barrier
    v_mfma_f32_32x32x16_bf16 v[88:103], v[52:55], v[220:223], v[88:103]
    v_rcp_f32 v29, v29
    v_mul_f32 v27, s36, v83
    v_fma_f32 v30, v26, -0.5, -1.0
    ds_read_b64_tr_b16 v[44:45], v6 offset:10240
    ds_read_b64_tr_b16 v[46:47], v6 offset:10752
    ds_read_b64_tr_b16 v[48:49], v6 offset:12288
    ds_read_b64_tr_b16 v[50:51], v6 offset:12800
    buffer_load_dwordx4 v2, s[8:11], s35 offen offset:1024 lds
    s_waitcnt lgkmcnt(4)
    v_mfma_f32_32x32x16_bf16 v[88:103], v[40:43], v[224:227], v[88:103]
    v_exp_f32 v27, v27
    v_fma_f32 v30, v26, v30, -1.0
    v_fmac_f32 v81, v81, v29
    ds_read_b64_tr_b16 v[52:53], v6 offset:14336
    ds_read_b64_tr_b16 v[54:55], v6 offset:14848
    ds_read_b128 v[56:59], v17 offset:768
    s_waitcnt lgkmcnt(5)
    v_mfma_f32_32x32x16_bf16 v[88:103], v[44:47], v[228:231], v[88:103]
    v_rcp_f32 v30, v30
    v_mul_f32 v24, s36, v84
    v_fma_f32 v31, v27, -0.5, -1.0
    v_cvt_pk_bf16_f32 v36, v80, v81
    ds_read_b64_tr_b16 v[40:41], v6 offset:16384
    ds_read_b64_tr_b16 v[42:43], v6 offset:16896
    ds_read_b128 v[60:63], v17 offset:800
    s_waitcnt lgkmcnt(6)
    v_mfma_f32_32x32x16_bf16 v[88:103], v[48:51], v[232:235], v[88:103]
    v_exp_f32 v24, v24
    v_fma_f32 v31, v27, v31, -1.0
    v_fmac_f32 v82, v82, v30
    ds_read_b64_tr_b16 v[44:45], v6 offset:18432
    ds_read_b64_tr_b16 v[46:47], v6 offset:18944
    ds_read_b128 v[64:67], v17 offset:832
    s_add_u32 m0, s33, 49152
    s_add_u32 s35, s42, 512
    s_waitcnt lgkmcnt(7)
    v_mfma_f32_32x32x16_bf16 v[88:103], v[52:55], v[236:239], v[88:103]
    v_rcp_f32 v31, v31
    v_mul_f32 v25, s36, v85
    v_fma_f32 v28, v24, -0.5, -1.0
    ds_read_b64_tr_b16 v[48:49], v6 offset:20480
    ds_read_b64_tr_b16 v[50:51], v6 offset:20992
    ds_read_b128 v[68:71], v17 offset:864
    buffer_load_dwordx4 v1, s[8:11], s35 offen lds
    s_waitcnt lgkmcnt(7)
    v_mfma_f32_32x32x16_bf16 v[88:103], v[40:43], v[240:243], v[88:103]
    v_exp_f32 v25, v25
    v_fma_f32 v28, v24, v28, -1.0
    v_fmac_f32 v83, v83, v31
    ds_read_b64_tr_b16 v[52:53], v6 offset:22528
    ds_read_b64_tr_b16 v[54:55], v6 offset:23040
    s_waitcnt lgkmcnt(6)
    v_mfma_f32_32x32x16_bf16 v[88:103], v[44:47], v[244:247], v[88:103]
    v_rcp_f32 v28, v28
    v_mul_f32 v26, s36, v86
    v_fma_f32 v29, v25, -0.5, -1.0
    v_cvt_pk_bf16_f32 v37, v82, v83
    ds_read_b64_tr_b16 v[40:41], v6 offset:24576
    ds_read_b64_tr_b16 v[42:43], v6 offset:25088
    s_waitcnt lgkmcnt(5)
    v_mfma_f32_32x32x16_bf16 v[88:103], v[48:51], v[248:251], v[88:103]
    v_exp_f32 v26, v26
    v_fma_f32 v29, v25, v29, -1.0
    v_fmac_f32 v84, v84, v28
    ds_read_b64_tr_b16 v[44:45], v6 offset:26624
    ds_read_b64_tr_b16 v[46:47], v6 offset:27136
    s_waitcnt lgkmcnt(4)
    v_mfma_f32_32x32x16_bf16 v[88:103], v[52:55], v[252:255], v[88:103]
    v_rcp_f32 v29, v29
    v_mul_f32 v27, s36, v87
    v_fma_f32 v30, v26, -0.5, -1.0
    ds_read_b64_tr_b16 v[48:49], v6 offset:28672
    ds_read_b64_tr_b16 v[50:51], v6 offset:29184
    buffer_load_dwordx4 v2, s[8:11], s35 offen offset:1024 lds
    s_waitcnt lgkmcnt(4)
    v_mfma_f32_32x32x16_bf16 v[56:71], v[40:43], v[112:115], v[56:71]
    v_exp_f32 v27, v27
    v_fma_f32 v30, v26, v30, -1.0
    v_fmac_f32 v85, v85, v29
    ds_read_b64_tr_b16 v[52:53], v6 offset:30720
    ds_read_b64_tr_b16 v[54:55], v6 offset:31232
    s_waitcnt lgkmcnt(4)
    v_mfma_f32_32x32x16_bf16 v[56:71], v[44:47], v[116:119], v[56:71]
    ds_read_b64_tr_b16 v[40:41], v6 offset:49152
    ds_read_b64_tr_b16 v[42:43], v6 offset:49664
    s_waitcnt lgkmcnt(4)
    v_mfma_f32_32x32x16_bf16 v[56:71], v[48:51], v[120:123], v[56:71]
    s_waitcnt lgkmcnt(2)
    s_waitcnt vmcnt(6)
    s_barrier
    v_mfma_f32_32x32x16_bf16 v[56:71], v[52:55], v[124:127], v[56:71]
    v_rcp_f32 v30, v30
    v_mul_f32 v24, s36, v88
    v_fma_f32 v31, v27, -0.5, -1.0
    v_cvt_pk_bf16_f32 v38, v84, v85
    ds_read_b64_tr_b16 v[44:45], v6 offset:51200
    ds_read_b64_tr_b16 v[46:47], v6 offset:51712
    ds_read_b64_tr_b16 v[48:49], v6 offset:53248
    ds_read_b64_tr_b16 v[50:51], v6 offset:53760
    s_add_u32 m0, s33, 81920
    s_add_u32 s35, s44, 512
    buffer_load_dwordx4 v1, s[8:11], s35 offen lds
    s_waitcnt lgkmcnt(4)
    v_mfma_f32_32x32x16_bf16 v[56:71], v[40:43], v[128:131], v[56:71]
    v_exp_f32 v24, v24
    v_fma_f32 v31, v27, v31, -1.0
    v_fmac_f32 v86, v86, v30
    ds_read_b64_tr_b16 v[52:53], v6 offset:55296
    ds_read_b64_tr_b16 v[54:55], v6 offset:55808
    s_waitcnt lgkmcnt(4)
    v_mfma_f32_32x32x16_bf16 v[56:71], v[44:47], v[132:135], v[56:71]
    v_rcp_f32 v31, v31
    v_mul_f32 v25, s36, v89
    v_fma_f32 v28, v24, -0.5, -1.0
    ds_read_b64_tr_b16 v[40:41], v6 offset:57344
    ds_read_b64_tr_b16 v[42:43], v6 offset:57856
    s_waitcnt lgkmcnt(4)
    v_mfma_f32_32x32x16_bf16 v[56:71], v[48:51], v[136:139], v[56:71]
    v_exp_f32 v25, v25
    v_fma_f32 v28, v24, v28, -1.0
    v_fmac_f32 v87, v87, v31
    ds_read_b64_tr_b16 v[44:45], v6 offset:59392
    ds_read_b64_tr_b16 v[46:47], v6 offset:59904
    s_waitcnt lgkmcnt(4)
    v_mfma_f32_32x32x16_bf16 v[56:71], v[52:55], v[140:143], v[56:71]
    v_rcp_f32 v28, v28
    v_mul_f32 v26, s36, v90
    v_fma_f32 v29, v25, -0.5, -1.0
    v_cvt_pk_bf16_f32 v39, v86, v87
    ds_read_b64_tr_b16 v[48:49], v6 offset:61440
    ds_read_b64_tr_b16 v[50:51], v6 offset:61952
    ds_write_b128 v12, v[36:39] offset:33792
    buffer_load_dwordx4 v2, s[8:11], s35 offen offset:1024 lds
    s_waitcnt lgkmcnt(5)
    v_mfma_f32_32x32x16_bf16 v[56:71], v[40:43], v[144:147], v[56:71]
    v_exp_f32 v26, v26
    v_fma_f32 v29, v25, v29, -1.0
    v_fmac_f32 v88, v88, v28
    ds_read_b64_tr_b16 v[52:53], v6 offset:63488
    ds_read_b64_tr_b16 v[54:55], v6 offset:64000
    s_waitcnt lgkmcnt(5)
    v_mfma_f32_32x32x16_bf16 v[56:71], v[44:47], v[148:151], v[56:71]
    v_rcp_f32 v29, v29
    v_mul_f32 v27, s36, v91
    v_fma_f32 v30, v26, -0.5, -1.0
    ds_read_b64_tr_b16 v[40:41], v7 offset:0
    ds_read_b64_tr_b16 v[42:43], v7 offset:512
    s_waitcnt lgkmcnt(5)
    v_mfma_f32_32x32x16_bf16 v[56:71], v[48:51], v[152:155], v[56:71]
    v_exp_f32 v27, v27
    v_fma_f32 v30, v26, v30, -1.0
    v_fmac_f32 v89, v89, v29
    ds_read_b64_tr_b16 v[44:45], v7 offset:2048
    ds_read_b64_tr_b16 v[46:47], v7 offset:2560
    s_waitcnt lgkmcnt(4)
    v_mfma_f32_32x32x16_bf16 v[56:71], v[52:55], v[156:159], v[56:71]
    v_rcp_f32 v30, v30
    v_mul_f32 v24, s36, v92
    v_fma_f32 v31, v27, -0.5, -1.0
    v_cvt_pk_bf16_f32 v32, v88, v89
    ds_read_b64_tr_b16 v[48:49], v7 offset:4096
    ds_read_b64_tr_b16 v[50:51], v7 offset:4608
    s_waitcnt lgkmcnt(4)
    v_mfma_f32_32x32x16_bf16 v[56:71], v[40:43], v[160:163], v[56:71]
    v_exp_f32 v24, v24
    v_fma_f32 v31, v27, v31, -1.0
    v_fmac_f32 v90, v90, v30
    ds_read_b64_tr_b16 v[52:53], v7 offset:6144
    ds_read_b64_tr_b16 v[54:55], v7 offset:6656
    s_waitcnt lgkmcnt(4)
    v_mfma_f32_32x32x16_bf16 v[56:71], v[44:47], v[164:167], v[56:71]
    v_rcp_f32 v31, v31
    v_mul_f32 v25, s36, v93
    v_fma_f32 v28, v24, -0.5, -1.0
    ds_read_b64_tr_b16 v[40:41], v7 offset:8192
    ds_read_b64_tr_b16 v[42:43], v7 offset:8704
    s_waitcnt lgkmcnt(4)
    v_mfma_f32_32x32x16_bf16 v[56:71], v[48:51], v[168:171], v[56:71]
    s_waitcnt lgkmcnt(2)
    s_waitcnt vmcnt(4)
    s_barrier
    v_mfma_f32_32x32x16_bf16 v[56:71], v[52:55], v[172:175], v[56:71]
    v_exp_f32 v25, v25
    v_fma_f32 v28, v24, v28, -1.0
    v_fmac_f32 v91, v91, v31
    ds_read_b64_tr_b16 v[44:45], v7 offset:10240
    ds_read_b64_tr_b16 v[46:47], v7 offset:10752
    ds_read_b64_tr_b16 v[48:49], v7 offset:12288
    ds_read_b64_tr_b16 v[50:51], v7 offset:12800
    s_add_u32 m0, s33, 114688
    s_add_u32 s35, s46, 512
    buffer_load_dwordx4 v1, s[8:11], s35 offen lds
    s_waitcnt lgkmcnt(4)
    v_mfma_f32_32x32x16_bf16 v[56:71], v[40:43], v[176:179], v[56:71]
    v_rcp_f32 v28, v28
    v_mul_f32 v26, s36, v94
    v_fma_f32 v29, v25, -0.5, -1.0
    v_cvt_pk_bf16_f32 v33, v90, v91
    ds_read_b64_tr_b16 v[52:53], v7 offset:14336
    ds_read_b64_tr_b16 v[54:55], v7 offset:14848
    s_waitcnt lgkmcnt(4)
    v_mfma_f32_32x32x16_bf16 v[56:71], v[44:47], v[180:183], v[56:71]
    v_exp_f32 v26, v26
    v_fma_f32 v29, v25, v29, -1.0
    v_fmac_f32 v92, v92, v28
    ds_read_b64_tr_b16 v[40:41], v5 offset:0
    ds_read_b64_tr_b16 v[42:43], v5 offset:512
    s_waitcnt lgkmcnt(4)
    v_mfma_f32_32x32x16_bf16 v[56:71], v[48:51], v[184:187], v[56:71]
    v_rcp_f32 v29, v29
    v_mul_f32 v27, s36, v95
    v_fma_f32 v30, v26, -0.5, -1.0
    ds_read_b64_tr_b16 v[44:45], v5 offset:2048
    ds_read_b64_tr_b16 v[46:47], v5 offset:2560
    s_waitcnt lgkmcnt(4)
    v_mfma_f32_32x32x16_bf16 v[56:71], v[52:55], v[188:191], v[56:71]
    v_exp_f32 v27, v27
    v_fma_f32 v30, v26, v30, -1.0
    v_fmac_f32 v93, v93, v29
    ds_read_b64_tr_b16 v[48:49], v5 offset:4096
    ds_read_b64_tr_b16 v[50:51], v5 offset:4608
    buffer_load_dwordx4 v2, s[8:11], s35 offen offset:1024 lds
    s_waitcnt lgkmcnt(4)
    v_mfma_f32_32x32x16_bf16 v[56:71], v[40:43], v[192:195], v[56:71]
    v_rcp_f32 v30, v30
    v_mul_f32 v24, s36, v96
    v_fma_f32 v31, v27, -0.5, -1.0
    v_cvt_pk_bf16_f32 v34, v92, v93
    ds_read_b64_tr_b16 v[52:53], v5 offset:6144
    ds_read_b64_tr_b16 v[54:55], v5 offset:6656
    s_waitcnt lgkmcnt(4)
    v_mfma_f32_32x32x16_bf16 v[56:71], v[44:47], v[196:199], v[56:71]
    v_exp_f32 v24, v24
    v_fma_f32 v31, v27, v31, -1.0
    v_fmac_f32 v94, v94, v30
    ds_read_b64_tr_b16 v[40:41], v5 offset:8192
    ds_read_b64_tr_b16 v[42:43], v5 offset:8704
    s_waitcnt lgkmcnt(4)
    v_mfma_f32_32x32x16_bf16 v[56:71], v[48:51], v[200:203], v[56:71]
    v_rcp_f32 v31, v31
    v_mul_f32 v25, s36, v97
    v_fma_f32 v28, v24, -0.5, -1.0
    ds_read_b64_tr_b16 v[44:45], v5 offset:10240
    ds_read_b64_tr_b16 v[46:47], v5 offset:10752
    s_waitcnt lgkmcnt(4)
    v_mfma_f32_32x32x16_bf16 v[56:71], v[52:55], v[204:207], v[56:71]
    v_exp_f32 v25, v25
    v_fma_f32 v28, v24, v28, -1.0
    v_fmac_f32 v95, v95, v31
    ds_read_b64_tr_b16 v[48:49], v5 offset:12288
    ds_read_b64_tr_b16 v[50:51], v5 offset:12800
    s_waitcnt lgkmcnt(4)
    v_mfma_f32_32x32x16_bf16 v[56:71], v[40:43], v[208:211], v[56:71]
    v_rcp_f32 v28, v28
    v_mul_f32 v26, s36, v98
    v_fma_f32 v29, v25, -0.5, -1.0
    v_cvt_pk_bf16_f32 v35, v94, v95
    ds_read_b64_tr_b16 v[52:53], v5 offset:14336
    ds_read_b64_tr_b16 v[54:55], v5 offset:14848
    ds_write_b128 v12, v[32:35] offset:0
    s_waitcnt lgkmcnt(5)
    v_mfma_f32_32x32x16_bf16 v[56:71], v[44:47], v[212:215], v[56:71]
    v_exp_f32 v26, v26
    v_fma_f32 v29, v25, v29, -1.0
    v_fmac_f32 v96, v96, v28
    ds_read_b64_tr_b16 v[40:41], v5 offset:32768
    ds_read_b64_tr_b16 v[42:43], v5 offset:33280
    s_waitcnt lgkmcnt(5)
    v_mfma_f32_32x32x16_bf16 v[56:71], v[48:51], v[216:219], v[56:71]
    s_waitcnt lgkmcnt(3)
    s_waitcnt vmcnt(4)
    s_barrier
    v_mfma_f32_32x32x16_bf16 v[56:71], v[52:55], v[220:223], v[56:71]
    v_rcp_f32 v29, v29
    v_mul_f32 v27, s36, v99
    v_fma_f32 v30, v26, -0.5, -1.0
    ds_read_b64_tr_b16 v[44:45], v5 offset:34816
    ds_read_b64_tr_b16 v[46:47], v5 offset:35328
    ds_read_b64_tr_b16 v[48:49], v5 offset:36864
    ds_read_b64_tr_b16 v[50:51], v5 offset:37376
    s_add_u32 m0, s33, 131072
    s_add_u32 s35, s48, 512
    buffer_load_dwordx4 v1, s[8:11], s35 offen lds
    s_waitcnt lgkmcnt(4)
    v_mfma_f32_32x32x16_bf16 v[56:71], v[40:43], v[224:227], v[56:71]
    v_exp_f32 v27, v27
    v_fma_f32 v30, v26, v30, -1.0
    v_fmac_f32 v97, v97, v29
    ds_read_b64_tr_b16 v[52:53], v5 offset:38912
    ds_read_b64_tr_b16 v[54:55], v5 offset:39424
    ds_read_b128 v[72:75], v17 offset:1024
    s_waitcnt lgkmcnt(5)
    v_mfma_f32_32x32x16_bf16 v[56:71], v[44:47], v[228:231], v[56:71]
    v_rcp_f32 v30, v30
    v_mul_f32 v24, s36, v100
    v_fma_f32 v31, v27, -0.5, -1.0
    v_cvt_pk_bf16_f32 v36, v96, v97
    ds_read_b64_tr_b16 v[40:41], v5 offset:40960
    ds_read_b64_tr_b16 v[42:43], v5 offset:41472
    ds_read_b128 v[76:79], v17 offset:1056
    s_waitcnt lgkmcnt(6)
    v_mfma_f32_32x32x16_bf16 v[56:71], v[48:51], v[232:235], v[56:71]
    v_exp_f32 v24, v24
    v_fma_f32 v31, v27, v31, -1.0
    v_fmac_f32 v98, v98, v30
    ds_read_b64_tr_b16 v[44:45], v5 offset:43008
    ds_read_b64_tr_b16 v[46:47], v5 offset:43520
    ds_read_b128 v[80:83], v17 offset:1088
    s_waitcnt lgkmcnt(7)
    v_mfma_f32_32x32x16_bf16 v[56:71], v[52:55], v[236:239], v[56:71]
    v_rcp_f32 v31, v31
    v_mul_f32 v25, s36, v101
    v_fma_f32 v28, v24, -0.5, -1.0
    ds_read_b64_tr_b16 v[48:49], v5 offset:45056
    ds_read_b64_tr_b16 v[50:51], v5 offset:45568
    ds_read_b128 v[84:87], v17 offset:1120
    buffer_load_dwordx4 v2, s[8:11], s35 offen offset:1024 lds
    s_waitcnt lgkmcnt(7)
    v_mfma_f32_32x32x16_bf16 v[56:71], v[40:43], v[240:243], v[56:71]
    v_exp_f32 v25, v25
    v_fma_f32 v28, v24, v28, -1.0
    v_fmac_f32 v99, v99, v31
    ds_read_b64_tr_b16 v[52:53], v5 offset:47104
    ds_read_b64_tr_b16 v[54:55], v5 offset:47616
    s_waitcnt lgkmcnt(6)
    v_mfma_f32_32x32x16_bf16 v[56:71], v[44:47], v[244:247], v[56:71]
    v_rcp_f32 v28, v28
    v_mul_f32 v26, s36, v102
    v_fma_f32 v29, v25, -0.5, -1.0
    v_cvt_pk_bf16_f32 v37, v98, v99
    ds_read_b64_tr_b16 v[40:41], v5 offset:49152
    ds_read_b64_tr_b16 v[42:43], v5 offset:49664
    s_waitcnt lgkmcnt(5)
    v_mfma_f32_32x32x16_bf16 v[56:71], v[48:51], v[248:251], v[56:71]
    v_exp_f32 v26, v26
    v_fma_f32 v29, v25, v29, -1.0
    v_fmac_f32 v100, v100, v28
    ds_read_b64_tr_b16 v[44:45], v5 offset:51200
    ds_read_b64_tr_b16 v[46:47], v5 offset:51712
    s_add_u32 m0, s33, 0
    s_add_u32 s35, s50, s59
    s_waitcnt lgkmcnt(4)
    v_mfma_f32_32x32x16_bf16 v[56:71], v[52:55], v[252:255], v[56:71]
    v_rcp_f32 v29, v29
    v_mul_f32 v27, s36, v103
    v_fma_f32 v30, v26, -0.5, -1.0
    ds_read_b64_tr_b16 v[48:49], v5 offset:53248
    ds_read_b64_tr_b16 v[50:51], v5 offset:53760
    buffer_load_dwordx4 v1, s[8:11], s35 offen lds
    s_waitcnt lgkmcnt(4)
    v_mfma_f32_32x32x16_bf16 v[72:87], v[40:43], v[112:115], v[72:87]
    v_exp_f32 v27, v27
    v_fma_f32 v30, v26, v30, -1.0
    v_fmac_f32 v101, v101, v29
    ds_read_b64_tr_b16 v[52:53], v5 offset:55296
    ds_read_b64_tr_b16 v[54:55], v5 offset:55808
    s_waitcnt lgkmcnt(4)
    v_mfma_f32_32x32x16_bf16 v[72:87], v[44:47], v[116:119], v[72:87]
    ds_read_b64_tr_b16 v[40:41], v5 offset:57344
    ds_read_b64_tr_b16 v[42:43], v5 offset:57856
    s_waitcnt lgkmcnt(4)
    v_mfma_f32_32x32x16_bf16 v[72:87], v[48:51], v[120:123], v[72:87]
    s_waitcnt lgkmcnt(2)
    s_waitcnt vmcnt(3)
    s_barrier
    v_mfma_f32_32x32x16_bf16 v[72:87], v[52:55], v[124:127], v[72:87]
    v_rcp_f32 v30, v30
    v_mul_f32 v24, s36, v56
    v_fma_f32 v31, v27, -0.5, -1.0
    v_cvt_pk_bf16_f32 v38, v100, v101
    ds_read_b64_tr_b16 v[44:45], v5 offset:59392
    ds_read_b64_tr_b16 v[46:47], v5 offset:59904
    ds_read_b64_tr_b16 v[48:49], v5 offset:61440
    ds_read_b64_tr_b16 v[50:51], v5 offset:61952
    buffer_load_dwordx4 v2, s[8:11], s35 offen offset:1024 lds
    s_waitcnt lgkmcnt(4)
    v_mfma_f32_32x32x16_bf16 v[72:87], v[40:43], v[128:131], v[72:87]
    v_exp_f32 v24, v24
    v_fma_f32 v31, v27, v31, -1.0
    v_fmac_f32 v102, v102, v30
    ds_read_b64_tr_b16 v[52:53], v5 offset:63488
    ds_read_b64_tr_b16 v[54:55], v5 offset:64000
    s_waitcnt lgkmcnt(4)
    v_mfma_f32_32x32x16_bf16 v[72:87], v[44:47], v[132:135], v[72:87]
    v_rcp_f32 v31, v31
    v_mul_f32 v25, s36, v57
    v_fma_f32 v28, v24, -0.5, -1.0
    ds_read_b64_tr_b16 v[40:41], v6 offset:16384
    ds_read_b64_tr_b16 v[42:43], v6 offset:16896
    s_waitcnt lgkmcnt(4)
    v_mfma_f32_32x32x16_bf16 v[72:87], v[48:51], v[136:139], v[72:87]
    v_exp_f32 v25, v25
    v_fma_f32 v28, v24, v28, -1.0
    v_fmac_f32 v103, v103, v31
    ds_read_b64_tr_b16 v[44:45], v6 offset:18432
    ds_read_b64_tr_b16 v[46:47], v6 offset:18944
    s_waitcnt lgkmcnt(4)
    v_mfma_f32_32x32x16_bf16 v[72:87], v[52:55], v[140:143], v[72:87]
    v_rcp_f32 v28, v28
    v_mul_f32 v26, s36, v58
    v_fma_f32 v29, v25, -0.5, -1.0
    v_cvt_pk_bf16_f32 v39, v102, v103
    ds_read_b64_tr_b16 v[48:49], v6 offset:20480
    ds_read_b64_tr_b16 v[50:51], v6 offset:20992
    ds_write_b128 v12, v[36:39] offset:1024
    s_waitcnt lgkmcnt(5)
    v_mfma_f32_32x32x16_bf16 v[72:87], v[40:43], v[144:147], v[72:87]
    v_exp_f32 v26, v26
    v_fma_f32 v29, v25, v29, -1.0
    v_fmac_f32 v56, v56, v28
    ds_read_b64_tr_b16 v[52:53], v6 offset:22528
    ds_read_b64_tr_b16 v[54:55], v6 offset:23040
    s_waitcnt lgkmcnt(5)
    v_mfma_f32_32x32x16_bf16 v[72:87], v[44:47], v[148:151], v[72:87]
    v_rcp_f32 v29, v29
    v_mul_f32 v27, s36, v59
    v_fma_f32 v30, v26, -0.5, -1.0
    ds_read_b64_tr_b16 v[40:41], v6 offset:24576
    ds_read_b64_tr_b16 v[42:43], v6 offset:25088
    s_waitcnt lgkmcnt(5)
    v_mfma_f32_32x32x16_bf16 v[72:87], v[48:51], v[152:155], v[72:87]
    v_exp_f32 v27, v27
    v_fma_f32 v30, v26, v30, -1.0
    v_fmac_f32 v57, v57, v29
    ds_read_b64_tr_b16 v[44:45], v6 offset:26624
    ds_read_b64_tr_b16 v[46:47], v6 offset:27136
    s_waitcnt lgkmcnt(4)
    v_mfma_f32_32x32x16_bf16 v[72:87], v[52:55], v[156:159], v[72:87]
    v_rcp_f32 v30, v30
    v_mul_f32 v24, s36, v60
    v_fma_f32 v31, v27, -0.5, -1.0
    v_cvt_pk_bf16_f32 v32, v56, v57
    ds_read_b64_tr_b16 v[48:49], v6 offset:28672
    ds_read_b64_tr_b16 v[50:51], v6 offset:29184
    s_waitcnt lgkmcnt(4)
    v_mfma_f32_32x32x16_bf16 v[72:87], v[40:43], v[160:163], v[72:87]
    v_exp_f32 v24, v24
    v_fma_f32 v31, v27, v31, -1.0
    v_fmac_f32 v58, v58, v30
    ds_read_b64_tr_b16 v[52:53], v6 offset:30720
    ds_read_b64_tr_b16 v[54:55], v6 offset:31232
    s_waitcnt lgkmcnt(4)
    v_mfma_f32_32x32x16_bf16 v[72:87], v[44:47], v[164:167], v[72:87]
    v_rcp_f32 v31, v31
    v_mul_f32 v25, s36, v61
    v_fma_f32 v28, v24, -0.5, -1.0
    ds_read_b64_tr_b16 v[40:41], v6 offset:49152
    ds_read_b64_tr_b16 v[42:43], v6 offset:49664
    s_waitcnt lgkmcnt(4)
    v_mfma_f32_32x32x16_bf16 v[72:87], v[48:51], v[168:171], v[72:87]
    s_waitcnt lgkmcnt(2)
    s_waitcnt vmcnt(2)
    s_barrier
    v_mfma_f32_32x32x16_bf16 v[72:87], v[52:55], v[172:175], v[72:87]
    v_exp_f32 v25, v25
    v_fma_f32 v28, v24, v28, -1.0
    v_fmac_f32 v59, v59, v31
    ds_read_b64_tr_b16 v[44:45], v6 offset:51200
    ds_read_b64_tr_b16 v[46:47], v6 offset:51712
    ds_read_b64_tr_b16 v[48:49], v6 offset:53248
    ds_read_b64_tr_b16 v[50:51], v6 offset:53760
    s_add_u32 m0, s33, 49152
    s_add_u32 s35, s43, 640
    buffer_load_dwordx4 v1, s[8:11], s35 offen lds
    s_waitcnt lgkmcnt(4)
    v_mfma_f32_32x32x16_bf16 v[72:87], v[40:43], v[176:179], v[72:87]
    v_rcp_f32 v28, v28
    v_mul_f32 v26, s36, v62
    v_fma_f32 v29, v25, -0.5, -1.0
    v_cvt_pk_bf16_f32 v33, v58, v59
    ds_read_b64_tr_b16 v[52:53], v6 offset:55296
    ds_read_b64_tr_b16 v[54:55], v6 offset:55808
    s_waitcnt lgkmcnt(4)
    v_mfma_f32_32x32x16_bf16 v[72:87], v[44:47], v[180:183], v[72:87]
    v_exp_f32 v26, v26
    v_fma_f32 v29, v25, v29, -1.0
    v_fmac_f32 v60, v60, v28
    ds_read_b64_tr_b16 v[40:41], v6 offset:57344
    ds_read_b64_tr_b16 v[42:43], v6 offset:57856
    s_waitcnt lgkmcnt(4)
    v_mfma_f32_32x32x16_bf16 v[72:87], v[48:51], v[184:187], v[72:87]
    v_rcp_f32 v29, v29
    v_mul_f32 v27, s36, v63
    v_fma_f32 v30, v26, -0.5, -1.0
    ds_read_b64_tr_b16 v[44:45], v6 offset:59392
    ds_read_b64_tr_b16 v[46:47], v6 offset:59904
    s_waitcnt lgkmcnt(4)
    v_mfma_f32_32x32x16_bf16 v[72:87], v[52:55], v[188:191], v[72:87]
    v_exp_f32 v27, v27
    v_fma_f32 v30, v26, v30, -1.0
    v_fmac_f32 v61, v61, v29
    ds_read_b64_tr_b16 v[48:49], v6 offset:61440
    ds_read_b64_tr_b16 v[50:51], v6 offset:61952
    buffer_load_dwordx4 v2, s[8:11], s35 offen offset:1024 lds
    s_waitcnt lgkmcnt(4)
    v_mfma_f32_32x32x16_bf16 v[72:87], v[40:43], v[192:195], v[72:87]
    v_rcp_f32 v30, v30
    v_mul_f32 v24, s36, v64
    v_fma_f32 v31, v27, -0.5, -1.0
    v_cvt_pk_bf16_f32 v34, v60, v61
    ds_read_b64_tr_b16 v[52:53], v6 offset:63488
    ds_read_b64_tr_b16 v[54:55], v6 offset:64000
    s_waitcnt lgkmcnt(4)
    v_mfma_f32_32x32x16_bf16 v[72:87], v[44:47], v[196:199], v[72:87]
    v_exp_f32 v24, v24
    v_fma_f32 v31, v27, v31, -1.0
    v_fmac_f32 v62, v62, v30
    ds_read_b64_tr_b16 v[40:41], v7 offset:0
    ds_read_b64_tr_b16 v[42:43], v7 offset:512
    s_waitcnt lgkmcnt(4)
    v_mfma_f32_32x32x16_bf16 v[72:87], v[48:51], v[200:203], v[72:87]
    v_rcp_f32 v31, v31
    v_mul_f32 v25, s36, v65
    v_fma_f32 v28, v24, -0.5, -1.0
    ds_read_b64_tr_b16 v[44:45], v7 offset:2048
    ds_read_b64_tr_b16 v[46:47], v7 offset:2560
    s_add_u32 m0, s33, 81920
    s_add_u32 s35, s45, 640
    s_waitcnt lgkmcnt(4)
    v_mfma_f32_32x32x16_bf16 v[72:87], v[52:55], v[204:207], v[72:87]
    v_exp_f32 v25, v25
    v_fma_f32 v28, v24, v28, -1.0
    v_fmac_f32 v63, v63, v31
    ds_read_b64_tr_b16 v[48:49], v7 offset:4096
    ds_read_b64_tr_b16 v[50:51], v7 offset:4608
    buffer_load_dwordx4 v1, s[8:11], s35 offen lds
    s_waitcnt lgkmcnt(4)
    v_mfma_f32_32x32x16_bf16 v[72:87], v[40:43], v[208:211], v[72:87]
    v_rcp_f32 v28, v28
    v_mul_f32 v26, s36, v66
    v_fma_f32 v29, v25, -0.5, -1.0
    v_cvt_pk_bf16_f32 v35, v62, v63
    ds_read_b64_tr_b16 v[52:53], v7 offset:6144
    ds_read_b64_tr_b16 v[54:55], v7 offset:6656
    ds_write_b128 v11, v[32:35] offset:32768
    s_waitcnt lgkmcnt(5)
    v_mfma_f32_32x32x16_bf16 v[72:87], v[44:47], v[212:215], v[72:87]
    v_exp_f32 v26, v26
    v_fma_f32 v29, v25, v29, -1.0
    v_fmac_f32 v64, v64, v28
    ds_read_b64_tr_b16 v[40:41], v7 offset:8192
    ds_read_b64_tr_b16 v[42:43], v7 offset:8704
    s_waitcnt lgkmcnt(5)
    v_mfma_f32_32x32x16_bf16 v[72:87], v[48:51], v[216:219], v[72:87]
    s_waitcnt lgkmcnt(3)
    s_waitcnt vmcnt(1)
    s_barrier
    v_mfma_f32_32x32x16_bf16 v[72:87], v[52:55], v[220:223], v[72:87]
    v_rcp_f32 v29, v29
    v_mul_f32 v27, s36, v67
    v_fma_f32 v30, v26, -0.5, -1.0
    ds_read_b64_tr_b16 v[44:45], v7 offset:10240
    ds_read_b64_tr_b16 v[46:47], v7 offset:10752
    ds_read_b64_tr_b16 v[48:49], v7 offset:12288
    ds_read_b64_tr_b16 v[50:51], v7 offset:12800
    buffer_load_dwordx4 v2, s[8:11], s35 offen offset:1024 lds
    s_waitcnt lgkmcnt(4)
    v_mfma_f32_32x32x16_bf16 v[72:87], v[40:43], v[224:227], v[72:87]
    v_exp_f32 v27, v27
    v_fma_f32 v30, v26, v30, -1.0
    v_fmac_f32 v65, v65, v29
    ds_read_b64_tr_b16 v[52:53], v7 offset:14336
    ds_read_b64_tr_b16 v[54:55], v7 offset:14848
    ds_read_b128 v[88:91], v17 offset:1280
    s_waitcnt lgkmcnt(5)
    v_mfma_f32_32x32x16_bf16 v[72:87], v[44:47], v[228:231], v[72:87]
    v_rcp_f32 v30, v30
    v_mul_f32 v24, s36, v68
    v_fma_f32 v31, v27, -0.5, -1.0
    v_cvt_pk_bf16_f32 v36, v64, v65
    ds_read_b64_tr_b16 v[40:41], v5 offset:0
    ds_read_b64_tr_b16 v[42:43], v5 offset:512
    ds_read_b128 v[92:95], v17 offset:1312
    s_waitcnt lgkmcnt(6)
    v_mfma_f32_32x32x16_bf16 v[72:87], v[48:51], v[232:235], v[72:87]
    v_exp_f32 v24, v24
    v_fma_f32 v31, v27, v31, -1.0
    v_fmac_f32 v66, v66, v30
    ds_read_b64_tr_b16 v[44:45], v5 offset:2048
    ds_read_b64_tr_b16 v[46:47], v5 offset:2560
    ds_read_b128 v[96:99], v17 offset:1344
    s_add_u32 m0, s33, 114688
    s_add_u32 s35, s47, 640
    s_waitcnt lgkmcnt(7)
    v_mfma_f32_32x32x16_bf16 v[72:87], v[52:55], v[236:239], v[72:87]
    v_rcp_f32 v31, v31
    v_mul_f32 v25, s36, v69
    v_fma_f32 v28, v24, -0.5, -1.0
    ds_read_b64_tr_b16 v[48:49], v5 offset:4096
    ds_read_b64_tr_b16 v[50:51], v5 offset:4608
    ds_read_b128 v[100:103], v17 offset:1376
    buffer_load_dwordx4 v1, s[8:11], s35 offen lds
    s_waitcnt lgkmcnt(7)
    v_mfma_f32_32x32x16_bf16 v[72:87], v[40:43], v[240:243], v[72:87]
    v_exp_f32 v25, v25
    v_fma_f32 v28, v24, v28, -1.0
    v_fmac_f32 v67, v67, v31
    ds_read_b64_tr_b16 v[52:53], v5 offset:6144
    ds_read_b64_tr_b16 v[54:55], v5 offset:6656
    s_waitcnt lgkmcnt(6)
    v_mfma_f32_32x32x16_bf16 v[72:87], v[44:47], v[244:247], v[72:87]
    v_rcp_f32 v28, v28
    v_mul_f32 v26, s36, v70
    v_fma_f32 v29, v25, -0.5, -1.0
    v_cvt_pk_bf16_f32 v37, v66, v67
    ds_read_b64_tr_b16 v[40:41], v5 offset:8192
    ds_read_b64_tr_b16 v[42:43], v5 offset:8704
    s_waitcnt lgkmcnt(5)
    v_mfma_f32_32x32x16_bf16 v[72:87], v[48:51], v[248:251], v[72:87]
    v_exp_f32 v26, v26
    v_fma_f32 v29, v25, v29, -1.0
    v_fmac_f32 v68, v68, v28
    ds_read_b64_tr_b16 v[44:45], v5 offset:10240
    ds_read_b64_tr_b16 v[46:47], v5 offset:10752
    s_waitcnt lgkmcnt(4)
    v_mfma_f32_32x32x16_bf16 v[72:87], v[52:55], v[252:255], v[72:87]
    v_rcp_f32 v29, v29
    v_mul_f32 v27, s36, v71
    v_fma_f32 v30, v26, -0.5, -1.0
    ds_read_b64_tr_b16 v[48:49], v5 offset:12288
    ds_read_b64_tr_b16 v[50:51], v5 offset:12800
    buffer_load_dwordx4 v2, s[8:11], s35 offen offset:1024 lds
    s_waitcnt lgkmcnt(4)
    v_mfma_f32_32x32x16_bf16 v[88:103], v[40:43], v[112:115], v[88:103]
    v_exp_f32 v27, v27
    v_fma_f32 v30, v26, v30, -1.0
    v_fmac_f32 v69, v69, v29
    ds_read_b64_tr_b16 v[52:53], v5 offset:14336
    ds_read_b64_tr_b16 v[54:55], v5 offset:14848
    ds_read_b128 v[112:115], v14 offset:16384
    s_waitcnt lgkmcnt(5)
    v_mfma_f32_32x32x16_bf16 v[88:103], v[44:47], v[116:119], v[88:103]
    ds_read_b64_tr_b16 v[40:41], v5 offset:49152
    ds_read_b64_tr_b16 v[42:43], v5 offset:49664
    ds_read_b128 v[116:119], v14 offset:16640
    s_waitcnt lgkmcnt(6)
    v_mfma_f32_32x32x16_bf16 v[88:103], v[48:51], v[120:123], v[88:103]
    s_waitcnt lgkmcnt(4)
    s_waitcnt vmcnt(2)
    s_barrier
    v_mfma_f32_32x32x16_bf16 v[88:103], v[52:55], v[124:127], v[88:103]
    v_rcp_f32 v30, v30
    v_mul_f32 v24, s36, v72
    v_fma_f32 v31, v27, -0.5, -1.0
    v_cvt_pk_bf16_f32 v38, v68, v69
    ds_read_b64_tr_b16 v[44:45], v5 offset:51200
    ds_read_b64_tr_b16 v[46:47], v5 offset:51712
    ds_read_b64_tr_b16 v[48:49], v5 offset:53248
    ds_read_b64_tr_b16 v[50:51], v5 offset:53760
    ds_read_b128 v[120:123], v14 offset:24576
    s_add_u32 m0, s33, 131072
    s_add_u32 s35, s49, 640
    buffer_load_dwordx4 v1, s[8:11], s35 offen lds
    s_waitcnt lgkmcnt(6)
    v_mfma_f32_32x32x16_bf16 v[88:103], v[40:43], v[128:131], v[88:103]
    v_exp_f32 v24, v24
    v_fma_f32 v31, v27, v31, -1.0
    v_fmac_f32 v70, v70, v30
    ds_read_b64_tr_b16 v[52:53], v5 offset:55296
    ds_read_b64_tr_b16 v[54:55], v5 offset:55808
    ds_read_b128 v[124:127], v14 offset:24832
    s_waitcnt lgkmcnt(6)
    v_mfma_f32_32x32x16_bf16 v[88:103], v[44:47], v[132:135], v[88:103]
    v_rcp_f32 v31, v31
    v_mul_f32 v25, s36, v73
    v_fma_f32 v28, v24, -0.5, -1.0
    ds_read_b64_tr_b16 v[40:41], v5 offset:57344
    ds_read_b64_tr_b16 v[42:43], v5 offset:57856
    ds_read_b128 v[128:131], v15 offset:32768
    s_waitcnt lgkmcnt(7)
    v_mfma_f32_32x32x16_bf16 v[88:103], v[48:51], v[136:139], v[88:103]
    v_exp_f32 v25, v25
    v_fma_f32 v28, v24, v28, -1.0
    v_fmac_f32 v71, v71, v31
    ds_read_b64_tr_b16 v[44:45], v5 offset:59392
    ds_read_b64_tr_b16 v[46:47], v5 offset:59904
    ds_read_b128 v[132:135], v15 offset:33024
    s_waitcnt lgkmcnt(7)
    v_mfma_f32_32x32x16_bf16 v[88:103], v[52:55], v[140:143], v[88:103]
    v_rcp_f32 v28, v28
    v_mul_f32 v26, s36, v74
    v_fma_f32 v29, v25, -0.5, -1.0
    v_cvt_pk_bf16_f32 v39, v70, v71
    ds_read_b64_tr_b16 v[48:49], v5 offset:61440
    ds_read_b64_tr_b16 v[50:51], v5 offset:61952
    ds_write_b128 v11, v[36:39] offset:33792
    ds_read_b128 v[136:139], v15 offset:40960
    buffer_load_dwordx4 v2, s[8:11], s35 offen offset:1024 lds
    s_waitcnt lgkmcnt(8)
    v_mfma_f32_32x32x16_bf16 v[88:103], v[40:43], v[144:147], v[88:103]
    v_exp_f32 v26, v26
    v_fma_f32 v29, v25, v29, -1.0
    v_fmac_f32 v72, v72, v28
    ds_read_b64_tr_b16 v[52:53], v5 offset:63488
    ds_read_b64_tr_b16 v[54:55], v5 offset:64000
    ds_read_b128 v[140:143], v15 offset:41216
    s_waitcnt lgkmcnt(8)
    v_mfma_f32_32x32x16_bf16 v[88:103], v[44:47], v[148:151], v[88:103]
    v_rcp_f32 v29, v29
    v_mul_f32 v27, s36, v75
    v_fma_f32 v30, v26, -0.5, -1.0
    ds_read_b64_tr_b16 v[40:41], v6 offset:16384
    ds_read_b64_tr_b16 v[42:43], v6 offset:16896
    ds_read_b128 v[144:147], v15 offset:0
    s_waitcnt lgkmcnt(8)
    v_mfma_f32_32x32x16_bf16 v[88:103], v[48:51], v[152:155], v[88:103]
    v_exp_f32 v27, v27
    v_fma_f32 v30, v26, v30, -1.0
    v_fmac_f32 v73, v73, v29
    ds_read_b64_tr_b16 v[44:45], v6 offset:18432
    ds_read_b64_tr_b16 v[46:47], v6 offset:18944
    ds_read_b128 v[148:151], v15 offset:256
    s_add_u32 m0, s33, 0
    s_add_u32 s35, s34, 0
    s_waitcnt lgkmcnt(7)
    v_mfma_f32_32x32x16_bf16 v[88:103], v[52:55], v[156:159], v[88:103]
    v_rcp_f32 v30, v30
    v_mul_f32 v24, s36, v76
    v_fma_f32 v31, v27, -0.5, -1.0
    v_cvt_pk_bf16_f32 v32, v72, v73
    ds_read_b64_tr_b16 v[48:49], v6 offset:20480
    ds_read_b64_tr_b16 v[50:51], v6 offset:20992
    ds_read_b128 v[152:155], v15 offset:8192
    buffer_load_dwordx4 v3, s[12:15], s35 offen lds
    s_waitcnt lgkmcnt(7)
    v_mfma_f32_32x32x16_bf16 v[88:103], v[40:43], v[160:163], v[88:103]
    v_exp_f32 v24, v24
    v_fma_f32 v31, v27, v31, -1.0
    v_fmac_f32 v74, v74, v30
    ds_read_b64_tr_b16 v[52:53], v6 offset:22528
    ds_read_b64_tr_b16 v[54:55], v6 offset:23040
    ds_read_b128 v[156:159], v15 offset:8448
    s_waitcnt lgkmcnt(7)
    v_mfma_f32_32x32x16_bf16 v[88:103], v[44:47], v[164:167], v[88:103]
    v_rcp_f32 v31, v31
    v_mul_f32 v25, s36, v77
    v_fma_f32 v28, v24, -0.5, -1.0
    ds_read_b64_tr_b16 v[40:41], v6 offset:24576
    ds_read_b64_tr_b16 v[42:43], v6 offset:25088
    s_waitcnt lgkmcnt(6)
    v_mfma_f32_32x32x16_bf16 v[88:103], v[48:51], v[168:171], v[88:103]
    s_waitcnt lgkmcnt(3)
    s_waitcnt vmcnt(1)
    s_barrier
    v_mfma_f32_32x32x16_bf16 v[88:103], v[52:55], v[172:175], v[88:103]
    v_exp_f32 v25, v25
    v_fma_f32 v28, v24, v28, -1.0
    v_fmac_f32 v75, v75, v31
    ds_read_b64_tr_b16 v[44:45], v6 offset:26624
    ds_read_b64_tr_b16 v[46:47], v6 offset:27136
    ds_read_b64_tr_b16 v[48:49], v6 offset:28672
    ds_read_b64_tr_b16 v[50:51], v6 offset:29184
    ds_read_b128 v[160:163], v14 offset:32768
    buffer_load_dwordx4 v4, s[12:15], s35 offen offset:1024 lds
    s_waitcnt lgkmcnt(5)
    v_mfma_f32_32x32x16_bf16 v[88:103], v[40:43], v[176:179], v[88:103]
    v_rcp_f32 v28, v28
    v_mul_f32 v26, s36, v78
    v_fma_f32 v29, v25, -0.5, -1.0
    v_cvt_pk_bf16_f32 v33, v74, v75
    ds_read_b64_tr_b16 v[52:53], v6 offset:30720
    ds_read_b64_tr_b16 v[54:55], v6 offset:31232
    ds_read_b128 v[164:167], v14 offset:33024
    s_waitcnt lgkmcnt(6)
    v_mfma_f32_32x32x16_bf16 v[88:103], v[44:47], v[180:183], v[88:103]
    v_exp_f32 v26, v26
    v_fma_f32 v29, v25, v29, -1.0
    v_fmac_f32 v76, v76, v28
    ds_read_b64_tr_b16 v[40:41], v6 offset:49152
    ds_read_b64_tr_b16 v[42:43], v6 offset:49664
    ds_read_b128 v[168:171], v14 offset:40960
    s_add_u32 m0, s33, 16384
    s_add_u32 s35, s34, 147456
    s_waitcnt lgkmcnt(7)
    v_mfma_f32_32x32x16_bf16 v[88:103], v[48:51], v[184:187], v[88:103]
    v_rcp_f32 v29, v29
    v_mul_f32 v27, s36, v79
    v_fma_f32 v30, v26, -0.5, -1.0
    ds_read_b64_tr_b16 v[44:45], v6 offset:51200
    ds_read_b64_tr_b16 v[46:47], v6 offset:51712
    ds_read_b128 v[172:175], v14 offset:41216
    buffer_load_dwordx4 v3, s[12:15], s35 offen lds
    s_waitcnt lgkmcnt(7)
    v_mfma_f32_32x32x16_bf16 v[88:103], v[52:55], v[188:191], v[88:103]
    v_exp_f32 v27, v27
    v_fma_f32 v30, v26, v30, -1.0
    v_fmac_f32 v77, v77, v29
    ds_read_b64_tr_b16 v[48:49], v6 offset:53248
    ds_read_b64_tr_b16 v[50:51], v6 offset:53760
    s_waitcnt lgkmcnt(6)
    v_mfma_f32_32x32x16_bf16 v[88:103], v[40:43], v[192:195], v[88:103]
    v_rcp_f32 v30, v30
    v_mul_f32 v24, s36, v80
    v_fma_f32 v31, v27, -0.5, -1.0
    v_cvt_pk_bf16_f32 v34, v76, v77
    ds_read_b64_tr_b16 v[52:53], v6 offset:55296
    ds_read_b64_tr_b16 v[54:55], v6 offset:55808
    s_waitcnt lgkmcnt(5)
    v_mfma_f32_32x32x16_bf16 v[88:103], v[44:47], v[196:199], v[88:103]
    v_exp_f32 v24, v24
    v_fma_f32 v31, v27, v31, -1.0
    v_fmac_f32 v78, v78, v30
    ds_read_b64_tr_b16 v[40:41], v6 offset:57344
    ds_read_b64_tr_b16 v[42:43], v6 offset:57856
    buffer_load_dwordx4 v4, s[12:15], s35 offen offset:1024 lds
    s_waitcnt lgkmcnt(4)
    v_mfma_f32_32x32x16_bf16 v[88:103], v[48:51], v[200:203], v[88:103]
    v_rcp_f32 v31, v31
    v_mul_f32 v25, s36, v81
    v_fma_f32 v28, v24, -0.5, -1.0
    ds_read_b64_tr_b16 v[44:45], v6 offset:59392
    ds_read_b64_tr_b16 v[46:47], v6 offset:59904
    s_waitcnt lgkmcnt(4)
    v_mfma_f32_32x32x16_bf16 v[88:103], v[52:55], v[204:207], v[88:103]
    v_exp_f32 v25, v25
    v_fma_f32 v28, v24, v28, -1.0
    v_fmac_f32 v79, v79, v31
    ds_read_b64_tr_b16 v[48:49], v6 offset:61440
    ds_read_b64_tr_b16 v[50:51], v6 offset:61952
    s_add_u32 m0, s33, 98304
    s_add_u32 s35, s34, 128
    s_waitcnt lgkmcnt(4)
    v_mfma_f32_32x32x16_bf16 v[88:103], v[40:43], v[208:211], v[88:103]
    v_rcp_f32 v28, v28
    v_mul_f32 v26, s36, v82
    v_fma_f32 v29, v25, -0.5, -1.0
    v_cvt_pk_bf16_f32 v35, v78, v79
    ds_read_b64_tr_b16 v[52:53], v6 offset:63488
    ds_read_b64_tr_b16 v[54:55], v6 offset:64000
    ds_write_b128 v13, v[32:35] offset:16384
    buffer_load_dwordx4 v3, s[12:15], s35 offen lds
    s_waitcnt lgkmcnt(5)
    v_mfma_f32_32x32x16_bf16 v[88:103], v[44:47], v[212:215], v[88:103]
    v_exp_f32 v26, v26
    v_fma_f32 v29, v25, v29, -1.0
    v_fmac_f32 v80, v80, v28
    ds_read_b64_tr_b16 v[40:41], v7 offset:0
    ds_read_b64_tr_b16 v[42:43], v7 offset:512
    s_waitcnt lgkmcnt(5)
    v_mfma_f32_32x32x16_bf16 v[88:103], v[48:51], v[216:219], v[88:103]
    s_waitcnt lgkmcnt(3)
    s_waitcnt vmcnt(3)
    s_barrier
    v_mfma_f32_32x32x16_bf16 v[88:103], v[52:55], v[220:223], v[88:103]
    v_rcp_f32 v29, v29
    v_mul_f32 v27, s36, v83
    v_fma_f32 v30, v26, -0.5, -1.0
    ds_read_b64_tr_b16 v[44:45], v7 offset:2048
    ds_read_b64_tr_b16 v[46:47], v7 offset:2560
    ds_read_b64_tr_b16 v[48:49], v7 offset:4096
    ds_read_b64_tr_b16 v[50:51], v7 offset:4608
    buffer_load_dwordx4 v4, s[12:15], s35 offen offset:1024 lds
    s_waitcnt lgkmcnt(4)
    v_mfma_f32_32x32x16_bf16 v[88:103], v[40:43], v[224:227], v[88:103]
    v_exp_f32 v27, v27
    v_fma_f32 v30, v26, v30, -1.0
    v_fmac_f32 v81, v81, v29
    ds_read_b64_tr_b16 v[52:53], v7 offset:6144
    ds_read_b64_tr_b16 v[54:55], v7 offset:6656
    s_waitcnt lgkmcnt(4)
    v_mfma_f32_32x32x16_bf16 v[88:103], v[44:47], v[228:231], v[88:103]
    v_rcp_f32 v30, v30
    v_mul_f32 v24, s36, v84
    v_fma_f32 v31, v27, -0.5, -1.0
    v_cvt_pk_bf16_f32 v36, v80, v81
    ds_read_b64_tr_b16 v[40:41], v7 offset:8192
    ds_read_b64_tr_b16 v[42:43], v7 offset:8704
    s_add_u32 m0, s33, 49152
    s_add_u32 s35, s34, 147584
    s_waitcnt lgkmcnt(4)
    v_mfma_f32_32x32x16_bf16 v[88:103], v[48:51], v[232:235], v[88:103]
    v_exp_f32 v24, v24
    v_fma_f32 v31, v27, v31, -1.0
    v_fmac_f32 v82, v82, v30
    ds_read_b64_tr_b16 v[44:45], v7 offset:10240
    ds_read_b64_tr_b16 v[46:47], v7 offset:10752
    buffer_load_dwordx4 v3, s[12:15], s35 offen lds
    s_waitcnt lgkmcnt(4)
    v_mfma_f32_32x32x16_bf16 v[88:103], v[52:55], v[236:239], v[88:103]
    v_rcp_f32 v31, v31
    v_mul_f32 v25, s36, v85
    v_fma_f32 v28, v24, -0.5, -1.0
    ds_read_b64_tr_b16 v[48:49], v7 offset:12288
    ds_read_b64_tr_b16 v[50:51], v7 offset:12800
    s_waitcnt lgkmcnt(4)
    v_mfma_f32_32x32x16_bf16 v[88:103], v[40:43], v[240:243], v[88:103]
    v_exp_f32 v25, v25
    v_fma_f32 v28, v24, v28, -1.0
    v_fmac_f32 v83, v83, v31
    ds_read_b64_tr_b16 v[52:53], v7 offset:14336
    ds_read_b64_tr_b16 v[54:55], v7 offset:14848
    s_waitcnt lgkmcnt(4)
    v_mfma_f32_32x32x16_bf16 v[88:103], v[44:47], v[244:247], v[88:103]
    v_rcp_f32 v28, v28
    v_mul_f32 v26, s36, v86
    v_fma_f32 v29, v25, -0.5, -1.0
    v_cvt_pk_bf16_f32 v37, v82, v83
    ds_read_b64_tr_b16 v[40:41], v8 offset:0
    ds_read_b64_tr_b16 v[42:43], v8 offset:1024
    buffer_load_dwordx4 v4, s[12:15], s35 offen offset:1024 lds
    s_waitcnt lgkmcnt(4)
    v_mfma_f32_32x32x16_bf16 v[88:103], v[48:51], v[248:251], v[88:103]
    v_exp_f32 v26, v26
    v_fma_f32 v29, v25, v29, -1.0
    v_fmac_f32 v84, v84, v28
    ds_read_b64_tr_b16 v[44:45], v108 offset:0
    ds_read_b64_tr_b16 v[46:47], v108 offset:1024
    s_waitcnt lgkmcnt(4)
    v_mfma_f32_32x32x16_bf16 v[88:103], v[52:55], v[252:255], v[88:103]
    v_rcp_f32 v29, v29
    v_mul_f32 v27, s36, v87
    v_fma_f32 v30, v26, -0.5, -1.0
    ds_read_b64_tr_b16 v[48:49], v8 offset:4096
    ds_read_b64_tr_b16 v[50:51], v8 offset:5120
    s_add_u32 m0, s33, 65536
    s_add_u32 s35, s34, 294912
    s_waitcnt lgkmcnt(4)
    v_mfma_f32_16x16x32_bf16 v[56:59], v[40:43], v[112:115], 0
    ds_read_b64_tr_b16 v[52:53], v108 offset:4096
    v_mfma_f32_16x16x32_bf16 v[60:63], v[40:43], v[116:119], 0
    ds_read_b64_tr_b16 v[54:55], v108 offset:5120
    v_exp_f32 v27, v27
    v_fma_f32 v30, v26, v30, -1.0
    v_fmac_f32 v85, v85, v29
    buffer_load_dwordx4 v3, s[12:15], s35 offen lds
    s_waitcnt lgkmcnt(4)
    v_mfma_f32_16x16x32_bf16 v[64:67], v[44:47], v[112:115], 0
    ds_read_b64_tr_b16 v[40:41], v8 offset:8192
    v_mfma_f32_16x16x32_bf16 v[68:71], v[44:47], v[116:119], 0
    ds_read_b64_tr_b16 v[42:43], v8 offset:9216
    s_waitcnt lgkmcnt(4)
    v_mfma_f32_16x16x32_bf16 v[56:59], v[48:51], v[120:123], v[56:59]
    v_mfma_f32_16x16x32_bf16 v[60:63], v[48:51], v[124:127], v[60:63]
    s_waitcnt lgkmcnt(2)
    s_waitcnt vmcnt(5)
    s_barrier
    v_mfma_f32_16x16x32_bf16 v[64:67], v[52:55], v[120:123], v[64:67]
    ds_read_b64_tr_b16 v[44:45], v108 offset:8192
    v_mfma_f32_16x16x32_bf16 v[68:71], v[52:55], v[124:127], v[68:71]
    ds_read_b64_tr_b16 v[46:47], v108 offset:9216
    v_rcp_f32 v30, v30
    v_mul_f32 v24, s36, v88
    v_fma_f32 v31, v27, -0.5, -1.0
    v_cvt_pk_bf16_f32 v38, v84, v85
    ds_read_b64_tr_b16 v[48:49], v8 offset:12288
    ds_read_b64_tr_b16 v[50:51], v8 offset:13312
    buffer_load_dwordx4 v4, s[12:15], s35 offen offset:1024 lds
    s_waitcnt lgkmcnt(4)
    v_mfma_f32_16x16x32_bf16 v[56:59], v[40:43], v[128:131], v[56:59]
    ds_read_b64_tr_b16 v[52:53], v108 offset:12288
    v_mfma_f32_16x16x32_bf16 v[60:63], v[40:43], v[132:135], v[60:63]
    ds_read_b64_tr_b16 v[54:55], v108 offset:13312
    v_exp_f32 v24, v24
    v_fma_f32 v31, v27, v31, -1.0
    v_fmac_f32 v86, v86, v30
    s_waitcnt lgkmcnt(4)
    v_mfma_f32_16x16x32_bf16 v[64:67], v[44:47], v[128:131], v[64:67]
    ds_read_b64_tr_b16 v[40:41], v8 offset:16384
    v_mfma_f32_16x16x32_bf16 v[68:71], v[44:47], v[132:135], v[68:71]
    ds_read_b64_tr_b16 v[42:43], v8 offset:17408
    v_rcp_f32 v31, v31
    v_mul_f32 v25, s36, v89
    v_fma_f32 v28, v24, -0.5, -1.0
    v_exp_f32 v25, v25
    v_fma_f32 v28, v24, v28, -1.0
    v_fmac_f32 v87, v87, v31
    s_add_u32 m0, s33, 81920
    s_add_u32 s35, s34, 295040
    s_waitcnt lgkmcnt(4)
    v_mfma_f32_16x16x32_bf16 v[56:59], v[48:51], v[136:139], v[56:59]
    ds_read_b64_tr_b16 v[44:45], v108 offset:16384
    v_mfma_f32_16x16x32_bf16 v[60:63], v[48:51], v[140:143], v[60:63]
    ds_read_b64_tr_b16 v[46:47], v108 offset:17408
    v_rcp_f32 v28, v28
    v_mul_f32 v26, s36, v90
    v_fma_f32 v29, v25, -0.5, -1.0
    v_cvt_pk_bf16_f32 v39, v86, v87
    ds_write_b128 v13, v[36:39] offset:17408
    buffer_load_dwordx4 v3, s[12:15], s35 offen lds
    s_waitcnt lgkmcnt(5)
    v_mfma_f32_16x16x32_bf16 v[64:67], v[52:55], v[136:139], v[64:67]
    ds_read_b64_tr_b16 v[48:49], v8 offset:20480
    v_mfma_f32_16x16x32_bf16 v[68:71], v[52:55], v[140:143], v[68:71]
    ds_read_b64_tr_b16 v[50:51], v8 offset:21504
    v_exp_f32 v26, v26
    v_fma_f32 v29, v25, v29, -1.0
    v_fmac_f32 v88, v88, v28
    v_rcp_f32 v29, v29
    v_mul_f32 v27, s36, v91
    v_fma_f32 v30, v26, -0.5, -1.0
    s_waitcnt lgkmcnt(5)
    v_mfma_f32_16x16x32_bf16 v[56:59], v[40:43], v[144:147], v[56:59]
    ds_read_b64_tr_b16 v[52:53], v108 offset:20480
    v_mfma_f32_16x16x32_bf16 v[60:63], v[40:43], v[148:151], v[60:63]
    ds_read_b64_tr_b16 v[54:55], v108 offset:21504
    v_exp_f32 v27, v27
    v_fma_f32 v30, v26, v30, -1.0
    v_fmac_f32 v89, v89, v29
    s_waitcnt lgkmcnt(5)
    v_mfma_f32_16x16x32_bf16 v[64:67], v[44:47], v[144:147], v[64:67]
    ds_read_b64_tr_b16 v[40:41], v8 offset:24576
    v_mfma_f32_16x16x32_bf16 v[68:71], v[44:47], v[148:151], v[68:71]
    ds_read_b64_tr_b16 v[42:43], v8 offset:25600
    v_rcp_f32 v30, v30
    v_mul_f32 v24, s36, v92
    v_fma_f32 v31, v27, -0.5, -1.0
    v_cvt_pk_bf16_f32 v32, v88, v89
    v_exp_f32 v24, v24
    v_fma_f32 v31, v27, v31, -1.0
    v_fmac_f32 v90, v90, v30
    buffer_load_dwordx4 v4, s[12:15], s35 offen offset:1024 lds
    s_waitcnt lgkmcnt(4)
    v_mfma_f32_16x16x32_bf16 v[56:59], v[48:51], v[152:155], v[56:59]
    ds_read_b64_tr_b16 v[44:45], v108 offset:24576
    v_mfma_f32_16x16x32_bf16 v[60:63], v[48:51], v[156:159], v[60:63]
    ds_read_b64_tr_b16 v[46:47], v108 offset:25600
    v_rcp_f32 v31, v31
    v_mul_f32 v25, s36, v93
    v_fma_f32 v28, v24, -0.5, -1.0
    s_waitcnt lgkmcnt(4)
    v_mfma_f32_16x16x32_bf16 v[64:67], v[52:55], v[152:155], v[64:67]
    ds_read_b64_tr_b16 v[48:49], v8 offset:28672
    v_mfma_f32_16x16x32_bf16 v[68:71], v[52:55], v[156:159], v[68:71]
    ds_read_b64_tr_b16 v[50:51], v8 offset:29696
    v_exp_f32 v25, v25
    v_fma_f32 v28, v24, v28, -1.0
    v_fmac_f32 v91, v91, v31
    s_add_u32 m0, s33, 114688
    s_add_u32 s35, s34, 256
    s_waitcnt lgkmcnt(4)
    v_mfma_f32_16x16x32_bf16 v[56:59], v[40:43], v[160:163], v[56:59]
    ds_read_b64_tr_b16 v[52:53], v108 offset:28672
    v_mfma_f32_16x16x32_bf16 v[60:63], v[40:43], v[164:167], v[60:63]
    ds_read_b64_tr_b16 v[54:55], v108 offset:29696
    v_rcp_f32 v28, v28
    v_mul_f32 v26, s36, v94
    v_fma_f32 v29, v25, -0.5, -1.0
    v_cvt_pk_bf16_f32 v33, v90, v91
    v_exp_f32 v26, v26
    v_fma_f32 v29, v25, v29, -1.0
    v_fmac_f32 v92, v92, v28
    buffer_load_dwordx4 v3, s[12:15], s35 offen lds
    s_waitcnt lgkmcnt(4)
    v_mfma_f32_16x16x32_bf16 v[64:67], v[44:47], v[160:163], v[64:67]
    v_mfma_f32_16x16x32_bf16 v[68:71], v[44:47], v[164:167], v[68:71]
    s_waitcnt lgkmcnt(2)
    s_waitcnt vmcnt(5)
    s_barrier
    v_mfma_f32_16x16x32_bf16 v[56:59], v[48:51], v[168:171], v[56:59]
    ds_read_b64_tr_b16 v[40:41], v9 offset:32768
    v_mfma_f32_16x16x32_bf16 v[60:63], v[48:51], v[172:175], v[60:63]
    ds_read_b64_tr_b16 v[42:43], v9 offset:33792
    v_rcp_f32 v29, v29
    v_mul_f32 v27, s36, v95
    v_fma_f32 v30, v26, -0.5, -1.0
    ds_read_b64_tr_b16 v[44:45], v109 offset:32768
    ds_read_b64_tr_b16 v[46:47], v109 offset:33792
    ds_read_b128 v[176:179], v16 offset:16384
    s_waitcnt lgkmcnt(5)
    v_mfma_f32_16x16x32_bf16 v[64:67], v[52:55], v[168:171], v[64:67]
    ds_read_b64_tr_b16 v[48:49], v9 offset:36864
    v_mfma_f32_16x16x32_bf16 v[68:71], v[52:55], v[172:175], v[68:71]
    ds_read_b64_tr_b16 v[50:51], v9 offset:37888
    v_exp_f32 v27, v27
    v_fma_f32 v30, v26, v30, -1.0
    v_fmac_f32 v93, v93, v29
    v_rcp_f32 v30, v30
    v_mul_f32 v24, s36, v96
    v_fma_f32 v31, v27, -0.5, -1.0
    v_cvt_pk_bf16_f32 v34, v92, v93
    ds_read_b128 v[180:183], v16 offset:16640
    s_waitcnt lgkmcnt(6)
    v_mfma_f32_16x16x32_bf16 v[72:75], v[40:43], v[112:115], 0
    ds_read_b64_tr_b16 v[52:53], v109 offset:36864
    v_mfma_f32_16x16x32_bf16 v[76:79], v[40:43], v[116:119], 0
    ds_read_b64_tr_b16 v[54:55], v109 offset:37888
    v_exp_f32 v24, v24
    v_fma_f32 v31, v27, v31, -1.0
    v_fmac_f32 v94, v94, v30
    ds_read_b128 v[184:187], v16 offset:24576
    buffer_load_dwordx4 v4, s[12:15], s35 offen offset:1024 lds
    s_waitcnt lgkmcnt(7)
    v_mfma_f32_16x16x32_bf16 v[80:83], v[44:47], v[112:115], 0
    ds_read_b64_tr_b16 v[40:41], v9 offset:40960
    v_mfma_f32_16x16x32_bf16 v[84:87], v[44:47], v[116:119], 0
    ds_read_b64_tr_b16 v[42:43], v9 offset:41984
    v_rcp_f32 v31, v31
    v_mul_f32 v25, s36, v97
    v_fma_f32 v28, v24, -0.5, -1.0
    v_exp_f32 v25, v25
    v_fma_f32 v28, v24, v28, -1.0
    v_fmac_f32 v95, v95, v31
    ds_read_b128 v[188:191], v16 offset:24832
    s_waitcnt lgkmcnt(7)
    v_mfma_f32_16x16x32_bf16 v[72:75], v[48:51], v[120:123], v[72:75]
    ds_read_b64_tr_b16 v[44:45], v109 offset:40960
    v_mfma_f32_16x16x32_bf16 v[76:79], v[48:51], v[124:127], v[76:79]
    ds_read_b64_tr_b16 v[46:47], v109 offset:41984
    v_rcp_f32 v28, v28
    v_mul_f32 v26, s36, v98
    v_fma_f32 v29, v25, -0.5, -1.0
    v_cvt_pk_bf16_f32 v35, v94, v95
    ds_write_b128 v11, v[32:35] offset:32768
    s_waitcnt lgkmcnt(7)
    v_mfma_f32_16x16x32_bf16 v[80:83], v[52:55], v[120:123], v[80:83]
    ds_read_b64_tr_b16 v[48:49], v9 offset:45056
    v_mfma_f32_16x16x32_bf16 v[84:87], v[52:55], v[124:127], v[84:87]
    ds_read_b64_tr_b16 v[50:51], v9 offset:46080
    v_exp_f32 v26, v26
    v_fma_f32 v29, v25, v29, -1.0
    v_fmac_f32 v96, v96, v28
    v_rcp_f32 v29, v29
    v_mul_f32 v27, s36, v99
    v_fma_f32 v30, v26, -0.5, -1.0
    s_add_u32 m0, s33, 131072
    s_add_u32 s35, s34, 147712
    s_waitcnt lgkmcnt(6)
    v_mfma_f32_16x16x32_bf16 v[72:75], v[40:43], v[128:131], v[72:75]
    ds_read_b64_tr_b16 v[52:53], v109 offset:45056
    v_mfma_f32_16x16x32_bf16 v[76:79], v[40:43], v[132:135], v[76:79]
    ds_read_b64_tr_b16 v[54:55], v109 offset:46080
    v_exp_f32 v27, v27
    v_fma_f32 v30, v26, v30, -1.0
    v_fmac_f32 v97, v97, v29
    buffer_load_dwordx4 v3, s[12:15], s35 offen lds
    s_cmp_eq_u32 s28, 0
    s_cbranch_scc1 L_cntl
L_cntl_r:
    s_waitcnt lgkmcnt(5)
    v_mfma_f32_16x16x32_bf16 v[80:83], v[44:47], v[128:131], v[80:83]
    ds_read_b64_tr_b16 v[40:41], v8 offset:49152
    v_mfma_f32_16x16x32_bf16 v[84:87], v[44:47], v[132:135], v[84:87]
    ds_read_b64_tr_b16 v[42:43], v8 offset:50176
    v_rcp_f32 v30, v30
    v_mul_f32 v24, s36, v100
    v_fma_f32 v31, v27, -0.5, -1.0
    v_cvt_pk_bf16_f32 v36, v96, v97
    s_waitcnt lgkmcnt(4)
    v_mfma_f32_16x16x32_bf16 v[72:75], v[48:51], v[136:139], v[72:75]
    ds_read_b64_tr_b16 v[44:45], v108 offset:49152
    v_mfma_f32_16x16x32_bf16 v[76:79], v[48:51], v[140:143], v[76:79]
    ds_read_b64_tr_b16 v[46:47], v108 offset:50176
    v_exp_f32 v24, v24
    v_fma_f32 v31, v27, v31, -1.0
    v_fmac_f32 v98, v98, v30
    v_rcp_f32 v31, v31
    v_mul_f32 v25, s36, v101
    v_fma_f32 v28, v24, -0.5, -1.0
    s_waitcnt lgkmcnt(4)
    v_mfma_f32_16x16x32_bf16 v[80:83], v[52:55], v[136:139], v[80:83]
    v_mfma_f32_16x16x32_bf16 v[84:87], v[52:55], v[140:143], v[84:87]
    s_waitcnt lgkmcnt(2)
    s_waitcnt vmcnt(5)
    s_barrier
    v_mfma_f32_16x16x32_bf16 v[72:75], v[40:43], v[144:147], v[72:75]
    ds_read_b64_tr_b16 v[48:49], v8 offset:53248
    v_mfma_f32_16x16x32_bf16 v[76:79], v[40:43], v[148:151], v[76:79]
    ds_read_b64_tr_b16 v[50:51], v8 offset:54272
    v_exp_f32 v25, v25
    v_fma_f32 v28, v24, v28, -1.0
    v_fmac_f32 v99, v99, v31
    ds_read_b64_tr_b16 v[52:53], v108 offset:53248
    ds_read_b64_tr_b16 v[54:55], v108 offset:54272
    buffer_load_dwordx4 v4, s[12:15], s35 offen offset:1024 lds
    s_waitcnt lgkmcnt(4)
    v_mfma_f32_16x16x32_bf16 v[80:83], v[44:47], v[144:147], v[80:83]
    ds_read_b64_tr_b16 v[40:41], v8 offset:57344
    v_mfma_f32_16x16x32_bf16 v[84:87], v[44:47], v[148:151], v[84:87]
    ds_read_b64_tr_b16 v[42:43], v8 offset:58368
    v_rcp_f32 v28, v28
    v_mul_f32 v26, s36, v102
    v_fma_f32 v29, v25, -0.5, -1.0
    v_cvt_pk_bf16_f32 v37, v98, v99
    v_exp_f32 v26, v26
    v_fma_f32 v29, v25, v29, -1.0
    v_fmac_f32 v100, v100, v28
    s_waitcnt lgkmcnt(4)
    v_mfma_f32_16x16x32_bf16 v[72:75], v[48:51], v[152:155], v[72:75]
    ds_read_b64_tr_b16 v[44:45], v108 offset:57344
    v_mfma_f32_16x16x32_bf16 v[76:79], v[48:51], v[156:159], v[76:79]
    ds_read_b64_tr_b16 v[46:47], v108 offset:58368
    v_rcp_f32 v29, v29
    v_mul_f32 v27, s36, v103
    v_fma_f32 v30, v26, -0.5, -1.0
    s_waitcnt lgkmcnt(4)
    v_mfma_f32_16x16x32_bf16 v[80:83], v[52:55], v[152:155], v[80:83]
    ds_read_b64_tr_b16 v[48:49], v8 offset:61440
    v_mfma_f32_16x16x32_bf16 v[84:87], v[52:55], v[156:159], v[84:87]
    ds_read_b64_tr_b16 v[50:51], v8 offset:62464
    v_exp_f32 v27, v27
    v_fma_f32 v30, v26, v30, -1.0
    v_fmac_f32 v101, v101, v29
    v_rcp_f32 v30, v30
    v_fma_f32 v31, v27, -0.5, -1.0
    v_cvt_pk_bf16_f32 v38, v100, v101
    s_add_u32 m0, s33, 0
    s_add_u32 s35, s34, 295168
    s_waitcnt lgkmcnt(4)
    v_mfma_f32_16x16x32_bf16 v[72:75], v[40:43], v[160:163], v[72:75]
    ds_read_b64_tr_b16 v[52:53], v108 offset:61440
    v_mfma_f32_16x16x32_bf16 v[76:79], v[40:43], v[164:167], v[76:79]
    ds_read_b64_tr_b16 v[54:55], v108 offset:62464
    v_fma_f32 v31, v27, v31, -1.0
    v_fmac_f32 v102, v102, v30
    buffer_load_dwordx4 v3, s[12:15], s35 offen lds
    s_waitcnt lgkmcnt(4)
    v_mfma_f32_16x16x32_bf16 v[80:83], v[44:47], v[160:163], v[80:83]
    ds_read_b64_tr_b16 v[40:41], v9 offset:0
    v_mfma_f32_16x16x32_bf16 v[84:87], v[44:47], v[164:167], v[84:87]
    ds_read_b64_tr_b16 v[42:43], v9 offset:1024
    v_rcp_f32 v31, v31
    s_nop 0
    v_fmac_f32 v103, v103, v31
    s_waitcnt lgkmcnt(4)
    v_mfma_f32_16x16x32_bf16 v[72:75], v[48:51], v[168:171], v[72:75]
    ds_read_b64_tr_b16 v[44:45], v109 offset:0
    v_mfma_f32_16x16x32_bf16 v[76:79], v[48:51], v[172:175], v[76:79]
    ds_read_b64_tr_b16 v[46:47], v109 offset:1024
    v_cvt_pk_bf16_f32 v39, v102, v103
    ds_write_b128 v11, v[36:39] offset:33792
    s_waitcnt lgkmcnt(5)
    v_mfma_f32_16x16x32_bf16 v[80:83], v[52:55], v[168:171], v[80:83]
    v_mfma_f32_16x16x32_bf16 v[84:87], v[52:55], v[172:175], v[84:87]
    s_waitcnt lgkmcnt(3)
    s_waitcnt vmcnt(5) lgkmcnt(0)
    s_barrier
    v_mfma_f32_16x16x32_bf16 v[56:59], v[40:43], v[176:179], v[56:59]
    ds_read_b64_tr_b16 v[48:49], v9 offset:4096
    v_mfma_f32_16x16x32_bf16 v[60:63], v[40:43], v[180:183], v[60:63]
    ds_read_b64_tr_b16 v[50:51], v9 offset:5120
    ds_read_b64_tr_b16 v[52:53], v109 offset:4096
    ds_read_b64_tr_b16 v[54:55], v109 offset:5120
    ds_read_b128 v[192:195], v14 offset:32768
    ds_read_b128 v[196:199], v14 offset:33024
    buffer_load_dwordx4 v4, s[12:15], s35 offen offset:1024 lds
    v_mfma_f32_16x16x32_bf16 v[64:67], v[44:47], v[176:179], v[64:67]
    ds_read_b64_tr_b16 v[40:41], v9 offset:8192
    v_mfma_f32_16x16x32_bf16 v[68:71], v[44:47], v[180:183], v[68:71]
    ds_read_b64_tr_b16 v[42:43], v9 offset:9216
    ds_read_b128 v[200:203], v14 offset:40960
    ds_read_b128 v[204:207], v14 offset:41216
    s_waitcnt lgkmcnt(8)
    v_mfma_f32_16x16x32_bf16 v[56:59], v[48:51], v[184:187], v[56:59]
    ds_read_b64_tr_b16 v[44:45], v109 offset:8192
    v_mfma_f32_16x16x32_bf16 v[60:63], v[48:51], v[188:191], v[60:63]
    ds_read_b64_tr_b16 v[46:47], v109 offset:9216
    s_waitcnt lgkmcnt(8)
    v_mfma_f32_16x16x32_bf16 v[64:67], v[52:55], v[184:187], v[64:67]
    ds_read_b64_tr_b16 v[48:49], v9 offset:12288
    v_mfma_f32_16x16x32_bf16 v[68:71], v[52:55], v[188:191], v[68:71]
    ds_read_b64_tr_b16 v[50:51], v9 offset:13312
    s_add_u32 m0, s33, 147456
    s_add_u32 s35, s34, 384
    s_waitcnt lgkmcnt(6)
    v_mfma_f32_16x16x32_bf16 v[56:59], v[40:43], v[192:195], v[56:59]
    ds_read_b64_tr_b16 v[52:53], v109 offset:12288
    v_mfma_f32_16x16x32_bf16 v[60:63], v[40:43], v[196:199], v[60:63]
    ds_read_b64_tr_b16 v[54:55], v109 offset:13312
    buffer_load_dwordx4 v3, s[12:15], s35 offen lds
    s_waitcnt lgkmcnt(4)
    v_mfma_f32_16x16x32_bf16 v[64:67], v[44:47], v[192:195], v[64:67]
    ds_read_b64_tr_b16 v[40:41], v9 offset:16384
    v_mfma_f32_16x16x32_bf16 v[68:71], v[44:47], v[196:199], v[68:71]
    ds_read_b64_tr_b16 v[42:43], v9 offset:17408
    s_waitcnt lgkmcnt(4)
    v_mfma_f32_16x16x32_bf16 v[56:59], v[48:51], v[200:203], v[56:59]
    ds_read_b64_tr_b16 v[44:45], v109 offset:16384
    v_mfma_f32_16x16x32_bf16 v[60:63], v[48:51], v[204:207], v[60:63]
    ds_read_b64_tr_b16 v[46:47], v109 offset:17408
    s_waitcnt lgkmcnt(4)
    v_mfma_f32_16x16x32_bf16 v[64:67], v[52:55], v[200:203], v[64:67]
    ds_read_b64_tr_b16 v[48:49], v9 offset:20480
    v_mfma_f32_16x16x32_bf16 v[68:71], v[52:55], v[204:207], v[68:71]
    ds_read_b64_tr_b16 v[50:51], v9 offset:21504
    s_waitcnt lgkmcnt(4)
    v_mfma_f32_16x16x32_bf16 v[72:75], v[40:43], v[176:179], v[72:75]
    ds_read_b64_tr_b16 v[52:53], v109 offset:20480
    v_mfma_f32_16x16x32_bf16 v[76:79], v[40:43], v[180:183], v[76:79]
    ds_read_b64_tr_b16 v[54:55], v109 offset:21504
    buffer_load_dwordx4 v4, s[12:15], s35 offen offset:1024 lds
    s_waitcnt lgkmcnt(4)
    v_mfma_f32_16x16x32_bf16 v[80:83], v[44:47], v[176:179], v[80:83]
    v_mfma_f32_16x16x32_bf16 v[84:87], v[44:47], v[180:183], v[84:87]
    s_waitcnt lgkmcnt(2)
    s_waitcnt vmcnt(4)
    s_cmp_eq_u32 s28, 0
    s_cbranch_scc1 L_cntc
L_cntc_r:
    s_barrier
    v_mfma_f32_16x16x32_bf16 v[72:75], v[48:51], v[184:187], v[72:75]
    ds_read_b64_tr_b16 v[40:41], v9 offset:24576
    v_mfma_f32_16x16x32_bf16 v[76:79], v[48:51], v[188:191], v[76:79]
    ds_read_b64_tr_b16 v[42:43], v9 offset:25600
    v_cvt_pk_bf16_f32 v32, v56, v57
    v_cvt_pk_bf16_f32 v33, v58, v59
    v_cvt_pk_bf16_f32 v34, v60, v61
    v_cvt_pk_bf16_f32 v35, v62, v63
    ds_read_b64_tr_b16 v[44:45], v109 offset:24576
    ds_read_b64_tr_b16 v[46:47], v109 offset:25600
    s_waitcnt lgkmcnt(4)
    v_mfma_f32_16x16x32_bf16 v[80:83], v[52:55], v[184:187], v[80:83]
    ds_read_b64_tr_b16 v[48:49], v9 offset:28672
    v_mfma_f32_16x16x32_bf16 v[84:87], v[52:55], v[188:191], v[84:87]
    ds_read_b64_tr_b16 v[50:51], v9 offset:29696
    v_cvt_pk_bf16_f32 v36, v64, v65
    v_cvt_pk_bf16_f32 v37, v66, v67
    v_cvt_pk_bf16_f32 v38, v68, v69
    v_cvt_pk_bf16_f32 v39, v70, v71
    s_add_u32 m0, s33, 16384
    s_add_u32 s35, s34, 147840
    s_waitcnt lgkmcnt(4)
    v_mfma_f32_16x16x32_bf16 v[72:75], v[40:43], v[192:195], v[72:75]
    ds_read_b64_tr_b16 v[52:53], v109 offset:28672
    v_mfma_f32_16x16x32_bf16 v[76:79], v[40:43], v[196:199], v[76:79]
    ds_read_b64_tr_b16 v[54:55], v109 offset:29696
    s_add_u32 s38, s37, 0
    v_permlane16_swap_b32 v32, v34
    v_permlane16_swap_b32 v33, v35
    v_permlane16_swap_b32 v36, v38
    buffer_load_dwordx4 v3, s[12:15], s35 offen lds
    s_waitcnt lgkmcnt(4)
    v_mfma_f32_16x16x32_bf16 v[80:83], v[44:47], v[192:195], v[80:83]
    ds_read_b64_tr_b16 v[40:41], v9 offset:49152
    v_mfma_f32_16x16x32_bf16 v[84:87], v[44:47], v[196:199], v[84:87]
    ds_read_b64_tr_b16 v[42:43], v9 offset:50176
    v_permlane16_swap_b32 v37, v39
    buffer_store_dwordx4 v[32:35], v20, s[16:19], s38 offen offset:0 sc1
    s_waitcnt lgkmcnt(4)
    v_mfma_f32_16x16x32_bf16 v[72:75], v[48:51], v[200:203], v[72:75]
    ds_read_b64_tr_b16 v[44:45], v109 offset:49152
    v_mfma_f32_16x16x32_bf16 v[76:79], v[48:51], v[204:207], v[76:79]
    ds_read_b64_tr_b16 v[46:47], v109 offset:50176
    s_waitcnt lgkmcnt(4)
    v_mfma_f32_16x16x32_bf16 v[80:83], v[52:55], v[200:203], v[80:83]
    ds_read_b64_tr_b16 v[48:49], v9 offset:53248
    v_mfma_f32_16x16x32_bf16 v[84:87], v[52:55], v[204:207], v[84:87]
    ds_read_b64_tr_b16 v[50:51], v9 offset:54272
    buffer_store_dwordx4 v[36:39], v20, s[16:19], s38 offen offset:1024 sc1
    s_waitcnt lgkmcnt(4)
    v_mfma_f32_16x16x32_bf16 v[208:211], v[40:43], v[112:115], 0
    ds_read_b64_tr_b16 v[52:53], v109 offset:53248
    v_mfma_f32_16x16x32_bf16 v[212:215], v[40:43], v[116:119], 0
    ds_read_b64_tr_b16 v[54:55], v109 offset:54272
    buffer_load_dwordx4 v4, s[12:15], s35 offen offset:1024 lds
    s_waitcnt lgkmcnt(4)
    v_mfma_f32_16x16x32_bf16 v[216:219], v[44:47], v[112:115], 0
    ds_read_b64_tr_b16 v[40:41], v9 offset:57344
    v_mfma_f32_16x16x32_bf16 v[220:223], v[44:47], v[116:119], 0
    ds_read_b64_tr_b16 v[42:43], v9 offset:58368
    s_waitcnt lgkmcnt(4)
    v_mfma_f32_16x16x32_bf16 v[208:211], v[48:51], v[120:123], v[208:211]
    ds_read_b64_tr_b16 v[44:45], v109 offset:57344
    v_mfma_f32_16x16x32_bf16 v[212:215], v[48:51], v[124:127], v[212:215]
    ds_read_b64_tr_b16 v[46:47], v109 offset:58368
    v_cvt_pk_bf16_f32 v32, v72, v73
    v_cvt_pk_bf16_f32 v33, v74, v75
    v_cvt_pk_bf16_f32 v34, v76, v77
    v_cvt_pk_bf16_f32 v35, v78, v79
    s_waitcnt lgkmcnt(4)
    v_mfma_f32_16x16x32_bf16 v[216:219], v[52:55], v[120:123], v[216:219]
    ds_read_b64_tr_b16 v[48:49], v9 offset:61440
    v_mfma_f32_16x16x32_bf16 v[220:223], v[52:55], v[124:127], v[220:223]
    ds_read_b64_tr_b16 v[50:51], v9 offset:62464
    v_cvt_pk_bf16_f32 v36, v80, v81
    v_cvt_pk_bf16_f32 v37, v82, v83
    v_cvt_pk_bf16_f32 v38, v84, v85
    v_cvt_pk_bf16_f32 v39, v86, v87
    s_add_u32 m0, s33, 98304
    s_add_u32 s35, s34, 295296
    s_waitcnt lgkmcnt(4)
    v_mfma_f32_16x16x32_bf16 v[208:211], v[40:43], v[128:131], v[208:211]
    ds_read_b64_tr_b16 v[52:53], v109 offset:61440
    v_mfma_f32_16x16x32_bf16 v[212:215], v[40:43], v[132:135], v[212:215]
    ds_read_b64_tr_b16 v[54:55], v109 offset:62464
    s_add_u32 s38, s37, 2048
    v_permlane16_swap_b32 v32, v34
    v_permlane16_swap_b32 v33, v35
    v_permlane16_swap_b32 v36, v38
    buffer_load_dwordx4 v3, s[12:15], s35 offen lds
    s_waitcnt lgkmcnt(4)
    v_mfma_f32_16x16x32_bf16 v[216:219], v[44:47], v[128:131], v[216:219]
    ds_read_b64_tr_b16 v[40:41], v10 offset:0
    v_mfma_f32_16x16x32_bf16 v[220:223], v[44:47], v[132:135], v[220:223]
    ds_read_b64_tr_b16 v[42:43], v10 offset:1024
    v_permlane16_swap_b32 v37, v39
    buffer_store_dwordx4 v[32:35], v20, s[16:19], s38 offen offset:0 sc1
    s_waitcnt lgkmcnt(4)
    v_mfma_f32_16x16x32_bf16 v[208:211], v[48:51], v[136:139], v[208:211]
    ds_read_b64_tr_b16 v[44:45], v110 offset:0
    v_mfma_f32_16x16x32_bf16 v[212:215], v[48:51], v[140:143], v[212:215]
    ds_read_b64_tr_b16 v[46:47], v110 offset:1024
    s_waitcnt lgkmcnt(4)
    v_mfma_f32_16x16x32_bf16 v[216:219], v[52:55], v[136:139], v[216:219]
    ds_read_b64_tr_b16 v[48:49], v10 offset:4096
    v_mfma_f32_16x16x32_bf16 v[220:223], v[52:55], v[140:143], v[220:223]
    ds_read_b64_tr_b16 v[50:51], v10 offset:5120
    buffer_store_dwordx4 v[36:39], v20, s[16:19], s38 offen offset:1024 sc1
    s_waitcnt lgkmcnt(4)
    v_mfma_f32_16x16x32_bf16 v[208:211], v[40:43], v[144:147], v[208:211]
    ds_read_b64_tr_b16 v[52:53], v110 offset:4096
    v_mfma_f32_16x16x32_bf16 v[212:215], v[40:43], v[148:151], v[212:215]
    ds_read_b64_tr_b16 v[54:55], v110 offset:5120
    buffer_load_dwordx4 v4, s[12:15], s35 offen offset:1024 lds
    s_waitcnt lgkmcnt(4)
    v_mfma_f32_16x16x32_bf16 v[216:219], v[44:47], v[144:147], v[216:219]
    v_mfma_f32_16x16x32_bf16 v[220:223], v[44:47], v[148:151], v[220:223]
    s_waitcnt lgkmcnt(2)
    s_waitcnt vmcnt(8)
    s_barrier
    v_mfma_f32_16x16x32_bf16 v[208:211], v[48:51], v[152:155], v[208:211]
    ds_read_b64_tr_b16 v[40:41], v10 offset:8192
    v_mfma_f32_16x16x32_bf16 v[212:215], v[48:51], v[156:159], v[212:215]
    ds_read_b64_tr_b16 v[42:43], v10 offset:9216
    ds_read_b64_tr_b16 v[44:45], v110 offset:8192
    ds_read_b64_tr_b16 v[46:47], v110 offset:9216
    s_waitcnt lgkmcnt(4)
    v_mfma_f32_16x16x32_bf16 v[216:219], v[52:55], v[152:155], v[216:219]
    ds_read_b64_tr_b16 v[48:49], v10 offset:12288
    v_mfma_f32_16x16x32_bf16 v[220:223], v[52:55], v[156:159], v[220:223]
    ds_read_b64_tr_b16 v[50:51], v10 offset:13312
    s_add_u32 m0, s33, 49152
    s_add_u32 s35, s34, 512
    s_waitcnt lgkmcnt(4)
    v_mfma_f32_16x16x32_bf16 v[208:211], v[40:43], v[160:163], v[208:211]
    ds_read_b64_tr_b16 v[52:53], v110 offset:12288
    v_mfma_f32_16x16x32_bf16 v[212:215], v[40:43], v[164:167], v[212:215]
    ds_read_b64_tr_b16 v[54:55], v110 offset:13312
    buffer_load_dwordx4 v3, s[12:15], s35 offen lds
    s_waitcnt vmcnt(6)
    v_mov_b32 v17, 1
    s_mov_b64 exec, 1
    buffer_atomic_add v17, off, s[16:19], s98 offset:20 sc1
    s_mov_b64 exec, -1
    s_waitcnt lgkmcnt(4)
    v_mfma_f32_16x16x32_bf16 v[216:219], v[44:47], v[160:163], v[216:219]
    ds_read_b64_tr_b16 v[40:41], v8 offset:0
    v_mfma_f32_16x16x32_bf16 v[220:223], v[44:47], v[164:167], v[220:223]
    ds_read_b64_tr_b16 v[42:43], v8 offset:1024
    s_waitcnt lgkmcnt(4)
    v_mfma_f32_16x16x32_bf16 v[208:211], v[48:51], v[168:171], v[208:211]
    ds_read_b64_tr_b16 v[44:45], v108 offset:0
    v_mfma_f32_16x16x32_bf16 v[212:215], v[48:51], v[172:175], v[212:215]
    ds_read_b64_tr_b16 v[46:47], v108 offset:1024
    s_waitcnt lgkmcnt(4)
    v_mfma_f32_16x16x32_bf16 v[216:219], v[52:55], v[168:171], v[216:219]
    ds_read_b64_tr_b16 v[48:49], v8 offset:4096
    v_mfma_f32_16x16x32_bf16 v[220:223], v[52:55], v[172:175], v[220:223]
    ds_read_b64_tr_b16 v[50:51], v8 offset:5120
    s_waitcnt lgkmcnt(4)
    v_mfma_f32_16x16x32_bf16 v[208:211], v[40:43], v[176:179], v[208:211]
    ds_read_b64_tr_b16 v[52:53], v108 offset:4096
    v_mfma_f32_16x16x32_bf16 v[212:215], v[40:43], v[180:183], v[212:215]
    ds_read_b64_tr_b16 v[54:55], v108 offset:5120
    buffer_load_dwordx4 v4, s[12:15], s35 offen offset:1024 lds
    s_waitcnt lgkmcnt(4)
    v_mfma_f32_16x16x32_bf16 v[216:219], v[44:47], v[176:179], v[216:219]
    ds_read_b64_tr_b16 v[40:41], v8 offset:8192
    v_mfma_f32_16x16x32_bf16 v[220:223], v[44:47], v[180:183], v[220:223]
    ds_read_b64_tr_b16 v[42:43], v8 offset:9216
    s_waitcnt lgkmcnt(4)
    v_mfma_f32_16x16x32_bf16 v[208:211], v[48:51], v[184:187], v[208:211]
    ds_read_b64_tr_b16 v[44:45], v108 offset:8192
    v_mfma_f32_16x16x32_bf16 v[212:215], v[48:51], v[188:191], v[212:215]
    ds_read_b64_tr_b16 v[46:47], v108 offset:9216
    s_waitcnt lgkmcnt(4)
    v_mfma_f32_16x16x32_bf16 v[216:219], v[52:55], v[184:187], v[216:219]
    ds_read_b64_tr_b16 v[48:49], v8 offset:12288
    v_mfma_f32_16x16x32_bf16 v[220:223], v[52:55], v[188:191], v[220:223]
    ds_read_b64_tr_b16 v[50:51], v8 offset:13312
    s_add_u32 m0, s33, 65536
    s_add_u32 s35, s34, 147968
    s_waitcnt lgkmcnt(4)
    v_mfma_f32_16x16x32_bf16 v[208:211], v[40:43], v[192:195], v[208:211]
    ds_read_b64_tr_b16 v[52:53], v108 offset:12288
    v_mfma_f32_16x16x32_bf16 v[212:215], v[40:43], v[196:199], v[212:215]
    ds_read_b64_tr_b16 v[54:55], v108 offset:13312
    buffer_load_dwordx4 v3, s[12:15], s35 offen lds
    s_waitcnt vmcnt(5)
    v_mov_b32 v17, 1
    s_mov_b64 exec, 1
    buffer_atomic_add v17, off, s[16:19], s98 offset:24 sc1
    s_mov_b64 exec, -1
    s_waitcnt lgkmcnt(4)
    v_mfma_f32_16x16x32_bf16 v[216:219], v[44:47], v[192:195], v[216:219]
    ds_read_b64_tr_b16 v[40:41], v10 offset:16384
    v_mfma_f32_16x16x32_bf16 v[220:223], v[44:47], v[196:199], v[220:223]
    ds_read_b64_tr_b16 v[42:43], v10 offset:17408
    s_waitcnt lgkmcnt(4)
    v_mfma_f32_16x16x32_bf16 v[208:211], v[48:51], v[200:203], v[208:211]
    ds_read_b64_tr_b16 v[44:45], v110 offset:16384
    v_mfma_f32_16x16x32_bf16 v[212:215], v[48:51], v[204:207], v[212:215]
    ds_read_b64_tr_b16 v[46:47], v110 offset:17408
    s_waitcnt lgkmcnt(4)
    v_mfma_f32_16x16x32_bf16 v[216:219], v[52:55], v[200:203], v[216:219]
    ds_read_b64_tr_b16 v[48:49], v10 offset:20480
    v_mfma_f32_16x16x32_bf16 v[220:223], v[52:55], v[204:207], v[220:223]
    ds_read_b64_tr_b16 v[50:51], v10 offset:21504
    s_waitcnt lgkmcnt(4)
    v_mfma_f32_16x16x32_bf16 v[56:59], v[40:43], v[112:115], 0
    ds_read_b64_tr_b16 v[52:53], v110 offset:20480
    v_mfma_f32_16x16x32_bf16 v[60:63], v[40:43], v[116:119], 0
    ds_read_b64_tr_b16 v[54:55], v110 offset:21504
    buffer_load_dwordx4 v4, s[12:15], s35 offen offset:1024 lds
    s_waitcnt lgkmcnt(4)
    v_mfma_f32_16x16x32_bf16 v[64:67], v[44:47], v[112:115], 0
    v_mfma_f32_16x16x32_bf16 v[68:71], v[44:47], v[116:119], 0
    s_waitcnt lgkmcnt(2)
    s_waitcnt vmcnt(6)
    s_barrier
    v_mfma_f32_16x16x32_bf16 v[56:59], v[48:51], v[120:123], v[56:59]
    ds_read_b64_tr_b16 v[40:41], v10 offset:24576
    v_mfma_f32_16x16x32_bf16 v[60:63], v[48:51], v[124:127], v[60:63]
    ds_read_b64_tr_b16 v[42:43], v10 offset:25600
    v_cvt_pk_bf16_f32 v32, v208, v209
    v_cvt_pk_bf16_f32 v33, v210, v211
    v_cvt_pk_bf16_f32 v34, v212, v213
    v_cvt_pk_bf16_f32 v35, v214, v215
    ds_read_b64_tr_b16 v[44:45], v110 offset:24576
    ds_read_b64_tr_b16 v[46:47], v110 offset:25600
    s_waitcnt lgkmcnt(4)
    v_mfma_f32_16x16x32_bf16 v[64:67], v[52:55], v[120:123], v[64:67]
    ds_read_b64_tr_b16 v[48:49], v10 offset:28672
    v_mfma_f32_16x16x32_bf16 v[68:71], v[52:55], v[124:127], v[68:71]
    ds_read_b64_tr_b16 v[50:51], v10 offset:29696
    v_cvt_pk_bf16_f32 v36, v216, v217
    v_cvt_pk_bf16_f32 v37, v218, v219
    v_cvt_pk_bf16_f32 v38, v220, v221
    v_cvt_pk_bf16_f32 v39, v222, v223
    s_add_u32 m0, s33, 32768
    s_add_u32 s35, s34, 295424
    s_waitcnt lgkmcnt(4)
    v_mfma_f32_16x16x32_bf16 v[56:59], v[40:43], v[128:131], v[56:59]
    ds_read_b64_tr_b16 v[52:53], v110 offset:28672
    v_mfma_f32_16x16x32_bf16 v[60:63], v[40:43], v[132:135], v[60:63]
    ds_read_b64_tr_b16 v[54:55], v110 offset:29696
    s_add_u32 s38, s37, 4096
    v_permlane16_swap_b32 v32, v34
    v_permlane16_swap_b32 v33, v35
    v_permlane16_swap_b32 v36, v38
    buffer_load_dwordx4 v3, s[12:15], s35 offen lds
    s_waitcnt lgkmcnt(4)
    v_mfma_f32_16x16x32_bf16 v[64:67], v[44:47], v[128:131], v[64:67]
    ds_read_b64_tr_b16 v[40:41], v8 offset:16384
    v_mfma_f32_16x16x32_bf16 v[68:71], v[44:47], v[132:135], v[68:71]
    ds_read_b64_tr_b16 v[42:43], v8 offset:17408
    v_permlane16_swap_b32 v37, v39
    buffer_store_dwordx4 v[32:35], v20, s[16:19], s38 offen offset:0 sc1
    s_waitcnt lgkmcnt(4)
    v_mfma_f32_16x16x32_bf16 v[56:59], v[48:51], v[136:139], v[56:59]
    ds_read_b64_tr_b16 v[44:45], v108 offset:16384
    v_mfma_f32_16x16x32_bf16 v[60:63], v[48:51], v[140:143], v[60:63]
    ds_read_b64_tr_b16 v[46:47], v108 offset:17408
    s_waitcnt lgkmcnt(4)
    v_mfma_f32_16x16x32_bf16 v[64:67], v[52:55], v[136:139], v[64:67]
    ds_read_b64_tr_b16 v[48:49], v8 offset:20480
    v_mfma_f32_16x16x32_bf16 v[68:71], v[52:55], v[140:143], v[68:71]
    ds_read_b64_tr_b16 v[50:51], v8 offset:21504
    buffer_store_dwordx4 v[36:39], v20, s[16:19], s38 offen offset:1024 sc1
    s_waitcnt lgkmcnt(4)
    v_mfma_f32_16x16x32_bf16 v[56:59], v[40:43], v[144:147], v[56:59]
    ds_read_b64_tr_b16 v[52:53], v108 offset:20480
    v_mfma_f32_16x16x32_bf16 v[60:63], v[40:43], v[148:151], v[60:63]
    ds_read_b64_tr_b16 v[54:55], v108 offset:21504
    buffer_load_dwordx4 v4, s[12:15], s35 offen offset:1024 lds
    s_waitcnt lgkmcnt(4)
    v_mfma_f32_16x16x32_bf16 v[64:67], v[44:47], v[144:147], v[64:67]
    ds_read_b64_tr_b16 v[40:41], v8 offset:24576
    v_mfma_f32_16x16x32_bf16 v[68:71], v[44:47], v[148:151], v[68:71]
    ds_read_b64_tr_b16 v[42:43], v8 offset:25600
    s_waitcnt lgkmcnt(4)
    v_mfma_f32_16x16x32_bf16 v[56:59], v[48:51], v[152:155], v[56:59]
    ds_read_b64_tr_b16 v[44:45], v108 offset:24576
    v_mfma_f32_16x16x32_bf16 v[60:63], v[48:51], v[156:159], v[60:63]
    ds_read_b64_tr_b16 v[46:47], v108 offset:25600
    s_waitcnt lgkmcnt(4)
    v_mfma_f32_16x16x32_bf16 v[64:67], v[52:55], v[152:155], v[64:67]
    ds_read_b64_tr_b16 v[48:49], v8 offset:28672
    v_mfma_f32_16x16x32_bf16 v[68:71], v[52:55], v[156:159], v[68:71]
    ds_read_b64_tr_b16 v[50:51], v8 offset:29696
    s_add_u32 m0, s33, 81920
    s_add_u32 s35, s34, 640
    s_waitcnt lgkmcnt(4)
    v_mfma_f32_16x16x32_bf16 v[56:59], v[40:43], v[160:163], v[56:59]
    ds_read_b64_tr_b16 v[52:53], v108 offset:28672
    v_mfma_f32_16x16x32_bf16 v[60:63], v[40:43], v[164:167], v[60:63]
    ds_read_b64_tr_b16 v[54:55], v108 offset:29696
    buffer_load_dwordx4 v3, s[12:15], s35 offen lds
    s_waitcnt lgkmcnt(4)
    v_mfma_f32_16x16x32_bf16 v[64:67], v[44:47], v[160:163], v[64:67]
    ds_read_b64_tr_b16 v[40:41], v9 offset:32768
    v_mfma_f32_16x16x32_bf16 v[68:71], v[44:47], v[164:167], v[68:71]
    ds_read_b64_tr_b16 v[42:43], v9 offset:33792
    s_waitcnt lgkmcnt(4)
    v_mfma_f32_16x16x32_bf16 v[56:59], v[48:51], v[168:171], v[56:59]
    ds_read_b64_tr_b16 v[44:45], v109 offset:32768
    v_mfma_f32_16x16x32_bf16 v[60:63], v[48:51], v[172:175], v[60:63]
    ds_read_b64_tr_b16 v[46:47], v109 offset:33792
    s_waitcnt lgkmcnt(4)
    v_mfma_f32_16x16x32_bf16 v[64:67], v[52:55], v[168:171], v[64:67]
    ds_read_b64_tr_b16 v[48:49], v9 offset:36864
    v_mfma_f32_16x16x32_bf16 v[68:71], v[52:55], v[172:175], v[68:71]
    ds_read_b64_tr_b16 v[50:51], v9 offset:37888
    s_waitcnt lgkmcnt(4)
    v_mfma_f32_16x16x32_bf16 v[56:59], v[40:43], v[176:179], v[56:59]
    ds_read_b64_tr_b16 v[52:53], v109 offset:36864
    v_mfma_f32_16x16x32_bf16 v[60:63], v[40:43], v[180:183], v[60:63]
    ds_read_b64_tr_b16 v[54:55], v109 offset:37888
    buffer_load_dwordx4 v4, s[12:15], s35 offen offset:1024 lds
    s_waitcnt lgkmcnt(4)
    v_mfma_f32_16x16x32_bf16 v[64:67], v[44:47], v[176:179], v[64:67]
    v_mfma_f32_16x16x32_bf16 v[68:71], v[44:47], v[180:183], v[68:71]
    s_waitcnt lgkmcnt(2)
    s_waitcnt vmcnt(6)
    s_barrier
    v_mfma_f32_16x16x32_bf16 v[56:59], v[48:51], v[184:187], v[56:59]
    ds_read_b64_tr_b16 v[40:41], v9 offset:40960
    v_mfma_f32_16x16x32_bf16 v[60:63], v[48:51], v[188:191], v[60:63]
    ds_read_b64_tr_b16 v[42:43], v9 offset:41984
    ds_read_b64_tr_b16 v[44:45], v109 offset:40960
    ds_read_b64_tr_b16 v[46:47], v109 offset:41984
    s_waitcnt lgkmcnt(4)
    v_mfma_f32_16x16x32_bf16 v[64:67], v[52:55], v[184:187], v[64:67]
    ds_read_b64_tr_b16 v[48:49], v9 offset:45056
    v_mfma_f32_16x16x32_bf16 v[68:71], v[52:55], v[188:191], v[68:71]
    ds_read_b64_tr_b16 v[50:51], v9 offset:46080
    s_add_u32 m0, s33, 114688
    s_add_u32 s35, s34, 148096
    s_waitcnt lgkmcnt(4)
    v_mfma_f32_16x16x32_bf16 v[56:59], v[40:43], v[192:195], v[56:59]
    ds_read_b64_tr_b16 v[52:53], v109 offset:45056
    v_mfma_f32_16x16x32_bf16 v[60:63], v[40:43], v[196:199], v[60:63]
    ds_read_b64_tr_b16 v[54:55], v109 offset:46080
    buffer_load_dwordx4 v3, s[12:15], s35 offen lds
    s_waitcnt vmcnt(4)
    v_mov_b32 v17, 1
    s_mov_b64 exec, 1
    buffer_atomic_add v17, off, s[16:19], s98 offset:0 sc1
    s_mov_b64 exec, -1
    s_waitcnt lgkmcnt(4)
    v_mfma_f32_16x16x32_bf16 v[64:67], v[44:47], v[192:195], v[64:67]
    ds_read_b64_tr_b16 v[40:41], v8 offset:49152
    v_mfma_f32_16x16x32_bf16 v[68:71], v[44:47], v[196:199], v[68:71]
    ds_read_b64_tr_b16 v[42:43], v8 offset:50176
    s_waitcnt lgkmcnt(4)
    v_mfma_f32_16x16x32_bf16 v[56:59], v[48:51], v[200:203], v[56:59]
    ds_read_b64_tr_b16 v[44:45], v108 offset:49152
    v_mfma_f32_16x16x32_bf16 v[60:63], v[48:51], v[204:207], v[60:63]
    ds_read_b64_tr_b16 v[46:47], v108 offset:50176
    s_waitcnt lgkmcnt(4)
    v_mfma_f32_16x16x32_bf16 v[64:67], v[52:55], v[200:203], v[64:67]
    ds_read_b64_tr_b16 v[48:49], v8 offset:53248
    v_mfma_f32_16x16x32_bf16 v[68:71], v[52:55], v[204:207], v[68:71]
    ds_read_b64_tr_b16 v[50:51], v8 offset:54272
    s_waitcnt lgkmcnt(4)
    v_mfma_f32_16x16x32_bf16 v[72:75], v[40:43], v[112:115], 0
    ds_read_b64_tr_b16 v[52:53], v108 offset:53248
    v_mfma_f32_16x16x32_bf16 v[76:79], v[40:43], v[116:119], 0
    ds_read_b64_tr_b16 v[54:55], v108 offset:54272
    buffer_load_dwordx4 v4, s[12:15], s35 offen offset:1024 lds
    s_waitcnt lgkmcnt(4)
    v_mfma_f32_16x16x32_bf16 v[80:83], v[44:47], v[112:115], 0
    ds_read_b64_tr_b16 v[40:41], v8 offset:57344
    v_mfma_f32_16x16x32_bf16 v[84:87], v[44:47], v[116:119], 0
    ds_read_b64_tr_b16 v[42:43], v8 offset:58368
    s_waitcnt lgkmcnt(4)
    v_mfma_f32_16x16x32_bf16 v[72:75], v[48:51], v[120:123], v[72:75]
    ds_read_b64_tr_b16 v[44:45], v108 offset:57344
    v_mfma_f32_16x16x32_bf16 v[76:79], v[48:51], v[124:127], v[76:79]
    ds_read_b64_tr_b16 v[46:47], v108 offset:58368
    v_cvt_pk_bf16_f32 v32, v56, v57
    v_cvt_pk_bf16_f32 v33, v58, v59
    v_cvt_pk_bf16_f32 v34, v60, v61
    v_cvt_pk_bf16_f32 v35, v62, v63
    s_waitcnt lgkmcnt(4)
    v_mfma_f32_16x16x32_bf16 v[80:83], v[52:55], v[120:123], v[80:83]
    ds_read_b64_tr_b16 v[48:49], v8 offset:61440
    v_mfma_f32_16x16x32_bf16 v[84:87], v[52:55], v[124:127], v[84:87]
    ds_read_b64_tr_b16 v[50:51], v8 offset:62464
    v_cvt_pk_bf16_f32 v36, v64, v65
    v_cvt_pk_bf16_f32 v37, v66, v67
    v_cvt_pk_bf16_f32 v38, v68, v69
    v_cvt_pk_bf16_f32 v39, v70, v71
    s_add_u32 m0, s33, 131072
    s_add_u32 s35, s34, 295552
    s_waitcnt lgkmcnt(4)
    v_mfma_f32_16x16x32_bf16 v[72:75], v[40:43], v[128:131], v[72:75]
    ds_read_b64_tr_b16 v[52:53], v108 offset:61440
    v_mfma_f32_16x16x32_bf16 v[76:79], v[40:43], v[132:135], v[76:79]
    ds_read_b64_tr_b16 v[54:55], v108 offset:62464
    s_add_u32 s38, s37, 6144
    v_permlane16_swap_b32 v32, v34
    v_permlane16_swap_b32 v33, v35
    v_permlane16_swap_b32 v36, v38
    buffer_load_dwordx4 v3, s[12:15], s35 offen lds
    s_waitcnt lgkmcnt(4)
    v_mfma_f32_16x16x32_bf16 v[80:83], v[44:47], v[128:131], v[80:83]
    ds_read_b64_tr_b16 v[40:41], v9 offset:0
    v_mfma_f32_16x16x32_bf16 v[84:87], v[44:47], v[132:135], v[84:87]
    ds_read_b64_tr_b16 v[42:43], v9 offset:1024
    v_permlane16_swap_b32 v37, v39
    buffer_store_dwordx4 v[32:35], v20, s[16:19], s38 offen offset:0 sc1
    s_waitcnt lgkmcnt(4)
    v_mfma_f32_16x16x32_bf16 v[72:75], v[48:51], v[136:139], v[72:75]
    ds_read_b64_tr_b16 v[44:45], v109 offset:0
    v_mfma_f32_16x16x32_bf16 v[76:79], v[48:51], v[140:143], v[76:79]
    ds_read_b64_tr_b16 v[46:47], v109 offset:1024
    s_waitcnt lgkmcnt(4)
    v_mfma_f32_16x16x32_bf16 v[80:83], v[52:55], v[136:139], v[80:83]
    ds_read_b64_tr_b16 v[48:49], v9 offset:4096
    v_mfma_f32_16x16x32_bf16 v[84:87], v[52:55], v[140:143], v[84:87]
    ds_read_b64_tr_b16 v[50:51], v9 offset:5120
    buffer_store_dwordx4 v[36:39], v20, s[16:19], s38 offen offset:1024 sc1
    s_waitcnt lgkmcnt(4)
    v_mfma_f32_16x16x32_bf16 v[72:75], v[40:43], v[144:147], v[72:75]
    ds_read_b64_tr_b16 v[52:53], v109 offset:4096
    v_mfma_f32_16x16x32_bf16 v[76:79], v[40:43], v[148:151], v[76:79]
    ds_read_b64_tr_b16 v[54:55], v109 offset:5120
    buffer_load_dwordx4 v4, s[12:15], s35 offen offset:1024 lds
    s_waitcnt lgkmcnt(4)
    v_mfma_f32_16x16x32_bf16 v[80:83], v[44:47], v[144:147], v[80:83]
    v_mfma_f32_16x16x32_bf16 v[84:87], v[44:47], v[148:151], v[84:87]
    s_waitcnt lgkmcnt(2)
    s_waitcnt vmcnt(7)
    s_barrier
    v_mfma_f32_16x16x32_bf16 v[72:75], v[48:51], v[152:155], v[72:75]
    ds_read_b64_tr_b16 v[40:41], v9 offset:8192
    v_mfma_f32_16x16x32_bf16 v[76:79], v[48:51], v[156:159], v[76:79]
    ds_read_b64_tr_b16 v[42:43], v9 offset:9216
    ds_read_b64_tr_b16 v[44:45], v109 offset:8192
    ds_read_b64_tr_b16 v[46:47], v109 offset:9216
    s_waitcnt lgkmcnt(4)
    v_mfma_f32_16x16x32_bf16 v[80:83], v[52:55], v[152:155], v[80:83]
    ds_read_b64_tr_b16 v[48:49], v9 offset:12288
    v_mfma_f32_16x16x32_bf16 v[84:87], v[52:55], v[156:159], v[84:87]
    ds_read_b64_tr_b16 v[50:51], v9 offset:13312
    s_add_u32 m0, s33, 0
    s_add_u32 s35, s34, 768
    s_waitcnt lgkmcnt(4)
    v_mfma_f32_16x16x32_bf16 v[72:75], v[40:43], v[160:163], v[72:75]
    ds_read_b64_tr_b16 v[52:53], v109 offset:12288
    v_mfma_f32_16x16x32_bf16 v[76:79], v[40:43], v[164:167], v[76:79]
    ds_read_b64_tr_b16 v[54:55], v109 offset:13312
    buffer_load_dwordx4 v3, s[12:15], s35 offen lds
    s_waitcnt lgkmcnt(4)
    v_mfma_f32_16x16x32_bf16 v[80:83], v[44:47], v[160:163], v[80:83]
    ds_read_b64_tr_b16 v[40:41], v8 offset:32768
    v_mfma_f32_16x16x32_bf16 v[84:87], v[44:47], v[164:167], v[84:87]
    ds_read_b64_tr_b16 v[42:43], v8 offset:33792
    s_waitcnt lgkmcnt(4)
    v_mfma_f32_16x16x32_bf16 v[72:75], v[48:51], v[168:171], v[72:75]
    ds_read_b64_tr_b16 v[44:45], v108 offset:32768
    v_mfma_f32_16x16x32_bf16 v[76:79], v[48:51], v[172:175], v[76:79]
    ds_read_b64_tr_b16 v[46:47], v108 offset:33792
    s_waitcnt lgkmcnt(4)
    v_mfma_f32_16x16x32_bf16 v[80:83], v[52:55], v[168:171], v[80:83]
    ds_read_b64_tr_b16 v[48:49], v8 offset:36864
    v_mfma_f32_16x16x32_bf16 v[84:87], v[52:55], v[172:175], v[84:87]
    ds_read_b64_tr_b16 v[50:51], v8 offset:37888
    s_waitcnt lgkmcnt(4)
    v_mfma_f32_16x16x32_bf16 v[72:75], v[40:43], v[176:179], v[72:75]
    ds_read_b64_tr_b16 v[52:53], v108 offset:36864
    v_mfma_f32_16x16x32_bf16 v[76:79], v[40:43], v[180:183], v[76:79]
    ds_read_b64_tr_b16 v[54:55], v108 offset:37888
    buffer_load_dwordx4 v4, s[12:15], s35 offen offset:1024 lds
    s_waitcnt lgkmcnt(4)
    v_mfma_f32_16x16x32_bf16 v[80:83], v[44:47], v[176:179], v[80:83]
    ds_read_b64_tr_b16 v[40:41], v8 offset:40960
    v_mfma_f32_16x16x32_bf16 v[84:87], v[44:47], v[180:183], v[84:87]
    ds_read_b64_tr_b16 v[42:43], v8 offset:41984
    s_waitcnt lgkmcnt(4)
    v_mfma_f32_16x16x32_bf16 v[72:75], v[48:51], v[184:187], v[72:75]
    ds_read_b64_tr_b16 v[44:45], v108 offset:40960
    v_mfma_f32_16x16x32_bf16 v[76:79], v[48:51], v[188:191], v[76:79]
    ds_read_b64_tr_b16 v[46:47], v108 offset:41984
    s_waitcnt lgkmcnt(4)
    v_mfma_f32_16x16x32_bf16 v[80:83], v[52:55], v[184:187], v[80:83]
    ds_read_b64_tr_b16 v[48:49], v8 offset:45056
    v_mfma_f32_16x16x32_bf16 v[84:87], v[52:55], v[188:191], v[84:87]
    ds_read_b64_tr_b16 v[50:51], v8 offset:46080
    s_add_u32 m0, s33, 147456
    s_add_u32 s35, s34, 148224
    s_waitcnt lgkmcnt(4)
    v_mfma_f32_16x16x32_bf16 v[72:75], v[40:43], v[192:195], v[72:75]
    ds_read_b64_tr_b16 v[52:53], v108 offset:45056
    v_mfma_f32_16x16x32_bf16 v[76:79], v[40:43], v[196:199], v[76:79]
    ds_read_b64_tr_b16 v[54:55], v108 offset:46080
    buffer_load_dwordx4 v3, s[12:15], s35 offen lds
    s_waitcnt vmcnt(4)
    v_mov_b32 v17, 1
    s_mov_b64 exec, 1
    buffer_atomic_add v17, off, s[16:19], s98 offset:12 sc1
    s_mov_b64 exec, -1
    s_waitcnt lgkmcnt(4)
    v_mfma_f32_16x16x32_bf16 v[80:83], v[44:47], v[192:195], v[80:83]
    ds_read_b64_tr_b16 v[40:41], v9 offset:16384
    v_mfma_f32_16x16x32_bf16 v[84:87], v[44:47], v[196:199], v[84:87]
    ds_read_b64_tr_b16 v[42:43], v9 offset:17408
    s_waitcnt lgkmcnt(4)
    v_mfma_f32_16x16x32_bf16 v[72:75], v[48:51], v[200:203], v[72:75]
    ds_read_b64_tr_b16 v[44:45], v109 offset:16384
    v_mfma_f32_16x16x32_bf16 v[76:79], v[48:51], v[204:207], v[76:79]
    ds_read_b64_tr_b16 v[46:47], v109 offset:17408
    s_waitcnt lgkmcnt(4)
    v_mfma_f32_16x16x32_bf16 v[80:83], v[52:55], v[200:203], v[80:83]
    ds_read_b64_tr_b16 v[48:49], v9 offset:20480
    v_mfma_f32_16x16x32_bf16 v[84:87], v[52:55], v[204:207], v[84:87]
    ds_read_b64_tr_b16 v[50:51], v9 offset:21504
    s_waitcnt lgkmcnt(4)
    v_mfma_f32_16x16x32_bf16 v[56:59], v[40:43], v[112:115], 0
    ds_read_b64_tr_b16 v[52:53], v109 offset:20480
    v_mfma_f32_16x16x32_bf16 v[60:63], v[40:43], v[116:119], 0
    ds_read_b64_tr_b16 v[54:55], v109 offset:21504
    buffer_load_dwordx4 v4, s[12:15], s35 offen offset:1024 lds
    s_waitcnt lgkmcnt(4)
    v_mfma_f32_16x16x32_bf16 v[64:67], v[44:47], v[112:115], 0
    v_mfma_f32_16x16x32_bf16 v[68:71], v[44:47], v[116:119], 0
    s_waitcnt lgkmcnt(2)
    s_waitcnt vmcnt(5)
    s_barrier
    v_mfma_f32_16x16x32_bf16 v[56:59], v[48:51], v[120:123], v[56:59]
    ds_read_b64_tr_b16 v[40:41], v9 offset:24576
    v_mfma_f32_16x16x32_bf16 v[60:63], v[48:51], v[124:127], v[60:63]
    ds_read_b64_tr_b16 v[42:43], v9 offset:25600
    v_cvt_pk_bf16_f32 v32, v72, v73
    v_cvt_pk_bf16_f32 v33, v74, v75
    v_cvt_pk_bf16_f32 v34, v76, v77
    v_cvt_pk_bf16_f32 v35, v78, v79
    ds_read_b64_tr_b16 v[44:45], v109 offset:24576
    ds_read_b64_tr_b16 v[46:47], v109 offset:25600
    s_waitcnt lgkmcnt(4)
    v_mfma_f32_16x16x32_bf16 v[64:67], v[52:55], v[120:123], v[64:67]
    ds_read_b64_tr_b16 v[48:49], v9 offset:28672
    v_mfma_f32_16x16x32_bf16 v[68:71], v[52:55], v[124:127], v[68:71]
    ds_read_b64_tr_b16 v[50:51], v9 offset:29696
    v_cvt_pk_bf16_f32 v36, v80, v81
    v_cvt_pk_bf16_f32 v37, v82, v83
    v_cvt_pk_bf16_f32 v38, v84, v85
    v_cvt_pk_bf16_f32 v39, v86, v87
    s_add_u32 m0, s33, 16384
    s_add_u32 s35, s34, 295680
    s_waitcnt lgkmcnt(4)
    v_mfma_f32_16x16x32_bf16 v[56:59], v[40:43], v[128:131], v[56:59]
    ds_read_b64_tr_b16 v[52:53], v109 offset:28672
    v_mfma_f32_16x16x32_bf16 v[60:63], v[40:43], v[132:135], v[60:63]
    ds_read_b64_tr_b16 v[54:55], v109 offset:29696
    s_add_u32 s38, s37, 8192
    v_permlane16_swap_b32 v32, v34
    v_permlane16_swap_b32 v33, v35
    v_permlane16_swap_b32 v36, v38
    buffer_load_dwordx4 v3, s[12:15], s35 offen lds
    s_waitcnt lgkmcnt(4)
    v_mfma_f32_16x16x32_bf16 v[64:67], v[44:47], v[128:131], v[64:67]
    ds_read_b64_tr_b16 v[40:41], v9 offset:49152
    v_mfma_f32_16x16x32_bf16 v[68:71], v[44:47], v[132:135], v[68:71]
    ds_read_b64_tr_b16 v[42:43], v9 offset:50176
    v_permlane16_swap_b32 v37, v39
    buffer_store_dwordx4 v[32:35], v20, s[16:19], s38 offen offset:0 sc1
    s_waitcnt lgkmcnt(4)
    v_mfma_f32_16x16x32_bf16 v[56:59], v[48:51], v[136:139], v[56:59]
    ds_read_b64_tr_b16 v[44:45], v109 offset:49152
    v_mfma_f32_16x16x32_bf16 v[60:63], v[48:51], v[140:143], v[60:63]
    ds_read_b64_tr_b16 v[46:47], v109 offset:50176
    s_waitcnt lgkmcnt(4)
    v_mfma_f32_16x16x32_bf16 v[64:67], v[52:55], v[136:139], v[64:67]
    ds_read_b64_tr_b16 v[48:49], v9 offset:53248
    v_mfma_f32_16x16x32_bf16 v[68:71], v[52:55], v[140:143], v[68:71]
    ds_read_b64_tr_b16 v[50:51], v9 offset:54272
    buffer_store_dwordx4 v[36:39], v20, s[16:19], s38 offen offset:1024 sc1
    s_waitcnt lgkmcnt(4)
    v_mfma_f32_16x16x32_bf16 v[56:59], v[40:43], v[144:147], v[56:59]
    ds_read_b64_tr_b16 v[52:53], v109 offset:53248
    v_mfma_f32_16x16x32_bf16 v[60:63], v[40:43], v[148:151], v[60:63]
    ds_read_b64_tr_b16 v[54:55], v109 offset:54272
    buffer_load_dwordx4 v4, s[12:15], s35 offen offset:1024 lds
    s_waitcnt lgkmcnt(4)
    v_mfma_f32_16x16x32_bf16 v[64:67], v[44:47], v[144:147], v[64:67]
    ds_read_b64_tr_b16 v[40:41], v9 offset:57344
    v_mfma_f32_16x16x32_bf16 v[68:71], v[44:47], v[148:151], v[68:71]
    ds_read_b64_tr_b16 v[42:43], v9 offset:58368
    s_waitcnt lgkmcnt(4)
    v_mfma_f32_16x16x32_bf16 v[56:59], v[48:51], v[152:155], v[56:59]
    ds_read_b64_tr_b16 v[44:45], v109 offset:57344
    v_mfma_f32_16x16x32_bf16 v[60:63], v[48:51], v[156:159], v[60:63]
    ds_read_b64_tr_b16 v[46:47], v109 offset:58368
    s_waitcnt lgkmcnt(4)
    v_mfma_f32_16x16x32_bf16 v[64:67], v[52:55], v[152:155], v[64:67]
    ds_read_b64_tr_b16 v[48:49], v9 offset:61440
    v_mfma_f32_16x16x32_bf16 v[68:71], v[52:55], v[156:159], v[68:71]
    ds_read_b64_tr_b16 v[50:51], v9 offset:62464
    s_add_u32 m0, s33, 98304
    s_add_u32 s35, s34, 896
    s_waitcnt lgkmcnt(4)
    v_mfma_f32_16x16x32_bf16 v[56:59], v[40:43], v[160:163], v[56:59]
    ds_read_b64_tr_b16 v[52:53], v109 offset:61440
    v_mfma_f32_16x16x32_bf16 v[60:63], v[40:43], v[164:167], v[60:63]
    ds_read_b64_tr_b16 v[54:55], v109 offset:62464
    buffer_load_dwordx4 v3, s[12:15], s35 offen lds
    s_waitcnt lgkmcnt(4)
    v_mfma_f32_16x16x32_bf16 v[64:67], v[44:47], v[160:163], v[64:67]
    ds_read_b64_tr_b16 v[40:41], v10 offset:0
    v_mfma_f32_16x16x32_bf16 v[68:71], v[44:47], v[164:167], v[68:71]
    ds_read_b64_tr_b16 v[42:43], v10 offset:1024
    s_waitcnt lgkmcnt(4)
    v_mfma_f32_16x16x32_bf16 v[56:59], v[48:51], v[168:171], v[56:59]
    ds_read_b64_tr_b16 v[44:45], v110 offset:0
    v_mfma_f32_16x16x32_bf16 v[60:63], v[48:51], v[172:175], v[60:63]
    ds_read_b64_tr_b16 v[46:47], v110 offset:1024
    s_waitcnt lgkmcnt(4)
    v_mfma_f32_16x16x32_bf16 v[64:67], v[52:55], v[168:171], v[64:67]
    ds_read_b64_tr_b16 v[48:49], v10 offset:4096
    v_mfma_f32_16x16x32_bf16 v[68:71], v[52:55], v[172:175], v[68:71]
    ds_read_b64_tr_b16 v[50:51], v10 offset:5120
    s_waitcnt lgkmcnt(4)
    v_mfma_f32_16x16x32_bf16 v[56:59], v[40:43], v[176:179], v[56:59]
    ds_read_b64_tr_b16 v[52:53], v110 offset:4096
    v_mfma_f32_16x16x32_bf16 v[60:63], v[40:43], v[180:183], v[60:63]
    ds_read_b64_tr_b16 v[54:55], v110 offset:5120
    buffer_load_dwordx4 v4, s[12:15], s35 offen offset:1024 lds
    s_waitcnt lgkmcnt(4)
    v_mfma_f32_16x16x32_bf16 v[64:67], v[44:47], v[176:179], v[64:67]
    v_mfma_f32_16x16x32_bf16 v[68:71], v[44:47], v[180:183], v[68:71]
    s_waitcnt lgkmcnt(2)
    s_waitcnt vmcnt(6)
    s_barrier
    v_mfma_f32_16x16x32_bf16 v[56:59], v[48:51], v[184:187], v[56:59]
    ds_read_b64_tr_b16 v[40:41], v10 offset:8192
    v_mfma_f32_16x16x32_bf16 v[60:63], v[48:51], v[188:191], v[60:63]
    ds_read_b64_tr_b16 v[42:43], v10 offset:9216
    ds_read_b64_tr_b16 v[44:45], v110 offset:8192
    ds_read_b64_tr_b16 v[46:47], v110 offset:9216
    s_waitcnt lgkmcnt(4)
    v_mfma_f32_16x16x32_bf16 v[64:67], v[52:55], v[184:187], v[64:67]
    ds_read_b64_tr_b16 v[48:49], v10 offset:12288
    v_mfma_f32_16x16x32_bf16 v[68:71], v[52:55], v[188:191], v[68:71]
    ds_read_b64_tr_b16 v[50:51], v10 offset:13312
    s_add_u32 m0, s33, 49152
    s_add_u32 s35, s34, 148352
    s_waitcnt lgkmcnt(4)
    v_mfma_f32_16x16x32_bf16 v[56:59], v[40:43], v[192:195], v[56:59]
    ds_read_b64_tr_b16 v[52:53], v110 offset:12288
    v_mfma_f32_16x16x32_bf16 v[60:63], v[40:43], v[196:199], v[60:63]
    ds_read_b64_tr_b16 v[54:55], v110 offset:13312
    buffer_load_dwordx4 v3, s[12:15], s35 offen lds
    s_waitcnt vmcnt(4)
    v_mov_b32 v17, 1
    s_mov_b64 exec, 1
    buffer_atomic_add v17, off, s[16:19], s98 offset:16 sc1
    s_mov_b64 exec, -1
    s_waitcnt lgkmcnt(4)
    v_mfma_f32_16x16x32_bf16 v[64:67], v[44:47], v[192:195], v[64:67]
    ds_read_b64_tr_b16 v[40:41], v8 offset:0
    v_mfma_f32_16x16x32_bf16 v[68:71], v[44:47], v[196:199], v[68:71]
    ds_read_b64_tr_b16 v[42:43], v8 offset:1024
    s_waitcnt lgkmcnt(4)
    v_mfma_f32_16x16x32_bf16 v[56:59], v[48:51], v[200:203], v[56:59]
    ds_read_b64_tr_b16 v[44:45], v108 offset:0
    v_mfma_f32_16x16x32_bf16 v[60:63], v[48:51], v[204:207], v[60:63]
    ds_read_b64_tr_b16 v[46:47], v108 offset:1024
    s_waitcnt lgkmcnt(4)
    v_mfma_f32_16x16x32_bf16 v[64:67], v[52:55], v[200:203], v[64:67]
    ds_read_b64_tr_b16 v[48:49], v8 offset:4096
    v_mfma_f32_16x16x32_bf16 v[68:71], v[52:55], v[204:207], v[68:71]
    ds_read_b64_tr_b16 v[50:51], v8 offset:5120
    s_waitcnt lgkmcnt(4)
    v_mfma_f32_16x16x32_bf16 v[72:75], v[40:43], v[112:115], 0
    ds_read_b64_tr_b16 v[52:53], v108 offset:4096
    v_mfma_f32_16x16x32_bf16 v[76:79], v[40:43], v[116:119], 0
    ds_read_b64_tr_b16 v[54:55], v108 offset:5120
    buffer_load_dwordx4 v4, s[12:15], s35 offen offset:1024 lds
    s_waitcnt lgkmcnt(4)
    v_mfma_f32_16x16x32_bf16 v[80:83], v[44:47], v[112:115], 0
    ds_read_b64_tr_b16 v[40:41], v8 offset:8192
    v_mfma_f32_16x16x32_bf16 v[84:87], v[44:47], v[116:119], 0
    ds_read_b64_tr_b16 v[42:43], v8 offset:9216
    s_waitcnt lgkmcnt(4)
    v_mfma_f32_16x16x32_bf16 v[72:75], v[48:51], v[120:123], v[72:75]
    ds_read_b64_tr_b16 v[44:45], v108 offset:8192
    v_mfma_f32_16x16x32_bf16 v[76:79], v[48:51], v[124:127], v[76:79]
    ds_read_b64_tr_b16 v[46:47], v108 offset:9216
    v_cvt_pk_bf16_f32 v32, v56, v57
    v_cvt_pk_bf16_f32 v33, v58, v59
    v_cvt_pk_bf16_f32 v34, v60, v61
    v_cvt_pk_bf16_f32 v35, v62, v63
    s_waitcnt lgkmcnt(4)
    v_mfma_f32_16x16x32_bf16 v[80:83], v[52:55], v[120:123], v[80:83]
    ds_read_b64_tr_b16 v[48:49], v8 offset:12288
    v_mfma_f32_16x16x32_bf16 v[84:87], v[52:55], v[124:127], v[84:87]
    ds_read_b64_tr_b16 v[50:51], v8 offset:13312
    v_cvt_pk_bf16_f32 v36, v64, v65
    v_cvt_pk_bf16_f32 v37, v66, v67
    v_cvt_pk_bf16_f32 v38, v68, v69
    v_cvt_pk_bf16_f32 v39, v70, v71
    s_add_u32 m0, s33, 65536
    s_add_u32 s35, s34, 295808
    s_waitcnt lgkmcnt(4)
    v_mfma_f32_16x16x32_bf16 v[72:75], v[40:43], v[128:131], v[72:75]
    ds_read_b64_tr_b16 v[52:53], v108 offset:12288
    v_mfma_f32_16x16x32_bf16 v[76:79], v[40:43], v[132:135], v[76:79]
    ds_read_b64_tr_b16 v[54:55], v108 offset:13312
    s_add_u32 s38, s37, 10240
    v_permlane16_swap_b32 v32, v34
    v_permlane16_swap_b32 v33, v35
    v_permlane16_swap_b32 v36, v38
    buffer_load_dwordx4 v3, s[12:15], s35 offen lds
    s_waitcnt lgkmcnt(4)
    v_mfma_f32_16x16x32_bf16 v[80:83], v[44:47], v[128:131], v[80:83]
    ds_read_b64_tr_b16 v[40:41], v10 offset:16384
    v_mfma_f32_16x16x32_bf16 v[84:87], v[44:47], v[132:135], v[84:87]
    ds_read_b64_tr_b16 v[42:43], v10 offset:17408
    v_permlane16_swap_b32 v37, v39
    buffer_store_dwordx4 v[32:35], v20, s[16:19], s38 offen offset:0 sc1
    s_waitcnt lgkmcnt(4)
    v_mfma_f32_16x16x32_bf16 v[72:75], v[48:51], v[136:139], v[72:75]
    ds_read_b64_tr_b16 v[44:45], v110 offset:16384
    v_mfma_f32_16x16x32_bf16 v[76:79], v[48:51], v[140:143], v[76:79]
    ds_read_b64_tr_b16 v[46:47], v110 offset:17408
    s_waitcnt lgkmcnt(4)
    v_mfma_f32_16x16x32_bf16 v[80:83], v[52:55], v[136:139], v[80:83]
    ds_read_b64_tr_b16 v[48:49], v10 offset:20480
    v_mfma_f32_16x16x32_bf16 v[84:87], v[52:55], v[140:143], v[84:87]
    ds_read_b64_tr_b16 v[50:51], v10 offset:21504
    buffer_store_dwordx4 v[36:39], v20, s[16:19], s38 offen offset:1024 sc1
    s_waitcnt lgkmcnt(4)
    v_mfma_f32_16x16x32_bf16 v[72:75], v[40:43], v[144:147], v[72:75]
    ds_read_b64_tr_b16 v[52:53], v110 offset:20480
    v_mfma_f32_16x16x32_bf16 v[76:79], v[40:43], v[148:151], v[76:79]
    ds_read_b64_tr_b16 v[54:55], v110 offset:21504
    buffer_load_dwordx4 v4, s[12:15], s35 offen offset:1024 lds
    s_waitcnt lgkmcnt(4)
    v_mfma_f32_16x16x32_bf16 v[80:83], v[44:47], v[144:147], v[80:83]
    v_mfma_f32_16x16x32_bf16 v[84:87], v[44:47], v[148:151], v[84:87]
    s_waitcnt lgkmcnt(2)
    s_waitcnt vmcnt(7)
    s_barrier
    v_mfma_f32_16x16x32_bf16 v[72:75], v[48:51], v[152:155], v[72:75]
    ds_read_b64_tr_b16 v[40:41], v10 offset:24576
    v_mfma_f32_16x16x32_bf16 v[76:79], v[48:51], v[156:159], v[76:79]
    ds_read_b64_tr_b16 v[42:43], v10 offset:25600
    ds_read_b64_tr_b16 v[44:45], v110 offset:24576
    ds_read_b64_tr_b16 v[46:47], v110 offset:25600
    s_waitcnt lgkmcnt(4)
    v_mfma_f32_16x16x32_bf16 v[80:83], v[52:55], v[152:155], v[80:83]
    ds_read_b64_tr_b16 v[48:49], v10 offset:28672
    v_mfma_f32_16x16x32_bf16 v[84:87], v[52:55], v[156:159], v[84:87]
    ds_read_b64_tr_b16 v[50:51], v10 offset:29696
    s_add_u32 m0, s33, 32768
    s_add_u32 s35, s34, 1024
    s_waitcnt lgkmcnt(4)
    v_mfma_f32_16x16x32_bf16 v[72:75], v[40:43], v[160:163], v[72:75]
    ds_read_b64_tr_b16 v[52:53], v110 offset:28672
    v_mfma_f32_16x16x32_bf16 v[76:79], v[40:43], v[164:167], v[76:79]
    ds_read_b64_tr_b16 v[54:55], v110 offset:29696
    buffer_load_dwordx4 v3, s[12:15], s35 offen lds
    s_waitcnt lgkmcnt(4)
    v_mfma_f32_16x16x32_bf16 v[80:83], v[44:47], v[160:163], v[80:83]
    ds_read_b64_tr_b16 v[40:41], v8 offset:16384
    v_mfma_f32_16x16x32_bf16 v[84:87], v[44:47], v[164:167], v[84:87]
    ds_read_b64_tr_b16 v[42:43], v8 offset:17408
    s_waitcnt lgkmcnt(4)
    v_mfma_f32_16x16x32_bf16 v[72:75], v[48:51], v[168:171], v[72:75]
    ds_read_b64_tr_b16 v[44:45], v108 offset:16384
    v_mfma_f32_16x16x32_bf16 v[76:79], v[48:51], v[172:175], v[76:79]
    ds_read_b64_tr_b16 v[46:47], v108 offset:17408
    s_waitcnt lgkmcnt(4)
    v_mfma_f32_16x16x32_bf16 v[80:83], v[52:55], v[168:171], v[80:83]
    ds_read_b64_tr_b16 v[48:49], v8 offset:20480
    v_mfma_f32_16x16x32_bf16 v[84:87], v[52:55], v[172:175], v[84:87]
    ds_read_b64_tr_b16 v[50:51], v8 offset:21504
    s_waitcnt lgkmcnt(4)
    v_mfma_f32_16x16x32_bf16 v[72:75], v[40:43], v[176:179], v[72:75]
    ds_read_b64_tr_b16 v[52:53], v108 offset:20480
    v_mfma_f32_16x16x32_bf16 v[76:79], v[40:43], v[180:183], v[76:79]
    ds_read_b64_tr_b16 v[54:55], v108 offset:21504
    buffer_load_dwordx4 v4, s[12:15], s35 offen offset:1024 lds
    s_waitcnt lgkmcnt(4)
    v_mfma_f32_16x16x32_bf16 v[80:83], v[44:47], v[176:179], v[80:83]
    ds_read_b64_tr_b16 v[40:41], v8 offset:24576
    v_mfma_f32_16x16x32_bf16 v[84:87], v[44:47], v[180:183], v[84:87]
    ds_read_b64_tr_b16 v[42:43], v8 offset:25600
    s_waitcnt lgkmcnt(4)
    v_mfma_f32_16x16x32_bf16 v[72:75], v[48:51], v[184:187], v[72:75]
    ds_read_b64_tr_b16 v[44:45], v108 offset:24576
    v_mfma_f32_16x16x32_bf16 v[76:79], v[48:51], v[188:191], v[76:79]
    ds_read_b64_tr_b16 v[46:47], v108 offset:25600
    s_waitcnt lgkmcnt(4)
    v_mfma_f32_16x16x32_bf16 v[80:83], v[52:55], v[184:187], v[80:83]
    ds_read_b64_tr_b16 v[48:49], v8 offset:28672
    v_mfma_f32_16x16x32_bf16 v[84:87], v[52:55], v[188:191], v[84:87]
    ds_read_b64_tr_b16 v[50:51], v8 offset:29696
    s_add_u32 m0, s33, 81920
    s_add_u32 s35, s34, 148480
    s_waitcnt lgkmcnt(4)
    v_mfma_f32_16x16x32_bf16 v[72:75], v[40:43], v[192:195], v[72:75]
    ds_read_b64_tr_b16 v[52:53], v108 offset:28672
    v_mfma_f32_16x16x32_bf16 v[76:79], v[40:43], v[196:199], v[76:79]
    ds_read_b64_tr_b16 v[54:55], v108 offset:29696
    buffer_load_dwordx4 v3, s[12:15], s35 offen lds
    s_waitcnt vmcnt(4)
    v_mov_b32 v17, 1
    s_mov_b64 exec, 1
    buffer_atomic_add v17, off, s[16:19], s98 offset:4 sc1
    s_mov_b64 exec, -1
    s_waitcnt lgkmcnt(4)
    v_mfma_f32_16x16x32_bf16 v[80:83], v[44:47], v[192:195], v[80:83]
    ds_read_b64_tr_b16 v[40:41], v9 offset:32768
    v_mfma_f32_16x16x32_bf16 v[84:87], v[44:47], v[196:199], v[84:87]
    ds_read_b64_tr_b16 v[42:43], v9 offset:33792
    s_waitcnt lgkmcnt(4)
    v_mfma_f32_16x16x32_bf16 v[72:75], v[48:51], v[200:203], v[72:75]
    ds_read_b64_tr_b16 v[44:45], v109 offset:32768
    v_mfma_f32_16x16x32_bf16 v[76:79], v[48:51], v[204:207], v[76:79]
    ds_read_b64_tr_b16 v[46:47], v109 offset:33792
    s_waitcnt lgkmcnt(4)
    v_mfma_f32_16x16x32_bf16 v[80:83], v[52:55], v[200:203], v[80:83]
    ds_read_b64_tr_b16 v[48:49], v9 offset:36864
    v_mfma_f32_16x16x32_bf16 v[84:87], v[52:55], v[204:207], v[84:87]
    ds_read_b64_tr_b16 v[50:51], v9 offset:37888
    s_waitcnt lgkmcnt(4)
    v_mfma_f32_16x16x32_bf16 v[56:59], v[40:43], v[112:115], 0
    ds_read_b64_tr_b16 v[52:53], v109 offset:36864
    v_mfma_f32_16x16x32_bf16 v[60:63], v[40:43], v[116:119], 0
    ds_read_b64_tr_b16 v[54:55], v109 offset:37888
    buffer_load_dwordx4 v4, s[12:15], s35 offen offset:1024 lds
    s_waitcnt lgkmcnt(4)
    v_mfma_f32_16x16x32_bf16 v[64:67], v[44:47], v[112:115], 0
    v_mfma_f32_16x16x32_bf16 v[68:71], v[44:47], v[116:119], 0
    s_waitcnt lgkmcnt(2)
    s_waitcnt vmcnt(5)
    s_barrier
    v_mfma_f32_16x16x32_bf16 v[56:59], v[48:51], v[120:123], v[56:59]
    ds_read_b64_tr_b16 v[40:41], v9 offset:40960
    v_mfma_f32_16x16x32_bf16 v[60:63], v[48:51], v[124:127], v[60:63]
    ds_read_b64_tr_b16 v[42:43], v9 offset:41984
    v_cvt_pk_bf16_f32 v32, v72, v73
    v_cvt_pk_bf16_f32 v33, v74, v75
    v_cvt_pk_bf16_f32 v34, v76, v77
    v_cvt_pk_bf16_f32 v35, v78, v79
    ds_read_b64_tr_b16 v[44:45], v109 offset:40960
    ds_read_b64_tr_b16 v[46:47], v109 offset:41984
    s_cmp_eq_u32 s28, 0
    s_cbranch_scc1 L_othl
L_othl_r:
    s_waitcnt lgkmcnt(4)
    v_mfma_f32_16x16x32_bf16 v[64:67], v[52:55], v[120:123], v[64:67]
    ds_read_b64_tr_b16 v[48:49], v9 offset:45056
    v_mfma_f32_16x16x32_bf16 v[68:71], v[52:55], v[124:127], v[68:71]
    ds_read_b64_tr_b16 v[50:51], v9 offset:46080
    v_cvt_pk_bf16_f32 v36, v80, v81
    v_cvt_pk_bf16_f32 v37, v82, v83
    v_cvt_pk_bf16_f32 v38, v84, v85
    v_cvt_pk_bf16_f32 v39, v86, v87
    s_add_u32 m0, s33, 114688
    s_add_u32 s35, s34, 295936
    s_waitcnt lgkmcnt(4)
    v_mfma_f32_16x16x32_bf16 v[56:59], v[40:43], v[128:131], v[56:59]
    ds_read_b64_tr_b16 v[52:53], v109 offset:45056
    v_mfma_f32_16x16x32_bf16 v[60:63], v[40:43], v[132:135], v[60:63]
    ds_read_b64_tr_b16 v[54:55], v109 offset:46080
    s_add_u32 s38, s37, 12288
    v_permlane16_swap_b32 v32, v34
    v_permlane16_swap_b32 v33, v35
    v_permlane16_swap_b32 v36, v38
    buffer_load_dwordx4 v3, s[12:15], s35 offen lds
    s_waitcnt lgkmcnt(4)
    v_mfma_f32_16x16x32_bf16 v[64:67], v[44:47], v[128:131], v[64:67]
    ds_read_b64_tr_b16 v[40:41], v8 offset:49152
    v_mfma_f32_16x16x32_bf16 v[68:71], v[44:47], v[132:135], v[68:71]
    ds_read_b64_tr_b16 v[42:43], v8 offset:50176
    v_permlane16_swap_b32 v37, v39
    buffer_store_dwordx4 v[32:35], v20, s[16:19], s38 offen offset:0 sc1
    s_waitcnt lgkmcnt(4)
    v_mfma_f32_16x16x32_bf16 v[56:59], v[48:51], v[136:139], v[56:59]
    ds_read_b64_tr_b16 v[44:45], v108 offset:49152
    v_mfma_f32_16x16x32_bf16 v[60:63], v[48:51], v[140:143], v[60:63]
    ds_read_b64_tr_b16 v[46:47], v108 offset:50176
    s_waitcnt lgkmcnt(4)
    v_mfma_f32_16x16x32_bf16 v[64:67], v[52:55], v[136:139], v[64:67]
    ds_read_b64_tr_b16 v[48:49], v8 offset:53248
    v_mfma_f32_16x16x32_bf16 v[68:71], v[52:55], v[140:143], v[68:71]
    ds_read_b64_tr_b16 v[50:51], v8 offset:54272
    buffer_store_dwordx4 v[36:39], v20, s[16:19], s38 offen offset:1024 sc1
    s_waitcnt lgkmcnt(4)
    v_mfma_f32_16x16x32_bf16 v[56:59], v[40:43], v[144:147], v[56:59]
    ds_read_b64_tr_b16 v[52:53], v108 offset:53248
    v_mfma_f32_16x16x32_bf16 v[60:63], v[40:43], v[148:151], v[60:63]
    ds_read_b64_tr_b16 v[54:55], v108 offset:54272
    buffer_load_dwordx4 v4, s[12:15], s35 offen offset:1024 lds
    s_waitcnt lgkmcnt(4)
    v_mfma_f32_16x16x32_bf16 v[64:67], v[44:47], v[144:147], v[64:67]
    ds_read_b64_tr_b16 v[40:41], v8 offset:57344
    v_mfma_f32_16x16x32_bf16 v[68:71], v[44:47], v[148:151], v[68:71]
    ds_read_b64_tr_b16 v[42:43], v8 offset:58368
    s_waitcnt lgkmcnt(4)
    v_mfma_f32_16x16x32_bf16 v[56:59], v[48:51], v[152:155], v[56:59]
    ds_read_b64_tr_b16 v[44:45], v108 offset:57344
    v_mfma_f32_16x16x32_bf16 v[60:63], v[48:51], v[156:159], v[60:63]
    ds_read_b64_tr_b16 v[46:47], v108 offset:58368
    s_waitcnt lgkmcnt(4)
    v_mfma_f32_16x16x32_bf16 v[64:67], v[52:55], v[152:155], v[64:67]
    ds_read_b64_tr_b16 v[48:49], v8 offset:61440
    v_mfma_f32_16x16x32_bf16 v[68:71], v[52:55], v[156:159], v[68:71]
    ds_read_b64_tr_b16 v[50:51], v8 offset:62464
    s_waitcnt lgkmcnt(4)
    v_mfma_f32_16x16x32_bf16 v[56:59], v[40:43], v[160:163], v[56:59]
    ds_read_b64_tr_b16 v[52:53], v108 offset:61440
    v_mfma_f32_16x16x32_bf16 v[60:63], v[40:43], v[164:167], v[60:63]
    ds_read_b64_tr_b16 v[54:55], v108 offset:62464
    s_waitcnt lgkmcnt(4)
    v_mfma_f32_16x16x32_bf16 v[64:67], v[44:47], v[160:163], v[64:67]
    ds_read_b64_tr_b16 v[40:41], v9 offset:0
    v_mfma_f32_16x16x32_bf16 v[68:71], v[44:47], v[164:167], v[68:71]
    ds_read_b64_tr_b16 v[42:43], v9 offset:1024
    s_waitcnt lgkmcnt(4)
    v_mfma_f32_16x16x32_bf16 v[56:59], v[48:51], v[168:171], v[56:59]
    ds_read_b64_tr_b16 v[44:45], v109 offset:0
    v_mfma_f32_16x16x32_bf16 v[60:63], v[48:51], v[172:175], v[60:63]
    ds_read_b64_tr_b16 v[46:47], v109 offset:1024
    s_waitcnt lgkmcnt(4)
    v_mfma_f32_16x16x32_bf16 v[64:67], v[52:55], v[168:171], v[64:67]
    ds_read_b64_tr_b16 v[48:49], v9 offset:4096
    v_mfma_f32_16x16x32_bf16 v[68:71], v[52:55], v[172:175], v[68:71]
    ds_read_b64_tr_b16 v[50:51], v9 offset:5120
    s_waitcnt lgkmcnt(4)
    v_mfma_f32_16x16x32_bf16 v[56:59], v[40:43], v[176:179], v[56:59]
    ds_read_b64_tr_b16 v[52:53], v109 offset:4096
    v_mfma_f32_16x16x32_bf16 v[60:63], v[40:43], v[180:183], v[60:63]
    ds_read_b64_tr_b16 v[54:55], v109 offset:5120
    s_waitcnt lgkmcnt(4)
    v_mfma_f32_16x16x32_bf16 v[64:67], v[44:47], v[176:179], v[64:67]
    v_mfma_f32_16x16x32_bf16 v[68:71], v[44:47], v[180:183], v[68:71]
    s_waitcnt lgkmcnt(2)
    s_waitcnt vmcnt(4)
    s_cmp_eq_u32 s28, 0
    s_cbranch_scc1 L_othc
L_othc_r:
    s_barrier
    v_mfma_f32_16x16x32_bf16 v[56:59], v[48:51], v[184:187], v[56:59]
    ds_read_b64_tr_b16 v[40:41], v9 offset:8192
    v_mfma_f32_16x16x32_bf16 v[60:63], v[48:51], v[188:191], v[60:63]
    ds_read_b64_tr_b16 v[42:43], v9 offset:9216
    ds_read_b64_tr_b16 v[44:45], v109 offset:8192
    ds_read_b64_tr_b16 v[46:47], v109 offset:9216
    s_lshl_b32 s42, s74, 12
    s_lshl_b32 s3, s76, 1
    s_add_u32 s42, s42, s3
    s_add_u32 m0, s33, 131072
    s_add_u32 s42, s42, 28311552
    s_mov_b32 exec_hi, 0
    s_add_u32 s42, s42, 1571840
    buffer_load_dwordx4 v106, s[16:19], s42 offen offset:1024 sc1 lds
    s_mov_b32 exec_hi, -1
    s_waitcnt lgkmcnt(4)
    v_mfma_f32_16x16x32_bf16 v[64:67], v[52:55], v[184:187], v[64:67]
    ds_read_b64_tr_b16 v[48:49], v9 offset:12288
    v_mfma_f32_16x16x32_bf16 v[68:71], v[52:55], v[188:191], v[68:71]
    ds_read_b64_tr_b16 v[50:51], v9 offset:13312
    s_waitcnt lgkmcnt(4)
    v_mfma_f32_16x16x32_bf16 v[56:59], v[40:43], v[192:195], v[56:59]
    ds_read_b64_tr_b16 v[52:53], v109 offset:12288
    v_mfma_f32_16x16x32_bf16 v[60:63], v[40:43], v[196:199], v[60:63]
    ds_read_b64_tr_b16 v[54:55], v109 offset:13312
    s_waitcnt lgkmcnt(4)
    v_mfma_f32_16x16x32_bf16 v[64:67], v[44:47], v[192:195], v[64:67]
    ds_read_b64_tr_b16 v[40:41], v8 offset:32768
    v_mfma_f32_16x16x32_bf16 v[68:71], v[44:47], v[196:199], v[68:71]
    ds_read_b64_tr_b16 v[42:43], v8 offset:33792
    s_lshl_b32 s3, s76, 3
    s_add_u32 s3, s3, 30670848
    buffer_load_dwordx2 v[104:105], v104, s[16:19], s3 offen sc1
    v_add_u32 v19, 131072, v19
    s_waitcnt lgkmcnt(4)
    v_mfma_f32_16x16x32_bf16 v[56:59], v[48:51], v[200:203], v[56:59]
    ds_read_b64_tr_b16 v[44:45], v108 offset:32768
    v_mfma_f32_16x16x32_bf16 v[60:63], v[48:51], v[204:207], v[60:63]
    ds_read_b64_tr_b16 v[46:47], v108 offset:33792
    s_waitcnt lgkmcnt(4)
    v_mfma_f32_16x16x32_bf16 v[64:67], v[52:55], v[200:203], v[64:67]
    ds_read_b64_tr_b16 v[48:49], v8 offset:36864
    v_mfma_f32_16x16x32_bf16 v[68:71], v[52:55], v[204:207], v[68:71]
    ds_read_b64_tr_b16 v[50:51], v8 offset:37888
    s_waitcnt lgkmcnt(4)
    v_mfma_f32_16x16x32_bf16 v[72:75], v[40:43], v[112:115], 0
    ds_read_b64_tr_b16 v[52:53], v108 offset:36864
    v_mfma_f32_16x16x32_bf16 v[76:79], v[40:43], v[116:119], 0
    ds_read_b64_tr_b16 v[54:55], v108 offset:37888
    s_waitcnt lgkmcnt(4)
    v_mfma_f32_16x16x32_bf16 v[80:83], v[44:47], v[112:115], 0
    ds_read_b64_tr_b16 v[40:41], v8 offset:40960
    v_mfma_f32_16x16x32_bf16 v[84:87], v[44:47], v[116:119], 0
    ds_read_b64_tr_b16 v[42:43], v8 offset:41984
    s_waitcnt lgkmcnt(4)
    v_mfma_f32_16x16x32_bf16 v[72:75], v[48:51], v[120:123], v[72:75]
    ds_read_b64_tr_b16 v[44:45], v108 offset:40960
    v_mfma_f32_16x16x32_bf16 v[76:79], v[48:51], v[124:127], v[76:79]
    ds_read_b64_tr_b16 v[46:47], v108 offset:41984
    v_cvt_pk_bf16_f32 v32, v56, v57
    v_cvt_pk_bf16_f32 v33, v58, v59
    v_cvt_pk_bf16_f32 v34, v60, v61
    v_cvt_pk_bf16_f32 v35, v62, v63
    s_waitcnt lgkmcnt(4)
    v_mfma_f32_16x16x32_bf16 v[80:83], v[52:55], v[120:123], v[80:83]
    ds_read_b64_tr_b16 v[48:49], v8 offset:45056
    v_mfma_f32_16x16x32_bf16 v[84:87], v[52:55], v[124:127], v[84:87]
    ds_read_b64_tr_b16 v[50:51], v8 offset:46080
    v_cvt_pk_bf16_f32 v36, v64, v65
    v_cvt_pk_bf16_f32 v37, v66, v67
    v_cvt_pk_bf16_f32 v38, v68, v69
    v_cvt_pk_bf16_f32 v39, v70, v71
    s_waitcnt lgkmcnt(4)
    v_mfma_f32_16x16x32_bf16 v[72:75], v[40:43], v[128:131], v[72:75]
    ds_read_b64_tr_b16 v[52:53], v108 offset:45056
    v_mfma_f32_16x16x32_bf16 v[76:79], v[40:43], v[132:135], v[76:79]
    ds_read_b64_tr_b16 v[54:55], v108 offset:46080
    s_add_u32 s38, s37, 14336
    v_permlane16_swap_b32 v32, v34
    v_permlane16_swap_b32 v33, v35
    v_permlane16_swap_b32 v36, v38
    s_waitcnt lgkmcnt(4)
    v_mfma_f32_16x16x32_bf16 v[80:83], v[44:47], v[128:131], v[80:83]
    ds_read_b64_tr_b16 v[40:41], v9 offset:16384
    v_mfma_f32_16x16x32_bf16 v[84:87], v[44:47], v[132:135], v[84:87]
    ds_read_b64_tr_b16 v[42:43], v9 offset:17408
    v_permlane16_swap_b32 v37, v39
    buffer_store_dwordx4 v[32:35], v20, s[16:19], s38 offen offset:0 sc1
    s_waitcnt lgkmcnt(4)
    v_mfma_f32_16x16x32_bf16 v[72:75], v[48:51], v[136:139], v[72:75]
    ds_read_b64_tr_b16 v[44:45], v109 offset:16384
    v_mfma_f32_16x16x32_bf16 v[76:79], v[48:51], v[140:143], v[76:79]
    ds_read_b64_tr_b16 v[46:47], v109 offset:17408
    s_waitcnt lgkmcnt(4)
    v_mfma_f32_16x16x32_bf16 v[80:83], v[52:55], v[136:139], v[80:83]
    ds_read_b64_tr_b16 v[48:49], v9 offset:20480
    v_mfma_f32_16x16x32_bf16 v[84:87], v[52:55], v[140:143], v[84:87]
    ds_read_b64_tr_b16 v[50:51], v9 offset:21504
    buffer_store_dwordx4 v[36:39], v20, s[16:19], s38 offen offset:1024 sc1
    s_waitcnt lgkmcnt(4)
    v_mfma_f32_16x16x32_bf16 v[72:75], v[40:43], v[144:147], v[72:75]
    ds_read_b64_tr_b16 v[52:53], v109 offset:20480
    v_mfma_f32_16x16x32_bf16 v[76:79], v[40:43], v[148:151], v[76:79]
    ds_read_b64_tr_b16 v[54:55], v109 offset:21504
    s_waitcnt lgkmcnt(4)
    v_mfma_f32_16x16x32_bf16 v[80:83], v[44:47], v[144:147], v[80:83]
    v_mfma_f32_16x16x32_bf16 v[84:87], v[44:47], v[148:151], v[84:87]
    s_waitcnt lgkmcnt(2)
    s_waitcnt vmcnt(4)
    s_barrier
    v_mfma_f32_16x16x32_bf16 v[72:75], v[48:51], v[152:155], v[72:75]
    ds_read_b64_tr_b16 v[40:41], v9 offset:24576
    v_mfma_f32_16x16x32_bf16 v[76:79], v[48:51], v[156:159], v[76:79]
    ds_read_b64_tr_b16 v[42:43], v9 offset:25600
    ds_read_b64_tr_b16 v[44:45], v109 offset:24576
    ds_read_b64_tr_b16 v[46:47], v109 offset:25600
    s_waitcnt lgkmcnt(4)
    v_mfma_f32_16x16x32_bf16 v[80:83], v[52:55], v[152:155], v[80:83]
    ds_read_b64_tr_b16 v[48:49], v9 offset:28672
    v_mfma_f32_16x16x32_bf16 v[84:87], v[52:55], v[156:159], v[84:87]
    ds_read_b64_tr_b16 v[50:51], v9 offset:29696
    s_waitcnt lgkmcnt(4)
    v_mfma_f32_16x16x32_bf16 v[72:75], v[40:43], v[160:163], v[72:75]
    ds_read_b64_tr_b16 v[52:53], v109 offset:28672
    v_mfma_f32_16x16x32_bf16 v[76:79], v[40:43], v[164:167], v[76:79]
    ds_read_b64_tr_b16 v[54:55], v109 offset:29696
    s_waitcnt lgkmcnt(4)
    v_mfma_f32_16x16x32_bf16 v[80:83], v[44:47], v[160:163], v[80:83]
    ds_read_b64_tr_b16 v[40:41], v9 offset:49152
    v_mfma_f32_16x16x32_bf16 v[84:87], v[44:47], v[164:167], v[84:87]
    ds_read_b64_tr_b16 v[42:43], v9 offset:50176
    s_waitcnt lgkmcnt(4)
    v_mfma_f32_16x16x32_bf16 v[72:75], v[48:51], v[168:171], v[72:75]
    ds_read_b64_tr_b16 v[44:45], v109 offset:49152
    v_mfma_f32_16x16x32_bf16 v[76:79], v[48:51], v[172:175], v[76:79]
    ds_read_b64_tr_b16 v[46:47], v109 offset:50176
    s_waitcnt lgkmcnt(4)
    v_mfma_f32_16x16x32_bf16 v[80:83], v[52:55], v[168:171], v[80:83]
    ds_read_b64_tr_b16 v[48:49], v9 offset:53248
    v_mfma_f32_16x16x32_bf16 v[84:87], v[52:55], v[172:175], v[84:87]
    ds_read_b64_tr_b16 v[50:51], v9 offset:54272
    s_waitcnt lgkmcnt(4)
    v_mfma_f32_16x16x32_bf16 v[72:75], v[40:43], v[176:179], v[72:75]
    ds_read_b64_tr_b16 v[52:53], v109 offset:53248
    v_mfma_f32_16x16x32_bf16 v[76:79], v[40:43], v[180:183], v[76:79]
    ds_read_b64_tr_b16 v[54:55], v109 offset:54272
    s_waitcnt lgkmcnt(4)
    v_mfma_f32_16x16x32_bf16 v[80:83], v[44:47], v[176:179], v[80:83]
    ds_read_b64_tr_b16 v[40:41], v9 offset:57344
    v_mfma_f32_16x16x32_bf16 v[84:87], v[44:47], v[180:183], v[84:87]
    ds_read_b64_tr_b16 v[42:43], v9 offset:58368
    s_waitcnt lgkmcnt(4)
    v_mfma_f32_16x16x32_bf16 v[72:75], v[48:51], v[184:187], v[72:75]
    ds_read_b64_tr_b16 v[44:45], v109 offset:57344
    v_mfma_f32_16x16x32_bf16 v[76:79], v[48:51], v[188:191], v[76:79]
    ds_read_b64_tr_b16 v[46:47], v109 offset:58368
    s_waitcnt lgkmcnt(4)
    v_mfma_f32_16x16x32_bf16 v[80:83], v[52:55], v[184:187], v[80:83]
    ds_read_b64_tr_b16 v[48:49], v9 offset:61440
    v_mfma_f32_16x16x32_bf16 v[84:87], v[52:55], v[188:191], v[84:87]
    ds_read_b64_tr_b16 v[50:51], v9 offset:62464
    s_waitcnt lgkmcnt(4)
    v_mfma_f32_16x16x32_bf16 v[72:75], v[40:43], v[192:195], v[72:75]
    ds_read_b64_tr_b16 v[52:53], v109 offset:61440
    v_mfma_f32_16x16x32_bf16 v[76:79], v[40:43], v[196:199], v[76:79]
    ds_read_b64_tr_b16 v[54:55], v109 offset:62464
    s_waitcnt lgkmcnt(4)
    v_mfma_f32_16x16x32_bf16 v[80:83], v[44:47], v[192:195], v[80:83]
    v_mfma_f32_16x16x32_bf16 v[84:87], v[44:47], v[196:199], v[84:87]
    s_waitcnt lgkmcnt(2)
    v_mfma_f32_16x16x32_bf16 v[72:75], v[48:51], v[200:203], v[72:75]
    v_mfma_f32_16x16x32_bf16 v[76:79], v[48:51], v[204:207], v[76:79]
    s_waitcnt lgkmcnt(0)
    v_mfma_f32_16x16x32_bf16 v[80:83], v[52:55], v[200:203], v[80:83]
    v_mfma_f32_16x16x32_bf16 v[84:87], v[52:55], v[204:207], v[84:87]
    s_nop 11
    v_cvt_pk_bf16_f32 v32, v72, v73
    v_cvt_pk_bf16_f32 v33, v74, v75
    v_cvt_pk_bf16_f32 v34, v76, v77
    v_cvt_pk_bf16_f32 v35, v78, v79
    v_cvt_pk_bf16_f32 v36, v80, v81
    v_cvt_pk_bf16_f32 v37, v82, v83
    v_cvt_pk_bf16_f32 v38, v84, v85
    v_cvt_pk_bf16_f32 v39, v86, v87
    s_add_u32 s38, s37, 16384
    v_permlane16_swap_b32 v32, v34
    v_permlane16_swap_b32 v33, v35
    v_permlane16_swap_b32 v36, v38
    v_permlane16_swap_b32 v37, v39
    buffer_store_dwordx4 v[32:35], v20, s[16:19], s38 offen offset:0 sc1
    buffer_store_dwordx4 v[36:39], v20, s[16:19], s38 offen offset:1024 sc1
    s_waitcnt vmcnt(4)
    s_mul_i32 s42, s76, 1152
    s_lshr_b32 s3, s74, 6
    s_lshl_b32 s3, s3, 7
    s_add_u32 s42, s42, s3
    s_add_u32 s42, s42, 768
    v_add_u32 v107, 0, v107
    v_lshrrev_b32 v5, 3, v0
    s_lshl_b32 s3, s28, 2
    v_add_u32 v5, s3, v5
    v_and_b32 v7, 7, v0
    v_lshlrev_b32 v7, 4, v7
    v_mul_u32_u24 v6, 1152, v5
    v_add_u32 v6, v6, v7
    v_mul_u32_u24 v5, 144, v5
    v_add_u32 v5, v5, v7
    v_add_u32 v5, 0, v5
    ds_read_b64_tr_b16 v[252:253], v19 offset:1024
    s_waitcnt vmcnt(0)
    v_mov_b32 v17, 1
    s_mov_b64 exec, 1
    buffer_atomic_add v17, off, s[16:19], s98 offset:8 sc1
    s_mov_b64 exec, -1
    v_mov_b32 v22, 0
    s_mov_b64 exec, 1
    buffer_atomic_add v22, off, s[16:19], s99 offset:8 sc0 sc1
    s_mov_b64 exec, -1
    s_barrier
    s_waitcnt vmcnt(0)
    v_readfirstlane_b32 s3, v22
    s_cmp_ge_u32 s3, 12
    s_cbranch_scc0 L_spin1
L_ret1:
    s_add_u32 s44, s39, 12288
    buffer_load_dwordx4 v[136:139], v23, s[16:19], s44 offen sc1
    s_add_u32 s44, s39, 307200
    buffer_load_dwordx4 v[140:143], v23, s[16:19], s44 offen sc1
    s_add_u32 s44, s39, 602112
    buffer_load_dwordx4 v[144:147], v23, s[16:19], s44 offen sc1
    s_add_u32 s44, s39, 897024
    buffer_load_dwordx4 v[148:151], v23, s[16:19], s44 offen sc1
    s_add_u32 s44, s39, 1191936
    buffer_load_dwordx4 v[152:155], v23, s[16:19], s44 offen sc1
    s_add_u32 s44, s39, 1486848
    buffer_load_dwordx4 v[156:159], v23, s[16:19], s44 offen sc1
    s_waitcnt vmcnt(5)
    v_lshlrev_b32 v240, 16, v136
    v_and_b32 v241, 0xffff0000, v136
    v_lshlrev_b32 v242, 16, v137
    v_and_b32 v243, 0xffff0000, v137
    v_lshlrev_b32 v28, 16, v138
    v_and_b32 v29, 0xffff0000, v138
    v_lshlrev_b32 v30, 16, v139
    v_and_b32 v21, 0xffff0000, v139
    s_waitcnt vmcnt(4)
    v_lshlrev_b32 v24, 16, v140
    v_and_b32 v25, 0xffff0000, v140
    v_lshlrev_b32 v26, 16, v141
    v_and_b32 v27, 0xffff0000, v141
    v_add_f32 v240, v240, v24
    v_add_f32 v241, v241, v25
    v_add_f32 v242, v242, v26
    v_add_f32 v243, v243, v27
    v_lshlrev_b32 v24, 16, v142
    v_and_b32 v25, 0xffff0000, v142
    v_lshlrev_b32 v26, 16, v143
    v_and_b32 v27, 0xffff0000, v143
    v_add_f32 v28, v28, v24
    v_add_f32 v29, v29, v25
    v_add_f32 v30, v30, v26
    v_add_f32 v21, v21, v27
    s_waitcnt vmcnt(3)
    v_lshlrev_b32 v24, 16, v144
    v_and_b32 v25, 0xffff0000, v144
    v_lshlrev_b32 v26, 16, v145
    v_and_b32 v27, 0xffff0000, v145
    v_add_f32 v240, v240, v24
    v_add_f32 v241, v241, v25
    v_add_f32 v242, v242, v26
    v_add_f32 v243, v243, v27
    v_lshlrev_b32 v24, 16, v146
    v_and_b32 v25, 0xffff0000, v146
    v_lshlrev_b32 v26, 16, v147
    v_and_b32 v27, 0xffff0000, v147
    v_add_f32 v28, v28, v24
    v_add_f32 v29, v29, v25
    v_add_f32 v30, v30, v26
    v_add_f32 v21, v21, v27
    s_waitcnt vmcnt(2)
    v_lshlrev_b32 v24, 16, v148
    v_and_b32 v25, 0xffff0000, v148
    v_lshlrev_b32 v26, 16, v149
    v_and_b32 v27, 0xffff0000, v149
    v_add_f32 v240, v240, v24
    v_add_f32 v241, v241, v25
    v_add_f32 v242, v242, v26
    v_add_f32 v243, v243, v27
    v_lshlrev_b32 v24, 16, v150
    v_and_b32 v25, 0xffff0000, v150
    v_lshlrev_b32 v26, 16, v151
    v_and_b32 v27, 0xffff0000, v151
    v_add_f32 v28, v28, v24
    v_add_f32 v29, v29, v25
    v_add_f32 v30, v30, v26
    v_add_f32 v21, v21, v27
    s_waitcnt vmcnt(1)
    v_lshlrev_b32 v24, 16, v152
    v_and_b32 v25, 0xffff0000, v152
    v_lshlrev_b32 v26, 16, v153
    v_and_b32 v27, 0xffff0000, v153
    v_add_f32 v240, v240, v24
    v_add_f32 v241, v241, v25
    v_add_f32 v242, v242, v26
    v_add_f32 v243, v243, v27
    v_lshlrev_b32 v24, 16, v154
    v_and_b32 v25, 0xffff0000, v154
    v_lshlrev_b32 v26, 16, v155
    v_and_b32 v27, 0xffff0000, v155
    v_add_f32 v28, v28, v24
    v_add_f32 v29, v29, v25
    v_add_f32 v30, v30, v26
    v_add_f32 v21, v21, v27
    s_waitcnt vmcnt(0)
    v_lshlrev_b32 v24, 16, v156
    v_and_b32 v25, 0xffff0000, v156
    v_lshlrev_b32 v26, 16, v157
    v_and_b32 v27, 0xffff0000, v157
    v_add_f32 v240, v240, v24
    v_add_f32 v241, v241, v25
    v_add_f32 v242, v242, v26
    v_add_f32 v243, v243, v27
    v_lshlrev_b32 v24, 16, v158
    v_and_b32 v25, 0xffff0000, v158
    v_lshlrev_b32 v26, 16, v159
    v_and_b32 v27, 0xffff0000, v159
    v_add_f32 v28, v28, v24
    v_add_f32 v29, v29, v25
    v_add_f32 v30, v30, v26
    v_add_f32 v21, v21, v27
    s_nop 1
    v_permlane32_swap_b32 v240, v28
    v_permlane32_swap_b32 v241, v29
    v_permlane32_swap_b32 v242, v30
    v_permlane32_swap_b32 v243, v21
    v_add_f32 v240, v240, v28
    v_add_f32 v241, v241, v29
    v_add_f32 v242, v242, v30
    v_add_f32 v243, v243, v21
    s_waitcnt lgkmcnt(0)
    v_and_b32 v255, 0xffff0000, v253
    v_lshlrev_b32 v254, 16, v253
    v_and_b32 v253, 0xffff0000, v252
    v_lshlrev_b32 v252, 16, v252
    v_mul_f32 v240, v105, v240
    v_mul_f32 v241, v105, v241
    v_mul_f32 v242, v105, v242
    v_mul_f32 v243, v105, v243
    v_fmac_f32 v240, v104, v252
    v_fmac_f32 v241, v104, v253
    v_fmac_f32 v242, v104, v254
    v_fmac_f32 v243, v104, v255
    v_cvt_pk_bf16_f32 v240, v240, v241
    v_cvt_pk_bf16_f32 v241, v242, v243
    ds_write_b64 v107, v[240:241]
    s_waitcnt lgkmcnt(0)
    s_barrier
    s_mov_b32 exec_hi, 0
    ds_read_b128 v[232:235], v5
    s_waitcnt lgkmcnt(0)
    buffer_store_dwordx4 v[232:235], v6, s[20:23], s42 offen
    s_mov_b32 exec_hi, -1
    s_endpgm
L_cntl:
    buffer_load_dword v22, off, s[24:27], 0 offset:64 sc1
    s_branch L_cntl_r
L_cntc:
    s_mov_b32 s43, 0
    s_waitcnt vmcnt(5)
L_cnt_l:
    v_cmp_le_u32 vcc, 64, v22
    s_cbranch_vccnz L_cntc_r
    s_sleep 2
    buffer_load_dword v22, off, s[24:27], 0 offset:64 sc1
    s_add_u32 s43, s43, 1
    s_cmp_lt_u32 s43, 65536
    s_waitcnt vmcnt(0)
    s_cbranch_scc1 L_cnt_l
    s_branch L_cntc_r
L_othl:
    buffer_load_dword v31, off, s[24:27], 0 offset:128 sc1
    s_branch L_othl_r
L_othc:
    s_mov_b32 s43, 0
    s_waitcnt vmcnt(4)
L_oth_l:
    v_cmp_le_u32 vcc, 64, v31
    s_cbranch_vccnz L_othc_r
    s_sleep 2
    buffer_load_dword v31, off, s[24:27], 0 offset:128 sc1
    s_add_u32 s43, s43, 1
    s_cmp_lt_u32 s43, 65536
    s_waitcnt vmcnt(0)
    s_cbranch_scc1 L_oth_l
    s_branch L_othc_r
L_spin1:
    s_mov_b32 s43, 0
L_spin1_l:
    s_sleep 2
    v_mov_b32 v22, 0
    s_mov_b64 exec, 1
    buffer_atomic_add v22, off, s[16:19], s99 offset:8 sc0 sc1
    s_mov_b64 exec, -1
    s_add_u32 s43, s43, 1
    s_waitcnt vmcnt(0)
    v_readfirstlane_b32 s3, v22
    s_cmp_ge_u32 s3, 12
    s_cbranch_scc1 L_ret1
    s_cmp_lt_u32 s43, 65536
    s_cbranch_scc1 L_spin1_l
    s_branch L_ret1
L_mlp_end:
L_conv_rest:
    v_lshlrev_b32 v124, 2, v3
    v_cvt_f32_u32 v6, v124
    v_lshrrev_b32 v124, 2, v3
    v_and_b32 v125, 3, v3
    v_lshl_add_u32 v126, v124, 6, v125
    v_cvt_f32_u32 v7, v126
    v_lshrrev_b32 v126, 1, v3
    v_and_b32 v127, 1, v3
    v_lshlrev_b32 v127, 1, v127
    v_lshl_add_u32 v126, v126, 6, v127
    v_cmp_gt_u32 vcc, 8, v3
    v_add_u32 v126, 256, v126
    v_lshlrev_b32 v127, 6, v3
    v_cndmask_b32 v126, v127, v126, vcc
    v_cvt_f32_u32 v8, v126
    s_mul_i32 s32, s28, 8320
    s_add_u32 s32, s32, 41472
    v_lshl_add_u32 v5, v4, 6, s32
    v_lshl_add_u32 v10, v0, 5, s32
    s_lshl_b32 s3, s28, 8
    s_add_u32 s3, s3, 2048
    v_add_u32 v11, s3, v5
    s_add_u32 s33, s32, 4608
    v_lshrrev_b32 v124, 1, v4
    v_and_b32 v125, 1, v4
    v_lshlrev_b32 v126, 3, v3
    v_lshl_add_u32 v126, v4, 7, v126
    v_add_u32 v12, s33, v126
    v_lshlrev_b32 v126, 2, v3
    v_lshlrev_b32 v127, 1, v3
    v_cmp_gt_u32 vcc, 2, v4
    v_mov_b32 v128, 32
    s_add_u32 s3, s33, 512
    v_cndmask_b32 v126, v127, v126, vcc
    v_cndmask_b32 v128, v128, 2, vcc
    v_lshl_add_u32 v126, v4, 7, v126
    v_add_u32 v13, s3, v126
    v_add_u32 v14, v13, v128
    v_mov_b32 v128, 768
    v_mov_b32 v126, 1312
    v_cndmask_b32 v128, v128, v126, vcc
    v_lshl_add_u32 v127, v4, 7, v127
    v_add3_u32 v15, v127, v128, s33
    v_lshl_add_u32 v16, v0, 4, s33
    v_max_u32 v126, 1, v0
    v_lshl_add_u32 v17, v126, 4, s33
    v_add_u32 v17, -2, v17
    s_add_u32 s3, s33, 512
    v_lshl_add_u32 v18, v0, 3, s3
    v_min_u32 v126, 1, v0
    v_lshl_add_u32 v126, v126, 1, v18
    v_add_u32 v19, -2, v126
    s_add_u32 s3, s33, 768
    v_lshl_add_u32 v20, v0, 2, s3
    s_add_u32 s3, s33, 1024
    v_lshl_add_u32 v21, v0, 1, s3
    v_lshl_add_u32 v22, v0, 4, s32
    v_and_b32 v126, 1, v0
    v_cmp_eq_u32 vcc, 0, v126
    v_mov_b32 v126, 0x05040504
    v_mov_b32 v127, 0x05040100
    v_cndmask_b32 v23, v126, v127, vcc
    v_lshl_add_u32 v126, v124, 4, v3
    v_lshlrev_b32 v127, 3, v125
    v_sub_u32 v126, v126, v127
    v_add_u32 v126, 9, v126
    v_and_b32 v127, 1, v126
    v_add_u32 v126, v126, v127
    v_mul_u32_u24 v127, 4160, v127
    v_lshl_add_u32 v126, v126, 1, v127
    v_add_u32 v30, s32, v126
    v_add_u32 v31, 1024, v30
    v_add_u32 v32, 2048, v30
    v_add_u32 v33, 3072, v30
    v_sub_u32 v126, v3, v124
    v_lshlrev_b32 v126, 5, v126
    v_lshl_add_u32 v126, v125, 4, v126
    s_mul_i32 s3, s28, 4608
    s_add_u32 s3, s3, 32
    v_add_u32 v34, s3, v126
    v_lshlrev_b32 v35, 5, v3
    v_lshl_add_u32 v35, v4, 3, v35
    s_lshl_b32 s3, s28, 2
    v_add_u32 v27, s3, v4
    v_mul_u32_u24 v27, 1152, v27
    v_lshl_add_u32 v27, v3, 3, v27
    v_lshrrev_b32 v126, 2, v3
    v_lshlrev_b32 v127, 3, v4
    v_sub_u32 v126, v127, v126
    v_add_u32 v126, 3, v126
    v_mul_u32_u24 v126, 1152, v126
    v_and_b32 v127, 3, v0
    v_lshl_add_u32 v126, v127, 3, v126
    s_lshl_b32 s3, s28, 5
    v_add_u32 v25, s3, v126
    v_lshlrev_b32 v26, 6, v3
    v_lshl_add_u32 v26, v4, 4, v26
    s_lshl_b32 s3, s28, 10
    v_add_u32 v26, s3, v26
    v_lshrrev_b32 v126, 2, v0
    v_mul_u32_u24 v126, 36864, v126
    v_lshl_add_u32 v29, v127, 4, v126
    s_mul_i32 s3, s29, 36864
    s_add_u32 s4, s40, s3
    s_addc_u32 s5, s41, 0
    s_mov_b32 s6, 36864
    s_mov_b32 s7, 0x20000
    s_add_u32 s3, s3, 30752768
    s_add_u32 s8, s72, s3
    s_addc_u32 s9, s73, 0
    s_mov_b32 s10, 36864
    s_mov_b32 s11, 0x20000
    s_mov_b32 s16, s72
    s_mov_b32 s17, s73
    s_mov_b32 s18, 33374208
    s_mov_b32 s19, 0x20000
    s_mov_b32 s20, s70
    s_mov_b32 s21, s71
    s_mov_b32 s22, 256
    s_mov_b32 s23, 0x20000
    s_lshl_b32 s3, s29, 3
    s_add_u32 s3, s3, s28
    s_lshl_b32 s98, s3, 5
    s_add_u32 s98, s98, 30670848
    s_lshr_b32 s3, s39, 1
    s_mul_i32 s3, s3, 1327104
    s_add_u32 s12, s64, s3
    s_addc_u32 s13, s65, 0
    s_mov_b32 s14, 1327104
    s_mov_b32 s15, 0x20000
    s_mov_b32 s34, 0x3fb8aa3b
    s_mov_b32 s35, 0x3e22f983
    s_mov_b32 s36, 0x01000100
    s_mov_b32 s37, 0x05040302
    s_mov_b32 s38, 0x03020302
    v_lshlrev_b32 v148, 4, v0
    s_lshl_b32 s75, s28, 10
    s_add_u32 m0, s75, 0
    s_add_u32 s3, s75, 0
    buffer_load_dwordx4 v148, s[4:7], s3 offen lds
    s_add_u32 m0, s75, 8192
    s_add_u32 s3, s75, 8192
    buffer_load_dwordx4 v148, s[4:7], s3 offen lds
    s_add_u32 m0, s75, 16384
    s_add_u32 s3, s75, 16384
    buffer_load_dwordx4 v148, s[4:7], s3 offen lds
    s_add_u32 m0, s75, 24576
    s_add_u32 s3, s75, 24576
    buffer_load_dwordx4 v148, s[4:7], s3 offen lds
    s_add_u32 m0, s75, 32768
    s_add_u32 s3, s75, 32768
    buffer_load_dwordx4 v148, s[4:7], s3 offen lds
    s_waitcnt vmcnt(5)
    v_lshlrev_b32 v124, 16, v42
    v_mul_f32 v124, s34, v124
    v_exp_f32 v124, v124
    s_nop 0
    v_cvt_pk_bf16_f32 v124, v124, v124
    v_and_b32 v124, 0xffff0000, v124
    v_lshlrev_b32 v125, 16, v36
    v_lshlrev_b32 v126, 16, v37
    v_lshlrev_b32 v127, 16, v38
    v_lshlrev_b32 v128, 16, v39
    v_lshlrev_b32 v129, 16, v40
    v_lshlrev_b32 v130, 16, v41
    v_mul_f32 v125, v124, v125
    v_mul_f32 v126, v124, v126
    v_mul_f32 v127, v124, v127
    v_mul_f32 v128, v124, v128
    v_mul_f32 v132, s34, v125
    v_mul_f32 v133, s35, v126
    v_mul_f32 v134, v129, v127
    v_mul_f32 v135, v129, v128
    v_rndne_f32 v125, v133
    v_fma_f32 v134, -v130, v128, v134
    v_fmac_f32 v135, v130, v127
    v_sub_f32 v133, v133, v125
    ds_write_b128 v10, v[132:135] offset:0
    v_and_b32 v125, 0xffff0000, v36
    v_and_b32 v126, 0xffff0000, v37
    v_and_b32 v127, 0xffff0000, v38
    v_and_b32 v128, 0xffff0000, v39
    v_and_b32 v129, 0xffff0000, v40
    v_and_b32 v130, 0xffff0000, v41
    v_mul_f32 v125, v124, v125
    v_mul_f32 v126, v124, v126
    v_mul_f32 v127, v124, v127
    v_mul_f32 v128, v124, v128
    v_mul_f32 v136, s34, v125
    v_mul_f32 v137, s35, v126
    v_mul_f32 v138, v129, v127
    v_mul_f32 v139, v129, v128
    v_rndne_f32 v125, v137
    v_fma_f32 v138, -v130, v128, v138
    v_fmac_f32 v139, v130, v127
    v_sub_f32 v137, v137, v125
    ds_write_b128 v10, v[136:139] offset:16
    v_mul_f32 v125, 0x45000000, v132
    v_mul_f32 v126, 0x45000000, v133
    v_exp_f32 v125, v125
    v_fract_f32 v126, v126
    v_cos_f32 v127, v126
    v_sin_f32 v126, v126
    v_mul_f32 v127, v127, v134
    v_fma_f32 v127, -v126, v135, v127
    v_mul_f32 v42, v125, v127
    v_mul_f32 v125, 0x45000000, v136
    v_mul_f32 v126, 0x45000000, v137
    v_exp_f32 v125, v125
    v_fract_f32 v126, v126
    v_cos_f32 v127, v126
    v_sin_f32 v126, v126
    v_mul_f32 v127, v127, v138
    v_fma_f32 v127, -v126, v139, v127
    v_fmac_f32 v42, v125, v127
    s_nop 1
    v_add_f32_dpp v42, v42, v42 quad_perm:[1,0,3,2] row_mask:0xf bank_mask:0xf
    s_nop 1
    v_add_f32_dpp v42, v42, v42 quad_perm:[2,3,0,1] row_mask:0xf bank_mask:0xf
    s_nop 1
    v_add_f32_dpp v42, v42, v42 row_half_mirror row_mask:0xf bank_mask:0xf
    s_nop 1
    v_add_f32_dpp v42, v42, v42 row_mirror row_mask:0xf bank_mask:0xf
    v_mov_b32 v125, v42
    s_nop 1
    v_permlane16_swap_b32 v125, v42
    v_add_f32 v42, v42, v125
    v_mov_b32 v125, v42
    s_nop 1
    v_permlane32_swap_b32 v125, v42
    v_add_f32 v42, v42, v125
    v_lshlrev_b32 v124, 16, v50
    v_mul_f32 v124, s34, v124
    v_exp_f32 v124, v124
    s_nop 0
    v_cvt_pk_bf16_f32 v124, v124, v124
    v_and_b32 v124, 0xffff0000, v124
    v_lshlrev_b32 v125, 16, v44
    v_lshlrev_b32 v126, 16, v45
    v_lshlrev_b32 v127, 16, v46
    v_lshlrev_b32 v128, 16, v47
    v_lshlrev_b32 v129, 16, v48
    v_lshlrev_b32 v130, 16, v49
    v_mul_f32 v125, v124, v125
    v_mul_f32 v126, v124, v126
    v_mul_f32 v127, v124, v127
    v_mul_f32 v128, v124, v128
    v_mul_f32 v132, s34, v125
    v_mul_f32 v133, s35, v126
    v_mul_f32 v134, v129, v127
    v_mul_f32 v135, v129, v128
    v_rndne_f32 v125, v133
    v_fma_f32 v134, -v130, v128, v134
    v_fmac_f32 v135, v130, v127
    v_sub_f32 v133, v133, v125
    ds_write_b128 v10, v[132:135] offset:2048
    v_and_b32 v125, 0xffff0000, v44
    v_and_b32 v126, 0xffff0000, v45
    v_and_b32 v127, 0xffff0000, v46
    v_and_b32 v128, 0xffff0000, v47
    v_and_b32 v129, 0xffff0000, v48
    v_and_b32 v130, 0xffff0000, v49
    v_mul_f32 v125, v124, v125
    v_mul_f32 v126, v124, v126
    v_mul_f32 v127, v124, v127
    v_mul_f32 v128, v124, v128
    v_mul_f32 v136, s34, v125
    v_mul_f32 v137, s35, v126
    v_mul_f32 v138, v129, v127
    v_mul_f32 v139, v129, v128
    v_rndne_f32 v125, v137
    v_fma_f32 v138, -v130, v128, v138
    v_fmac_f32 v139, v130, v127
    v_sub_f32 v137, v137, v125
    ds_write_b128 v10, v[136:139] offset:2064
    s_cmp_lg_u32 s28, 7
    s_cbranch_scc1 L_no2048
    v_mul_f32 v125, 0x45000000, v132
    v_mul_f32 v126, 0x45000000, v133
    v_exp_f32 v125, v125
    v_fract_f32 v126, v126
    v_cos_f32 v127, v126
    v_sin_f32 v126, v126
    v_mul_f32 v127, v127, v134
    v_fma_f32 v127, -v126, v135, v127
    v_mul_f32 v50, v125, v127
    v_mul_f32 v125, 0x45000000, v136
    v_mul_f32 v126, 0x45000000, v137
    v_exp_f32 v125, v125
    v_fract_f32 v126, v126
    v_cos_f32 v127, v126
    v_sin_f32 v126, v126
    v_mul_f32 v127, v127, v138
    v_fma_f32 v127, -v126, v139, v127
    v_fmac_f32 v50, v125, v127
    s_nop 1
    v_add_f32_dpp v50, v50, v50 quad_perm:[1,0,3,2] row_mask:0xf bank_mask:0xf
    s_nop 1
    v_add_f32_dpp v50, v50, v50 quad_perm:[2,3,0,1] row_mask:0xf bank_mask:0xf
    s_nop 1
    v_add_f32_dpp v50, v50, v50 row_half_mirror row_mask:0xf bank_mask:0xf
    s_nop 1
    v_add_f32_dpp v50, v50, v50 row_mirror row_mask:0xf bank_mask:0xf
    v_mov_b32 v125, v50
    s_nop 1
    v_permlane16_swap_b32 v125, v50
    v_add_f32 v50, v50, v125
    v_mov_b32 v125, v50
    s_nop 1
    v_permlane32_swap_b32 v125, v50
    v_add_f32 v50, v50, v125
L_no2048:
    s_waitcnt lgkmcnt(0)
    ds_read_b128 v[52:55], v5 offset:0
    ds_read_b128 v[56:59], v5 offset:16
    ds_read_b128 v[60:63], v5 offset:32
    ds_read_b128 v[64:67], v5 offset:48
    s_waitcnt lgkmcnt(0)
    ds_read_b128 v[68:71], v5 offset:256
    ds_read_b128 v[72:75], v5 offset:272
    ds_read_b128 v[76:79], v5 offset:288
    ds_read_b128 v[80:83], v5 offset:304
    v_pk_mul_f32 v[124:125], v[52:53], v[6:7] op_sel:[0,0] op_sel_hi:[1,0]
    v_pk_mul_f32 v[126:127], v[56:57], v[6:7] op_sel:[0,0] op_sel_hi:[1,0]
    v_pk_mul_f32 v[128:129], v[60:61], v[6:7] op_sel:[0,0] op_sel_hi:[1,0]
    v_pk_mul_f32 v[130:131], v[64:65], v[6:7] op_sel:[0,0] op_sel_hi:[1,0]
    v_exp_f32 v124, v124
    v_exp_f32 v126, v126
    v_exp_f32 v128, v128
    v_exp_f32 v130, v130
    v_cos_f32 v132, v125
    v_cos_f32 v134, v127
    v_cos_f32 v136, v129
    v_cos_f32 v138, v131
    v_sin_f32 v133, v125
    v_sin_f32 v135, v127
    v_sin_f32 v137, v129
    v_sin_f32 v139, v131
    v_pk_mul_f32 v[132:133], v[132:133], v[124:125] op_sel:[0,0] op_sel_hi:[1,0]
    v_pk_mul_f32 v[134:135], v[134:135], v[126:127] op_sel:[0,0] op_sel_hi:[1,0]
    v_pk_mul_f32 v[136:137], v[136:137], v[128:129] op_sel:[0,0] op_sel_hi:[1,0]
    v_pk_mul_f32 v[138:139], v[138:139], v[130:131] op_sel:[0,0] op_sel_hi:[1,0]
    v_pk_mul_f32 v[140:141], v[132:133], v[54:55] op_sel:[0,0] op_sel_hi:[0,1]
    v_pk_mul_f32 v[142:143], v[134:135], v[58:59] op_sel:[0,0] op_sel_hi:[0,1]
    v_pk_mul_f32 v[144:145], v[136:137], v[62:63] op_sel:[0,0] op_sel_hi:[0,1]
    v_pk_mul_f32 v[146:147], v[138:139], v[66:67] op_sel:[0,0] op_sel_hi:[0,1]
    v_pk_fma_f32 v[140:141], v[132:133], v[54:55], v[140:141] op_sel:[1,1,0] op_sel_hi:[1,0,1] neg_lo:[1,0,0] neg_hi:[1,0,1]
    v_pk_fma_f32 v[142:143], v[134:135], v[58:59], v[142:143] op_sel:[1,1,0] op_sel_hi:[1,0,1] neg_lo:[1,0,0] neg_hi:[1,0,1]
    v_pk_fma_f32 v[144:145], v[136:137], v[62:63], v[144:145] op_sel:[1,1,0] op_sel_hi:[1,0,1] neg_lo:[1,0,0] neg_hi:[1,0,1]
    v_pk_fma_f32 v[146:147], v[138:139], v[66:67], v[146:147] op_sel:[1,1,0] op_sel_hi:[1,0,1] neg_lo:[1,0,0] neg_hi:[1,0,1]
    v_pk_mul_f32 v[124:125], v[140:141], v[132:133] op_sel:[0,0] op_sel_hi:[1,0]
    v_pk_mul_f32 v[126:127], v[142:143], v[134:135] op_sel:[0,0] op_sel_hi:[1,0]
    v_pk_mul_f32 v[128:129], v[144:145], v[136:137] op_sel:[0,0] op_sel_hi:[1,0]
    v_pk_mul_f32 v[130:131], v[146:147], v[138:139] op_sel:[0,0] op_sel_hi:[1,0]
    v_cvt_pk_bf16_f32 v84, v140, v141
    v_cvt_pk_bf16_f32 v85, v142, v143
    v_cvt_pk_bf16_f32 v86, v144, v145
    v_cvt_pk_bf16_f32 v87, v146, v147
    v_pk_fma_f32 v[124:125], v[140:141], v[132:133], v[124:125] op_sel:[1,1,0] op_sel_hi:[0,1,1] neg_hi:[1,0,0]
    v_pk_fma_f32 v[126:127], v[142:143], v[134:135], v[126:127] op_sel:[1,1,0] op_sel_hi:[0,1,1] neg_hi:[1,0,0]
    v_pk_fma_f32 v[128:129], v[144:145], v[136:137], v[128:129] op_sel:[1,1,0] op_sel_hi:[0,1,1] neg_hi:[1,0,0]
    v_pk_fma_f32 v[130:131], v[146:147], v[138:139], v[130:131] op_sel:[1,1,0] op_sel_hi:[0,1,1] neg_hi:[1,0,0]
    v_cvt_pk_bf16_f32 v172, v124, v125
    v_cvt_pk_bf16_f32 v173, v126, v127
    v_cvt_pk_bf16_f32 v174, v128, v129
    v_cvt_pk_bf16_f32 v175, v130, v131
    v_pk_mul_f32 v[124:125], v[52:53], v[6:7] op_sel:[0,1] op_sel_hi:[1,1]
    v_pk_mul_f32 v[126:127], v[56:57], v[6:7] op_sel:[0,1] op_sel_hi:[1,1]
    v_pk_mul_f32 v[128:129], v[60:61], v[6:7] op_sel:[0,1] op_sel_hi:[1,1]
    v_pk_mul_f32 v[130:131], v[64:65], v[6:7] op_sel:[0,1] op_sel_hi:[1,1]
    v_exp_f32 v124, v124
    v_exp_f32 v126, v126
    v_exp_f32 v128, v128
    v_exp_f32 v130, v130
    v_cos_f32 v132, v125
    v_cos_f32 v134, v127
    v_cos_f32 v136, v129
    v_cos_f32 v138, v131
    v_sin_f32 v133, v125
    v_sin_f32 v135, v127
    v_sin_f32 v137, v129
    v_sin_f32 v139, v131
    v_pk_mul_f32 v[132:133], v[132:133], v[124:125] op_sel:[0,0] op_sel_hi:[1,0]
    v_pk_mul_f32 v[134:135], v[134:135], v[126:127] op_sel:[0,0] op_sel_hi:[1,0]
    v_pk_mul_f32 v[136:137], v[136:137], v[128:129] op_sel:[0,0] op_sel_hi:[1,0]
    v_pk_mul_f32 v[138:139], v[138:139], v[130:131] op_sel:[0,0] op_sel_hi:[1,0]
    v_cvt_pk_bf16_f32 v88, v132, v133
    v_cvt_pk_bf16_f32 v89, v134, v135
    v_cvt_pk_bf16_f32 v90, v136, v137
    v_cvt_pk_bf16_f32 v91, v138, v139
    v_pk_mul_f32 v[124:125], v[52:53], v[8:9] op_sel:[0,0] op_sel_hi:[1,0]
    v_pk_mul_f32 v[126:127], v[56:57], v[8:9] op_sel:[0,0] op_sel_hi:[1,0]
    v_pk_mul_f32 v[128:129], v[60:61], v[8:9] op_sel:[0,0] op_sel_hi:[1,0]
    v_pk_mul_f32 v[130:131], v[64:65], v[8:9] op_sel:[0,0] op_sel_hi:[1,0]
    v_exp_f32 v124, v124
    v_exp_f32 v126, v126
    v_exp_f32 v128, v128
    v_exp_f32 v130, v130
    v_fract_f32 v125, v125
    v_fract_f32 v127, v127
    v_fract_f32 v129, v129
    v_fract_f32 v131, v131
    v_cos_f32 v132, v125
    v_cos_f32 v134, v127
    v_cos_f32 v136, v129
    v_cos_f32 v138, v131
    v_sin_f32 v133, v125
    v_sin_f32 v135, v127
    v_sin_f32 v137, v129
    v_sin_f32 v139, v131
    v_pk_mul_f32 v[132:133], v[132:133], v[124:125] op_sel:[0,0] op_sel_hi:[1,0]
    v_pk_mul_f32 v[134:135], v[134:135], v[126:127] op_sel:[0,0] op_sel_hi:[1,0]
    v_pk_mul_f32 v[136:137], v[136:137], v[128:129] op_sel:[0,0] op_sel_hi:[1,0]
    v_pk_mul_f32 v[138:139], v[138:139], v[130:131] op_sel:[0,0] op_sel_hi:[1,0]
    v_pk_mul_f32 v[140:141], v[132:133], v[132:133] op_sel:[0,0] op_sel_hi:[0,1]
    v_pk_mul_f32 v[142:143], v[134:135], v[134:135] op_sel:[0,0] op_sel_hi:[0,1]
    v_pk_mul_f32 v[144:145], v[136:137], v[136:137] op_sel:[0,0] op_sel_hi:[0,1]
    v_pk_mul_f32 v[146:147], v[138:139], v[138:139] op_sel:[0,0] op_sel_hi:[0,1]
    v_cvt_pk_bf16_f32 v92, v132, v133
    v_cvt_pk_bf16_f32 v93, v134, v135
    v_cvt_pk_bf16_f32 v94, v136, v137
    v_cvt_pk_bf16_f32 v95, v138, v139
    v_pk_fma_f32 v[140:141], v[132:133], v[132:133], v[140:141] op_sel:[1,1,0] op_sel_hi:[0,1,1] neg_lo:[1,0,0]
    v_pk_fma_f32 v[142:143], v[134:135], v[134:135], v[142:143] op_sel:[1,1,0] op_sel_hi:[0,1,1] neg_lo:[1,0,0]
    v_pk_fma_f32 v[144:145], v[136:137], v[136:137], v[144:145] op_sel:[1,1,0] op_sel_hi:[0,1,1] neg_lo:[1,0,0]
    v_pk_fma_f32 v[146:147], v[138:139], v[138:139], v[146:147] op_sel:[1,1,0] op_sel_hi:[0,1,1] neg_lo:[1,0,0]
    v_cvt_pk_bf16_f32 v96, v140, v141
    v_cvt_pk_bf16_f32 v97, v142, v143
    v_cvt_pk_bf16_f32 v98, v144, v145
    v_cvt_pk_bf16_f32 v99, v146, v147
    v_mfma_f32_16x16x32_bf16 v[100:103], v[88:91], v[84:87], 0
    v_mfma_f32_16x16x32_bf16 v[104:107], v[92:95], v[84:87], 0
    v_mfma_f32_16x16x32_bf16 v[108:111], v[96:99], v[172:175], 0
    s_waitcnt lgkmcnt(0)
    ds_read_b128 v[52:55], v5 offset:512
    ds_read_b128 v[56:59], v5 offset:528
    ds_read_b128 v[60:63], v5 offset:544
    ds_read_b128 v[64:67], v5 offset:560
    s_mov_b32 s24, s66
    s_mov_b32 s25, s67
    s_mov_b32 s26, 1152
    s_mov_b32 s27, 0x20000
    v_lshlrev_b32 v169, 3, v3
    buffer_load_dwordx2 v[234:235], v169, s[24:27], 0 offen offset:0
    buffer_load_dwordx2 v[236:237], v169, s[24:27], 0 offen offset:128
    buffer_load_dwordx2 v[238:239], v169, s[24:27], 0 offen offset:256
    buffer_load_dwordx2 v[240:241], v169, s[24:27], 0 offen offset:384
    buffer_load_dwordx2 v[242:243], v169, s[24:27], 0 offen offset:512
    buffer_load_dwordx2 v[244:245], v169, s[24:27], 0 offen offset:640
    buffer_load_dwordx2 v[246:247], v169, s[24:27], 0 offen offset:768
    buffer_load_dwordx2 v[248:249], v169, s[24:27], 0 offen offset:896
    buffer_load_dwordx2 v[250:251], v169, s[24:27], 0 offen offset:1024
    v_pk_mul_f32 v[124:125], v[68:69], v[6:7] op_sel:[0,0] op_sel_hi:[1,0]
    v_pk_mul_f32 v[126:127], v[72:73], v[6:7] op_sel:[0,0] op_sel_hi:[1,0]
    v_pk_mul_f32 v[128:129], v[76:77], v[6:7] op_sel:[0,0] op_sel_hi:[1,0]
    v_pk_mul_f32 v[130:131], v[80:81], v[6:7] op_sel:[0,0] op_sel_hi:[1,0]
    v_exp_f32 v124, v124
    v_exp_f32 v126, v126
    v_exp_f32 v128, v128
    v_exp_f32 v130, v130
    v_cos_f32 v132, v125
    v_cos_f32 v134, v127
    v_cos_f32 v136, v129
    v_cos_f32 v138, v131
    v_sin_f32 v133, v125
    v_sin_f32 v135, v127
    v_sin_f32 v137, v129
    v_sin_f32 v139, v131
    v_pk_mul_f32 v[132:133], v[132:133], v[124:125] op_sel:[0,0] op_sel_hi:[1,0]
    v_pk_mul_f32 v[134:135], v[134:135], v[126:127] op_sel:[0,0] op_sel_hi:[1,0]
    v_pk_mul_f32 v[136:137], v[136:137], v[128:129] op_sel:[0,0] op_sel_hi:[1,0]
    v_pk_mul_f32 v[138:139], v[138:139], v[130:131] op_sel:[0,0] op_sel_hi:[1,0]
    v_pk_mul_f32 v[140:141], v[132:133], v[70:71] op_sel:[0,0] op_sel_hi:[0,1]
    v_pk_mul_f32 v[142:143], v[134:135], v[74:75] op_sel:[0,0] op_sel_hi:[0,1]
    v_pk_mul_f32 v[144:145], v[136:137], v[78:79] op_sel:[0,0] op_sel_hi:[0,1]
    v_pk_mul_f32 v[146:147], v[138:139], v[82:83] op_sel:[0,0] op_sel_hi:[0,1]
    v_pk_fma_f32 v[140:141], v[132:133], v[70:71], v[140:141] op_sel:[1,1,0] op_sel_hi:[1,0,1] neg_lo:[1,0,0] neg_hi:[1,0,1]
    v_pk_fma_f32 v[142:143], v[134:135], v[74:75], v[142:143] op_sel:[1,1,0] op_sel_hi:[1,0,1] neg_lo:[1,0,0] neg_hi:[1,0,1]
    v_pk_fma_f32 v[144:145], v[136:137], v[78:79], v[144:145] op_sel:[1,1,0] op_sel_hi:[1,0,1] neg_lo:[1,0,0] neg_hi:[1,0,1]
    v_pk_fma_f32 v[146:147], v[138:139], v[82:83], v[146:147] op_sel:[1,1,0] op_sel_hi:[1,0,1] neg_lo:[1,0,0] neg_hi:[1,0,1]
    v_pk_mul_f32 v[124:125], v[140:141], v[132:133] op_sel:[0,0] op_sel_hi:[1,0]
    v_pk_mul_f32 v[126:127], v[142:143], v[134:135] op_sel:[0,0] op_sel_hi:[1,0]
    v_pk_mul_f32 v[128:129], v[144:145], v[136:137] op_sel:[0,0] op_sel_hi:[1,0]
    v_pk_mul_f32 v[130:131], v[146:147], v[138:139] op_sel:[0,0] op_sel_hi:[1,0]
    v_cvt_pk_bf16_f32 v84, v140, v141
    v_cvt_pk_bf16_f32 v85, v142, v143
    v_cvt_pk_bf16_f32 v86, v144, v145
    v_cvt_pk_bf16_f32 v87, v146, v147
    v_pk_fma_f32 v[124:125], v[140:141], v[132:133], v[124:125] op_sel:[1,1,0] op_sel_hi:[0,1,1] neg_hi:[1,0,0]
    v_pk_fma_f32 v[126:127], v[142:143], v[134:135], v[126:127] op_sel:[1,1,0] op_sel_hi:[0,1,1] neg_hi:[1,0,0]
    v_pk_fma_f32 v[128:129], v[144:145], v[136:137], v[128:129] op_sel:[1,1,0] op_sel_hi:[0,1,1] neg_hi:[1,0,0]
    v_pk_fma_f32 v[130:131], v[146:147], v[138:139], v[130:131] op_sel:[1,1,0] op_sel_hi:[0,1,1] neg_hi:[1,0,0]
    v_cvt_pk_bf16_f32 v172, v124, v125
    v_cvt_pk_bf16_f32 v173, v126, v127
    v_cvt_pk_bf16_f32 v174, v128, v129
    v_cvt_pk_bf16_f32 v175, v130, v131
    v_pk_mul_f32 v[124:125], v[68:69], v[6:7] op_sel:[0,1] op_sel_hi:[1,1]
    v_pk_mul_f32 v[126:127], v[72:73], v[6:7] op_sel:[0,1] op_sel_hi:[1,1]
    v_pk_mul_f32 v[128:129], v[76:77], v[6:7] op_sel:[0,1] op_sel_hi:[1,1]
    v_pk_mul_f32 v[130:131], v[80:81], v[6:7] op_sel:[0,1] op_sel_hi:[1,1]
    v_exp_f32 v124, v124
    v_exp_f32 v126, v126
    v_exp_f32 v128, v128
    v_exp_f32 v130, v130
    v_cos_f32 v132, v125
    v_cos_f32 v134, v127
    v_cos_f32 v136, v129
    v_cos_f32 v138, v131
    v_sin_f32 v133, v125
    v_sin_f32 v135, v127
    v_sin_f32 v137, v129
    v_sin_f32 v139, v131
    v_pk_mul_f32 v[132:133], v[132:133], v[124:125] op_sel:[0,0] op_sel_hi:[1,0]
    v_pk_mul_f32 v[134:135], v[134:135], v[126:127] op_sel:[0,0] op_sel_hi:[1,0]
    v_pk_mul_f32 v[136:137], v[136:137], v[128:129] op_sel:[0,0] op_sel_hi:[1,0]
    v_pk_mul_f32 v[138:139], v[138:139], v[130:131] op_sel:[0,0] op_sel_hi:[1,0]
    v_cvt_pk_bf16_f32 v88, v132, v133
    v_cvt_pk_bf16_f32 v89, v134, v135
    v_cvt_pk_bf16_f32 v90, v136, v137
    v_cvt_pk_bf16_f32 v91, v138, v139
    v_pk_mul_f32 v[124:125], v[68:69], v[8:9] op_sel:[0,0] op_sel_hi:[1,0]
    v_pk_mul_f32 v[126:127], v[72:73], v[8:9] op_sel:[0,0] op_sel_hi:[1,0]
    v_pk_mul_f32 v[128:129], v[76:77], v[8:9] op_sel:[0,0] op_sel_hi:[1,0]
    v_pk_mul_f32 v[130:131], v[80:81], v[8:9] op_sel:[0,0] op_sel_hi:[1,0]
    v_exp_f32 v124, v124
    v_exp_f32 v126, v126
    v_exp_f32 v128, v128
    v_exp_f32 v130, v130
    v_fract_f32 v125, v125
    v_fract_f32 v127, v127
    v_fract_f32 v129, v129
    v_fract_f32 v131, v131
    v_cos_f32 v132, v125
    v_cos_f32 v134, v127
    v_cos_f32 v136, v129
    v_cos_f32 v138, v131
    v_sin_f32 v133, v125
    v_sin_f32 v135, v127
    v_sin_f32 v137, v129
    v_sin_f32 v139, v131
    v_pk_mul_f32 v[132:133], v[132:133], v[124:125] op_sel:[0,0] op_sel_hi:[1,0]
    v_pk_mul_f32 v[134:135], v[134:135], v[126:127] op_sel:[0,0] op_sel_hi:[1,0]
    v_pk_mul_f32 v[136:137], v[136:137], v[128:129] op_sel:[0,0] op_sel_hi:[1,0]
    v_pk_mul_f32 v[138:139], v[138:139], v[130:131] op_sel:[0,0] op_sel_hi:[1,0]
    v_pk_mul_f32 v[140:141], v[132:133], v[132:133] op_sel:[0,0] op_sel_hi:[0,1]
    v_pk_mul_f32 v[142:143], v[134:135], v[134:135] op_sel:[0,0] op_sel_hi:[0,1]
    v_pk_mul_f32 v[144:145], v[136:137], v[136:137] op_sel:[0,0] op_sel_hi:[0,1]
    v_pk_mul_f32 v[146:147], v[138:139], v[138:139] op_sel:[0,0] op_sel_hi:[0,1]
    v_cvt_pk_bf16_f32 v92, v132, v133
    v_cvt_pk_bf16_f32 v93, v134, v135
    v_cvt_pk_bf16_f32 v94, v136, v137
    v_cvt_pk_bf16_f32 v95, v138, v139
    v_pk_fma_f32 v[140:141], v[132:133], v[132:133], v[140:141] op_sel:[1,1,0] op_sel_hi:[0,1,1] neg_lo:[1,0,0]
    v_pk_fma_f32 v[142:143], v[134:135], v[134:135], v[142:143] op_sel:[1,1,0] op_sel_hi:[0,1,1] neg_lo:[1,0,0]
    v_pk_fma_f32 v[144:145], v[136:137], v[136:137], v[144:145] op_sel:[1,1,0] op_sel_hi:[0,1,1] neg_lo:[1,0,0]
    v_pk_fma_f32 v[146:147], v[138:139], v[138:139], v[146:147] op_sel:[1,1,0] op_sel_hi:[0,1,1] neg_lo:[1,0,0]
    v_cvt_pk_bf16_f32 v96, v140, v141
    v_cvt_pk_bf16_f32 v97, v142, v143
    v_cvt_pk_bf16_f32 v98, v144, v145
    v_cvt_pk_bf16_f32 v99, v146, v147
    v_mfma_f32_16x16x32_bf16 v[100:103], v[88:91], v[84:87], v[100:103]
    v_mfma_f32_16x16x32_bf16 v[104:107], v[92:95], v[84:87], v[104:107]
    v_mfma_f32_16x16x32_bf16 v[108:111], v[96:99], v[172:175], v[108:111]
    s_waitcnt lgkmcnt(0)
    ds_read_b128 v[68:71], v5 offset:768
    ds_read_b128 v[72:75], v5 offset:784
    ds_read_b128 v[76:79], v5 offset:800
    ds_read_b128 v[80:83], v5 offset:816
    s_waitcnt vmcnt(9)
    s_barrier
    ds_read_b64 v[216:217], v27 offset:0
    ds_read_b64 v[218:219], v27 offset:128
    ds_read_b64 v[220:221], v27 offset:256
    ds_read_b64 v[222:223], v27 offset:384
    ds_read_b64 v[224:225], v27 offset:512
    ds_read_b64 v[226:227], v27 offset:640
    ds_read_b64 v[228:229], v27 offset:768
    ds_read_b64 v[230:231], v27 offset:896
    ds_read_b64 v[232:233], v27 offset:1024
    ds_read_b64_tr_b16 v[148:149], v25 offset:4608
    ds_read_b64_tr_b16 v[150:151], v25 offset:0
    ds_read_b64_tr_b16 v[152:153], v25 offset:4864
    ds_read_b64_tr_b16 v[154:155], v25 offset:256
    s_waitcnt lgkmcnt(2)
    s_mov_b32 s3, 0
    buffer_store_dwordx4 v[148:151], v26, s[8:11], s3 offen sc1
    ds_read_b64_tr_b16 v[156:157], v25 offset:5120
    ds_read_b64_tr_b16 v[158:159], v25 offset:512
    s_waitcnt lgkmcnt(2)
    s_mov_b32 s3, 8192
    buffer_store_dwordx4 v[152:155], v26, s[8:11], s3 offen sc1
    ds_read_b64_tr_b16 v[160:161], v25 offset:5376
    ds_read_b64_tr_b16 v[162:163], v25 offset:768
    s_waitcnt lgkmcnt(2)
    s_mov_b32 s3, 16384
    buffer_store_dwordx4 v[156:159], v26, s[8:11], s3 offen sc1
    ds_read_b64_tr_b16 v[164:165], v25 offset:5632
    ds_read_b64_tr_b16 v[166:167], v25 offset:1024
    s_waitcnt lgkmcnt(2)
    s_mov_b32 s3, 24576
    buffer_store_dwordx4 v[160:163], v26, s[8:11], s3 offen sc1
    s_waitcnt lgkmcnt(0)
    v_mov_b32 v124, 0
    s_add_u32 s3, s98, 16384
    s_mov_b64 exec, 0xff
    buffer_store_dword v124, v24, s[16:19], s3 offen sc1
    s_mov_b64 exec, -1
    s_mov_b32 s3, 32768
    buffer_store_dwordx4 v[164:167], v26, s[8:11], s3 offen sc1
    v_pk_mul_f32 v[124:125], v[52:53], v[6:7] op_sel:[0,0] op_sel_hi:[1,0]
    v_pk_mul_f32 v[126:127], v[56:57], v[6:7] op_sel:[0,0] op_sel_hi:[1,0]
    v_pk_mul_f32 v[128:129], v[60:61], v[6:7] op_sel:[0,0] op_sel_hi:[1,0]
    v_pk_mul_f32 v[130:131], v[64:65], v[6:7] op_sel:[0,0] op_sel_hi:[1,0]
    v_exp_f32 v124, v124
    v_exp_f32 v126, v126
    v_exp_f32 v128, v128
    v_exp_f32 v130, v130
    v_cos_f32 v132, v125
    v_cos_f32 v134, v127
    v_cos_f32 v136, v129
    v_cos_f32 v138, v131
    v_sin_f32 v133, v125
    v_sin_f32 v135, v127
    v_sin_f32 v137, v129
    v_sin_f32 v139, v131
    v_pk_mul_f32 v[132:133], v[132:133], v[124:125] op_sel:[0,0] op_sel_hi:[1,0]
    v_pk_mul_f32 v[134:135], v[134:135], v[126:127] op_sel:[0,0] op_sel_hi:[1,0]
    v_pk_mul_f32 v[136:137], v[136:137], v[128:129] op_sel:[0,0] op_sel_hi:[1,0]
    v_pk_mul_f32 v[138:139], v[138:139], v[130:131] op_sel:[0,0] op_sel_hi:[1,0]
    v_pk_mul_f32 v[140:141], v[132:133], v[54:55] op_sel:[0,0] op_sel_hi:[0,1]
    v_pk_mul_f32 v[142:143], v[134:135], v[58:59] op_sel:[0,0] op_sel_hi:[0,1]
    v_pk_mul_f32 v[144:145], v[136:137], v[62:63] op_sel:[0,0] op_sel_hi:[0,1]
    v_pk_mul_f32 v[146:147], v[138:139], v[66:67] op_sel:[0,0] op_sel_hi:[0,1]
    v_pk_fma_f32 v[140:141], v[132:133], v[54:55], v[140:141] op_sel:[1,1,0] op_sel_hi:[1,0,1] neg_lo:[1,0,0] neg_hi:[1,0,1]
    v_pk_fma_f32 v[142:143], v[134:135], v[58:59], v[142:143] op_sel:[1,1,0] op_sel_hi:[1,0,1] neg_lo:[1,0,0] neg_hi:[1,0,1]
    v_pk_fma_f32 v[144:145], v[136:137], v[62:63], v[144:145] op_sel:[1,1,0] op_sel_hi:[1,0,1] neg_lo:[1,0,0] neg_hi:[1,0,1]
    v_pk_fma_f32 v[146:147], v[138:139], v[66:67], v[146:147] op_sel:[1,1,0] op_sel_hi:[1,0,1] neg_lo:[1,0,0] neg_hi:[1,0,1]
    v_pk_mul_f32 v[124:125], v[140:141], v[132:133] op_sel:[0,0] op_sel_hi:[1,0]
    v_pk_mul_f32 v[126:127], v[142:143], v[134:135] op_sel:[0,0] op_sel_hi:[1,0]
    v_pk_mul_f32 v[128:129], v[144:145], v[136:137] op_sel:[0,0] op_sel_hi:[1,0]
    v_pk_mul_f32 v[130:131], v[146:147], v[138:139] op_sel:[0,0] op_sel_hi:[1,0]
    v_cvt_pk_bf16_f32 v84, v140, v141
    v_cvt_pk_bf16_f32 v85, v142, v143
    v_cvt_pk_bf16_f32 v86, v144, v145
    v_cvt_pk_bf16_f32 v87, v146, v147
    v_pk_fma_f32 v[124:125], v[140:141], v[132:133], v[124:125] op_sel:[1,1,0] op_sel_hi:[0,1,1] neg_hi:[1,0,0]
    v_pk_fma_f32 v[126:127], v[142:143], v[134:135], v[126:127] op_sel:[1,1,0] op_sel_hi:[0,1,1] neg_hi:[1,0,0]
    v_pk_fma_f32 v[128:129], v[144:145], v[136:137], v[128:129] op_sel:[1,1,0] op_sel_hi:[0,1,1] neg_hi:[1,0,0]
    v_pk_fma_f32 v[130:131], v[146:147], v[138:139], v[130:131] op_sel:[1,1,0] op_sel_hi:[0,1,1] neg_hi:[1,0,0]
    v_cvt_pk_bf16_f32 v172, v124, v125
    v_cvt_pk_bf16_f32 v173, v126, v127
    v_cvt_pk_bf16_f32 v174, v128, v129
    v_cvt_pk_bf16_f32 v175, v130, v131
    v_pk_mul_f32 v[124:125], v[52:53], v[6:7] op_sel:[0,1] op_sel_hi:[1,1]
    v_pk_mul_f32 v[126:127], v[56:57], v[6:7] op_sel:[0,1] op_sel_hi:[1,1]
    v_pk_mul_f32 v[128:129], v[60:61], v[6:7] op_sel:[0,1] op_sel_hi:[1,1]
    v_pk_mul_f32 v[130:131], v[64:65], v[6:7] op_sel:[0,1] op_sel_hi:[1,1]
    v_exp_f32 v124, v124
    v_exp_f32 v126, v126
    v_exp_f32 v128, v128
    v_exp_f32 v130, v130
    v_cos_f32 v132, v125
    v_cos_f32 v134, v127
    v_cos_f32 v136, v129
    v_cos_f32 v138, v131
    v_sin_f32 v133, v125
    v_sin_f32 v135, v127
    v_sin_f32 v137, v129
    v_sin_f32 v139, v131
    v_pk_mul_f32 v[132:133], v[132:133], v[124:125] op_sel:[0,0] op_sel_hi:[1,0]
    v_pk_mul_f32 v[134:135], v[134:135], v[126:127] op_sel:[0,0] op_sel_hi:[1,0]
    v_pk_mul_f32 v[136:137], v[136:137], v[128:129] op_sel:[0,0] op_sel_hi:[1,0]
    v_pk_mul_f32 v[138:139], v[138:139], v[130:131] op_sel:[0,0] op_sel_hi:[1,0]
    v_cvt_pk_bf16_f32 v88, v132, v133
    v_cvt_pk_bf16_f32 v89, v134, v135
    v_cvt_pk_bf16_f32 v90, v136, v137
    v_cvt_pk_bf16_f32 v91, v138, v139
    v_pk_mul_f32 v[124:125], v[52:53], v[8:9] op_sel:[0,0] op_sel_hi:[1,0]
    v_pk_mul_f32 v[126:127], v[56:57], v[8:9] op_sel:[0,0] op_sel_hi:[1,0]
    v_pk_mul_f32 v[128:129], v[60:61], v[8:9] op_sel:[0,0] op_sel_hi:[1,0]
    v_pk_mul_f32 v[130:131], v[64:65], v[8:9] op_sel:[0,0] op_sel_hi:[1,0]
    v_exp_f32 v124, v124
    v_exp_f32 v126, v126
    v_exp_f32 v128, v128
    v_exp_f32 v130, v130
    v_fract_f32 v125, v125
    v_fract_f32 v127, v127
    v_fract_f32 v129, v129
    v_fract_f32 v131, v131
    v_cos_f32 v132, v125
    v_cos_f32 v134, v127
    v_cos_f32 v136, v129
    v_cos_f32 v138, v131
    v_sin_f32 v133, v125
    v_sin_f32 v135, v127
    v_sin_f32 v137, v129
    v_sin_f32 v139, v131
    v_pk_mul_f32 v[132:133], v[132:133], v[124:125] op_sel:[0,0] op_sel_hi:[1,0]
    v_pk_mul_f32 v[134:135], v[134:135], v[126:127] op_sel:[0,0] op_sel_hi:[1,0]
    v_pk_mul_f32 v[136:137], v[136:137], v[128:129] op_sel:[0,0] op_sel_hi:[1,0]
    v_pk_mul_f32 v[138:139], v[138:139], v[130:131] op_sel:[0,0] op_sel_hi:[1,0]
    v_pk_mul_f32 v[140:141], v[132:133], v[132:133] op_sel:[0,0] op_sel_hi:[0,1]
    v_pk_mul_f32 v[142:143], v[134:135], v[134:135] op_sel:[0,0] op_sel_hi:[0,1]
    v_pk_mul_f32 v[144:145], v[136:137], v[136:137] op_sel:[0,0] op_sel_hi:[0,1]
    v_pk_mul_f32 v[146:147], v[138:139], v[138:139] op_sel:[0,0] op_sel_hi:[0,1]
    v_cvt_pk_bf16_f32 v92, v132, v133
    v_cvt_pk_bf16_f32 v93, v134, v135
    v_cvt_pk_bf16_f32 v94, v136, v137
    v_cvt_pk_bf16_f32 v95, v138, v139
    v_pk_fma_f32 v[140:141], v[132:133], v[132:133], v[140:141] op_sel:[1,1,0] op_sel_hi:[0,1,1] neg_lo:[1,0,0]
    v_pk_fma_f32 v[142:143], v[134:135], v[134:135], v[142:143] op_sel:[1,1,0] op_sel_hi:[0,1,1] neg_lo:[1,0,0]
    v_pk_fma_f32 v[144:145], v[136:137], v[136:137], v[144:145] op_sel:[1,1,0] op_sel_hi:[0,1,1] neg_lo:[1,0,0]
    v_pk_fma_f32 v[146:147], v[138:139], v[138:139], v[146:147] op_sel:[1,1,0] op_sel_hi:[0,1,1] neg_lo:[1,0,0]
    v_cvt_pk_bf16_f32 v96, v140, v141
    v_cvt_pk_bf16_f32 v97, v142, v143
    v_cvt_pk_bf16_f32 v98, v144, v145
    v_cvt_pk_bf16_f32 v99, v146, v147
    v_mfma_f32_16x16x32_bf16 v[100:103], v[88:91], v[84:87], v[100:103]
    v_mfma_f32_16x16x32_bf16 v[104:107], v[92:95], v[84:87], v[104:107]
    v_mfma_f32_16x16x32_bf16 v[108:111], v[96:99], v[172:175], v[108:111]
    s_waitcnt lgkmcnt(0)
    ds_read_b128 v[52:55], v5 offset:1024
    ds_read_b128 v[56:59], v5 offset:1040
    ds_read_b128 v[60:63], v5 offset:1056
    ds_read_b128 v[64:67], v5 offset:1072
    s_waitcnt vmcnt(0)
    s_barrier
    s_cmp_lg_u32 s28, 0
    s_cbranch_scc1 L_cnt775
    v_mov_b32 v124, 1
    s_mov_b64 exec, 1
    buffer_atomic_add v124, off, s[20:23], 0 offset:64 sc1
    s_mov_b64 exec, -1
L_cnt775:
    v_mov_b32 v128, 0
    v_mov_b32 v129, 0
    v_mov_b32 v130, 0
    v_mov_b32 v131, 0
    v_cmp_gt_u32 vcc, 32, v0
    s_mul_i32 s3, s28, 4608
    v_mov_b32 v126, 36352
    v_mov_b32 v127, s3
    v_cndmask_b32 v126, v126, v127, vcc
    v_lshl_add_u32 v126, v0, 4, v126
    ds_write_b128 v126, v[128:131] offset:0
    v_pk_mul_f32 v[124:125], v[68:69], v[6:7] op_sel:[0,0] op_sel_hi:[1,0]
    v_pk_mul_f32 v[126:127], v[72:73], v[6:7] op_sel:[0,0] op_sel_hi:[1,0]
    v_pk_mul_f32 v[128:129], v[76:77], v[6:7] op_sel:[0,0] op_sel_hi:[1,0]
    v_pk_mul_f32 v[130:131], v[80:81], v[6:7] op_sel:[0,0] op_sel_hi:[1,0]
    v_exp_f32 v124, v124
    v_exp_f32 v126, v126
    v_exp_f32 v128, v128
    v_exp_f32 v130, v130
    v_cos_f32 v132, v125
    v_cos_f32 v134, v127
    v_cos_f32 v136, v129
    v_cos_f32 v138, v131
    v_sin_f32 v133, v125
    v_sin_f32 v135, v127
    v_sin_f32 v137, v129
    v_sin_f32 v139, v131
    v_pk_mul_f32 v[132:133], v[132:133], v[124:125] op_sel:[0,0] op_sel_hi:[1,0]
    v_pk_mul_f32 v[134:135], v[134:135], v[126:127] op_sel:[0,0] op_sel_hi:[1,0]
    v_pk_mul_f32 v[136:137], v[136:137], v[128:129] op_sel:[0,0] op_sel_hi:[1,0]
    v_pk_mul_f32 v[138:139], v[138:139], v[130:131] op_sel:[0,0] op_sel_hi:[1,0]
    v_pk_mul_f32 v[140:141], v[132:133], v[70:71] op_sel:[0,0] op_sel_hi:[0,1]
    v_pk_mul_f32 v[142:143], v[134:135], v[74:75] op_sel:[0,0] op_sel_hi:[0,1]
    v_pk_mul_f32 v[144:145], v[136:137], v[78:79] op_sel:[0,0] op_sel_hi:[0,1]
    v_pk_mul_f32 v[146:147], v[138:139], v[82:83] op_sel:[0,0] op_sel_hi:[0,1]
    v_pk_fma_f32 v[140:141], v[132:133], v[70:71], v[140:141] op_sel:[1,1,0] op_sel_hi:[1,0,1] neg_lo:[1,0,0] neg_hi:[1,0,1]
    v_pk_fma_f32 v[142:143], v[134:135], v[74:75], v[142:143] op_sel:[1,1,0] op_sel_hi:[1,0,1] neg_lo:[1,0,0] neg_hi:[1,0,1]
    v_pk_fma_f32 v[144:145], v[136:137], v[78:79], v[144:145] op_sel:[1,1,0] op_sel_hi:[1,0,1] neg_lo:[1,0,0] neg_hi:[1,0,1]
    v_pk_fma_f32 v[146:147], v[138:139], v[82:83], v[146:147] op_sel:[1,1,0] op_sel_hi:[1,0,1] neg_lo:[1,0,0] neg_hi:[1,0,1]
    v_pk_mul_f32 v[124:125], v[140:141], v[132:133] op_sel:[0,0] op_sel_hi:[1,0]
    v_pk_mul_f32 v[126:127], v[142:143], v[134:135] op_sel:[0,0] op_sel_hi:[1,0]
    v_pk_mul_f32 v[128:129], v[144:145], v[136:137] op_sel:[0,0] op_sel_hi:[1,0]
    v_pk_mul_f32 v[130:131], v[146:147], v[138:139] op_sel:[0,0] op_sel_hi:[1,0]
    v_cvt_pk_bf16_f32 v84, v140, v141
    v_cvt_pk_bf16_f32 v85, v142, v143
    v_cvt_pk_bf16_f32 v86, v144, v145
    v_cvt_pk_bf16_f32 v87, v146, v147
    v_pk_fma_f32 v[124:125], v[140:141], v[132:133], v[124:125] op_sel:[1,1,0] op_sel_hi:[0,1,1] neg_hi:[1,0,0]
    v_pk_fma_f32 v[126:127], v[142:143], v[134:135], v[126:127] op_sel:[1,1,0] op_sel_hi:[0,1,1] neg_hi:[1,0,0]
    v_pk_fma_f32 v[128:129], v[144:145], v[136:137], v[128:129] op_sel:[1,1,0] op_sel_hi:[0,1,1] neg_hi:[1,0,0]
    v_pk_fma_f32 v[130:131], v[146:147], v[138:139], v[130:131] op_sel:[1,1,0] op_sel_hi:[0,1,1] neg_hi:[1,0,0]
    v_cvt_pk_bf16_f32 v172, v124, v125
    v_cvt_pk_bf16_f32 v173, v126, v127
    v_cvt_pk_bf16_f32 v174, v128, v129
    v_cvt_pk_bf16_f32 v175, v130, v131
    v_pk_mul_f32 v[124:125], v[68:69], v[6:7] op_sel:[0,1] op_sel_hi:[1,1]
    v_pk_mul_f32 v[126:127], v[72:73], v[6:7] op_sel:[0,1] op_sel_hi:[1,1]
    v_pk_mul_f32 v[128:129], v[76:77], v[6:7] op_sel:[0,1] op_sel_hi:[1,1]
    v_pk_mul_f32 v[130:131], v[80:81], v[6:7] op_sel:[0,1] op_sel_hi:[1,1]
    v_exp_f32 v124, v124
    v_exp_f32 v126, v126
    v_exp_f32 v128, v128
    v_exp_f32 v130, v130
    v_cos_f32 v132, v125
    v_cos_f32 v134, v127
    v_cos_f32 v136, v129
    v_cos_f32 v138, v131
    v_sin_f32 v133, v125
    v_sin_f32 v135, v127
    v_sin_f32 v137, v129
    v_sin_f32 v139, v131
    v_pk_mul_f32 v[132:133], v[132:133], v[124:125] op_sel:[0,0] op_sel_hi:[1,0]
    v_pk_mul_f32 v[134:135], v[134:135], v[126:127] op_sel:[0,0] op_sel_hi:[1,0]
    v_pk_mul_f32 v[136:137], v[136:137], v[128:129] op_sel:[0,0] op_sel_hi:[1,0]
    v_pk_mul_f32 v[138:139], v[138:139], v[130:131] op_sel:[0,0] op_sel_hi:[1,0]
    v_cvt_pk_bf16_f32 v88, v132, v133
    v_cvt_pk_bf16_f32 v89, v134, v135
    v_cvt_pk_bf16_f32 v90, v136, v137
    v_cvt_pk_bf16_f32 v91, v138, v139
    v_pk_mul_f32 v[124:125], v[68:69], v[8:9] op_sel:[0,0] op_sel_hi:[1,0]
    v_pk_mul_f32 v[126:127], v[72:73], v[8:9] op_sel:[0,0] op_sel_hi:[1,0]
    v_pk_mul_f32 v[128:129], v[76:77], v[8:9] op_sel:[0,0] op_sel_hi:[1,0]
    v_pk_mul_f32 v[130:131], v[80:81], v[8:9] op_sel:[0,0] op_sel_hi:[1,0]
    v_exp_f32 v124, v124
    v_exp_f32 v126, v126
    v_exp_f32 v128, v128
    v_exp_f32 v130, v130
    v_fract_f32 v125, v125
    v_fract_f32 v127, v127
    v_fract_f32 v129, v129
    v_fract_f32 v131, v131
    v_cos_f32 v132, v125
    v_cos_f32 v134, v127
    v_cos_f32 v136, v129
    v_cos_f32 v138, v131
    v_sin_f32 v133, v125
    v_sin_f32 v135, v127
    v_sin_f32 v137, v129
    v_sin_f32 v139, v131
    v_pk_mul_f32 v[132:133], v[132:133], v[124:125] op_sel:[0,0] op_sel_hi:[1,0]
    v_pk_mul_f32 v[134:135], v[134:135], v[126:127] op_sel:[0,0] op_sel_hi:[1,0]
    v_pk_mul_f32 v[136:137], v[136:137], v[128:129] op_sel:[0,0] op_sel_hi:[1,0]
    v_pk_mul_f32 v[138:139], v[138:139], v[130:131] op_sel:[0,0] op_sel_hi:[1,0]
    v_pk_mul_f32 v[140:141], v[132:133], v[132:133] op_sel:[0,0] op_sel_hi:[0,1]
    v_pk_mul_f32 v[142:143], v[134:135], v[134:135] op_sel:[0,0] op_sel_hi:[0,1]
    v_pk_mul_f32 v[144:145], v[136:137], v[136:137] op_sel:[0,0] op_sel_hi:[0,1]
    v_pk_mul_f32 v[146:147], v[138:139], v[138:139] op_sel:[0,0] op_sel_hi:[0,1]
    v_cvt_pk_bf16_f32 v92, v132, v133
    v_cvt_pk_bf16_f32 v93, v134, v135
    v_cvt_pk_bf16_f32 v94, v136, v137
    v_cvt_pk_bf16_f32 v95, v138, v139
    v_pk_fma_f32 v[140:141], v[132:133], v[132:133], v[140:141] op_sel:[1,1,0] op_sel_hi:[0,1,1] neg_lo:[1,0,0]
    v_pk_fma_f32 v[142:143], v[134:135], v[134:135], v[142:143] op_sel:[1,1,0] op_sel_hi:[0,1,1] neg_lo:[1,0,0]
    v_pk_fma_f32 v[144:145], v[136:137], v[136:137], v[144:145] op_sel:[1,1,0] op_sel_hi:[0,1,1] neg_lo:[1,0,0]
    v_pk_fma_f32 v[146:147], v[138:139], v[138:139], v[146:147] op_sel:[1,1,0] op_sel_hi:[0,1,1] neg_lo:[1,0,0]
    v_cvt_pk_bf16_f32 v96, v140, v141
    v_cvt_pk_bf16_f32 v97, v142, v143
    v_cvt_pk_bf16_f32 v98, v144, v145
    v_cvt_pk_bf16_f32 v99, v146, v147
    v_mfma_f32_16x16x32_bf16 v[100:103], v[88:91], v[84:87], v[100:103]
    v_mfma_f32_16x16x32_bf16 v[104:107], v[92:95], v[84:87], v[104:107]
    v_mfma_f32_16x16x32_bf16 v[108:111], v[96:99], v[172:175], v[108:111]
    s_waitcnt lgkmcnt(0)
    ds_read_b128 v[68:71], v5 offset:1280
    ds_read_b128 v[72:75], v5 offset:1296
    ds_read_b128 v[76:79], v5 offset:1312
    ds_read_b128 v[80:83], v5 offset:1328
    v_min_u32 v28, 3455, v28
    v_mul_u32_u24 v124, 87382, v28
    v_lshrrev_b32 v124, 18, v124
    v_mul_u32_u24 v124, 768, v124
    v_lshl_add_u32 v28, v28, 7, v124
    buffer_load_dword v2, v28, s[12:15], 0 offen offset:0
    v_pk_mul_f32 v[124:125], v[52:53], v[6:7] op_sel:[0,0] op_sel_hi:[1,0]
    v_pk_mul_f32 v[126:127], v[56:57], v[6:7] op_sel:[0,0] op_sel_hi:[1,0]
    v_pk_mul_f32 v[128:129], v[60:61], v[6:7] op_sel:[0,0] op_sel_hi:[1,0]
    v_pk_mul_f32 v[130:131], v[64:65], v[6:7] op_sel:[0,0] op_sel_hi:[1,0]
    v_exp_f32 v124, v124
    v_exp_f32 v126, v126
    v_exp_f32 v128, v128
    v_exp_f32 v130, v130
    v_cos_f32 v132, v125
    v_cos_f32 v134, v127
    v_cos_f32 v136, v129
    v_cos_f32 v138, v131
    v_sin_f32 v133, v125
    v_sin_f32 v135, v127
    v_sin_f32 v137, v129
    v_sin_f32 v139, v131
    v_pk_mul_f32 v[132:133], v[132:133], v[124:125] op_sel:[0,0] op_sel_hi:[1,0]
    v_pk_mul_f32 v[134:135], v[134:135], v[126:127] op_sel:[0,0] op_sel_hi:[1,0]
    v_pk_mul_f32 v[136:137], v[136:137], v[128:129] op_sel:[0,0] op_sel_hi:[1,0]
    v_pk_mul_f32 v[138:139], v[138:139], v[130:131] op_sel:[0,0] op_sel_hi:[1,0]
    v_pk_mul_f32 v[140:141], v[132:133], v[54:55] op_sel:[0,0] op_sel_hi:[0,1]
    v_pk_mul_f32 v[142:143], v[134:135], v[58:59] op_sel:[0,0] op_sel_hi:[0,1]
    v_pk_mul_f32 v[144:145], v[136:137], v[62:63] op_sel:[0,0] op_sel_hi:[0,1]
    v_pk_mul_f32 v[146:147], v[138:139], v[66:67] op_sel:[0,0] op_sel_hi:[0,1]
    v_pk_fma_f32 v[140:141], v[132:133], v[54:55], v[140:141] op_sel:[1,1,0] op_sel_hi:[1,0,1] neg_lo:[1,0,0] neg_hi:[1,0,1]
    v_pk_fma_f32 v[142:143], v[134:135], v[58:59], v[142:143] op_sel:[1,1,0] op_sel_hi:[1,0,1] neg_lo:[1,0,0] neg_hi:[1,0,1]
    v_pk_fma_f32 v[144:145], v[136:137], v[62:63], v[144:145] op_sel:[1,1,0] op_sel_hi:[1,0,1] neg_lo:[1,0,0] neg_hi:[1,0,1]
    v_pk_fma_f32 v[146:147], v[138:139], v[66:67], v[146:147] op_sel:[1,1,0] op_sel_hi:[1,0,1] neg_lo:[1,0,0] neg_hi:[1,0,1]
    v_pk_mul_f32 v[124:125], v[140:141], v[132:133] op_sel:[0,0] op_sel_hi:[1,0]
    v_pk_mul_f32 v[126:127], v[142:143], v[134:135] op_sel:[0,0] op_sel_hi:[1,0]
    v_pk_mul_f32 v[128:129], v[144:145], v[136:137] op_sel:[0,0] op_sel_hi:[1,0]
    v_pk_mul_f32 v[130:131], v[146:147], v[138:139] op_sel:[0,0] op_sel_hi:[1,0]
    v_cvt_pk_bf16_f32 v84, v140, v141
    v_cvt_pk_bf16_f32 v85, v142, v143
    v_cvt_pk_bf16_f32 v86, v144, v145
    v_cvt_pk_bf16_f32 v87, v146, v147
    v_pk_fma_f32 v[124:125], v[140:141], v[132:133], v[124:125] op_sel:[1,1,0] op_sel_hi:[0,1,1] neg_hi:[1,0,0]
    v_pk_fma_f32 v[126:127], v[142:143], v[134:135], v[126:127] op_sel:[1,1,0] op_sel_hi:[0,1,1] neg_hi:[1,0,0]
    v_pk_fma_f32 v[128:129], v[144:145], v[136:137], v[128:129] op_sel:[1,1,0] op_sel_hi:[0,1,1] neg_hi:[1,0,0]
    v_pk_fma_f32 v[130:131], v[146:147], v[138:139], v[130:131] op_sel:[1,1,0] op_sel_hi:[0,1,1] neg_hi:[1,0,0]
    v_cvt_pk_bf16_f32 v172, v124, v125
    v_cvt_pk_bf16_f32 v173, v126, v127
    v_cvt_pk_bf16_f32 v174, v128, v129
    v_cvt_pk_bf16_f32 v175, v130, v131
    v_pk_mul_f32 v[124:125], v[52:53], v[6:7] op_sel:[0,1] op_sel_hi:[1,1]
    v_pk_mul_f32 v[126:127], v[56:57], v[6:7] op_sel:[0,1] op_sel_hi:[1,1]
    v_pk_mul_f32 v[128:129], v[60:61], v[6:7] op_sel:[0,1] op_sel_hi:[1,1]
    v_pk_mul_f32 v[130:131], v[64:65], v[6:7] op_sel:[0,1] op_sel_hi:[1,1]
    v_exp_f32 v124, v124
    v_exp_f32 v126, v126
    v_exp_f32 v128, v128
    v_exp_f32 v130, v130
    v_cos_f32 v132, v125
    v_cos_f32 v134, v127
    v_cos_f32 v136, v129
    v_cos_f32 v138, v131
    v_sin_f32 v133, v125
    v_sin_f32 v135, v127
    v_sin_f32 v137, v129
    v_sin_f32 v139, v131
    v_pk_mul_f32 v[132:133], v[132:133], v[124:125] op_sel:[0,0] op_sel_hi:[1,0]
    v_pk_mul_f32 v[134:135], v[134:135], v[126:127] op_sel:[0,0] op_sel_hi:[1,0]
    v_pk_mul_f32 v[136:137], v[136:137], v[128:129] op_sel:[0,0] op_sel_hi:[1,0]
    v_pk_mul_f32 v[138:139], v[138:139], v[130:131] op_sel:[0,0] op_sel_hi:[1,0]
    v_cvt_pk_bf16_f32 v88, v132, v133
    v_cvt_pk_bf16_f32 v89, v134, v135
    v_cvt_pk_bf16_f32 v90, v136, v137
    v_cvt_pk_bf16_f32 v91, v138, v139
    v_pk_mul_f32 v[124:125], v[52:53], v[8:9] op_sel:[0,0] op_sel_hi:[1,0]
    v_pk_mul_f32 v[126:127], v[56:57], v[8:9] op_sel:[0,0] op_sel_hi:[1,0]
    v_pk_mul_f32 v[128:129], v[60:61], v[8:9] op_sel:[0,0] op_sel_hi:[1,0]
    v_pk_mul_f32 v[130:131], v[64:65], v[8:9] op_sel:[0,0] op_sel_hi:[1,0]
    v_exp_f32 v124, v124
    v_exp_f32 v126, v126
    v_exp_f32 v128, v128
    v_exp_f32 v130, v130
    v_fract_f32 v125, v125
    v_fract_f32 v127, v127
    v_fract_f32 v129, v129
    v_fract_f32 v131, v131
    v_cos_f32 v132, v125
    v_cos_f32 v134, v127
    v_cos_f32 v136, v129
    v_cos_f32 v138, v131
    v_sin_f32 v133, v125
    v_sin_f32 v135, v127
    v_sin_f32 v137, v129
    v_sin_f32 v139, v131
    v_pk_mul_f32 v[132:133], v[132:133], v[124:125] op_sel:[0,0] op_sel_hi:[1,0]
    v_pk_mul_f32 v[134:135], v[134:135], v[126:127] op_sel:[0,0] op_sel_hi:[1,0]
    v_pk_mul_f32 v[136:137], v[136:137], v[128:129] op_sel:[0,0] op_sel_hi:[1,0]
    v_pk_mul_f32 v[138:139], v[138:139], v[130:131] op_sel:[0,0] op_sel_hi:[1,0]
    v_pk_mul_f32 v[140:141], v[132:133], v[132:133] op_sel:[0,0] op_sel_hi:[0,1]
    v_pk_mul_f32 v[142:143], v[134:135], v[134:135] op_sel:[0,0] op_sel_hi:[0,1]
    v_pk_mul_f32 v[144:145], v[136:137], v[136:137] op_sel:[0,0] op_sel_hi:[0,1]
    v_pk_mul_f32 v[146:147], v[138:139], v[138:139] op_sel:[0,0] op_sel_hi:[0,1]
    v_cvt_pk_bf16_f32 v92, v132, v133
    v_cvt_pk_bf16_f32 v93, v134, v135
    v_cvt_pk_bf16_f32 v94, v136, v137
    v_cvt_pk_bf16_f32 v95, v138, v139
    v_pk_fma_f32 v[140:141], v[132:133], v[132:133], v[140:141] op_sel:[1,1,0] op_sel_hi:[0,1,1] neg_lo:[1,0,0]
    v_pk_fma_f32 v[142:143], v[134:135], v[134:135], v[142:143] op_sel:[1,1,0] op_sel_hi:[0,1,1] neg_lo:[1,0,0]
    v_pk_fma_f32 v[144:145], v[136:137], v[136:137], v[144:145] op_sel:[1,1,0] op_sel_hi:[0,1,1] neg_lo:[1,0,0]
    v_pk_fma_f32 v[146:147], v[138:139], v[138:139], v[146:147] op_sel:[1,1,0] op_sel_hi:[0,1,1] neg_lo:[1,0,0]
    v_cvt_pk_bf16_f32 v96, v140, v141
    v_cvt_pk_bf16_f32 v97, v142, v143
    v_cvt_pk_bf16_f32 v98, v144, v145
    v_cvt_pk_bf16_f32 v99, v146, v147
    v_mfma_f32_16x16x32_bf16 v[100:103], v[88:91], v[84:87], v[100:103]
    v_mfma_f32_16x16x32_bf16 v[104:107], v[92:95], v[84:87], v[104:107]
    v_mfma_f32_16x16x32_bf16 v[108:111], v[96:99], v[172:175], v[108:111]
    s_waitcnt lgkmcnt(0)
    ds_read_b128 v[52:55], v5 offset:1536
    ds_read_b128 v[56:59], v5 offset:1552
    ds_read_b128 v[60:63], v5 offset:1568
    ds_read_b128 v[64:67], v5 offset:1584
    s_barrier
    s_cmp_lg_u32 s28, 0
    s_cbranch_scc1 L_ut_nopoll
    buffer_load_dword v1, off, s[20:23], 0 offset:64 sc1
L_ut_nopoll:
    v_pk_mul_f32 v[124:125], v[68:69], v[6:7] op_sel:[0,0] op_sel_hi:[1,0]
    v_pk_mul_f32 v[126:127], v[72:73], v[6:7] op_sel:[0,0] op_sel_hi:[1,0]
    v_pk_mul_f32 v[128:129], v[76:77], v[6:7] op_sel:[0,0] op_sel_hi:[1,0]
    v_pk_mul_f32 v[130:131], v[80:81], v[6:7] op_sel:[0,0] op_sel_hi:[1,0]
    v_exp_f32 v124, v124
    v_exp_f32 v126, v126
    v_exp_f32 v128, v128
    v_exp_f32 v130, v130
    v_cos_f32 v132, v125
    v_cos_f32 v134, v127
    v_cos_f32 v136, v129
    v_cos_f32 v138, v131
    v_sin_f32 v133, v125
    v_sin_f32 v135, v127
    v_sin_f32 v137, v129
    v_sin_f32 v139, v131
    v_pk_mul_f32 v[132:133], v[132:133], v[124:125] op_sel:[0,0] op_sel_hi:[1,0]
    v_pk_mul_f32 v[134:135], v[134:135], v[126:127] op_sel:[0,0] op_sel_hi:[1,0]
    v_pk_mul_f32 v[136:137], v[136:137], v[128:129] op_sel:[0,0] op_sel_hi:[1,0]
    v_pk_mul_f32 v[138:139], v[138:139], v[130:131] op_sel:[0,0] op_sel_hi:[1,0]
    v_pk_mul_f32 v[140:141], v[132:133], v[70:71] op_sel:[0,0] op_sel_hi:[0,1]
    v_pk_mul_f32 v[142:143], v[134:135], v[74:75] op_sel:[0,0] op_sel_hi:[0,1]
    v_pk_mul_f32 v[144:145], v[136:137], v[78:79] op_sel:[0,0] op_sel_hi:[0,1]
    v_pk_mul_f32 v[146:147], v[138:139], v[82:83] op_sel:[0,0] op_sel_hi:[0,1]
    v_pk_fma_f32 v[140:141], v[132:133], v[70:71], v[140:141] op_sel:[1,1,0] op_sel_hi:[1,0,1] neg_lo:[1,0,0] neg_hi:[1,0,1]
    v_pk_fma_f32 v[142:143], v[134:135], v[74:75], v[142:143] op_sel:[1,1,0] op_sel_hi:[1,0,1] neg_lo:[1,0,0] neg_hi:[1,0,1]
    v_pk_fma_f32 v[144:145], v[136:137], v[78:79], v[144:145] op_sel:[1,1,0] op_sel_hi:[1,0,1] neg_lo:[1,0,0] neg_hi:[1,0,1]
    v_pk_fma_f32 v[146:147], v[138:139], v[82:83], v[146:147] op_sel:[1,1,0] op_sel_hi:[1,0,1] neg_lo:[1,0,0] neg_hi:[1,0,1]
    v_pk_mul_f32 v[124:125], v[140:141], v[132:133] op_sel:[0,0] op_sel_hi:[1,0]
    v_pk_mul_f32 v[126:127], v[142:143], v[134:135] op_sel:[0,0] op_sel_hi:[1,0]
    v_pk_mul_f32 v[128:129], v[144:145], v[136:137] op_sel:[0,0] op_sel_hi:[1,0]
    v_pk_mul_f32 v[130:131], v[146:147], v[138:139] op_sel:[0,0] op_sel_hi:[1,0]
    v_cvt_pk_bf16_f32 v84, v140, v141
    v_cvt_pk_bf16_f32 v85, v142, v143
    v_cvt_pk_bf16_f32 v86, v144, v145
    v_cvt_pk_bf16_f32 v87, v146, v147
    v_pk_fma_f32 v[124:125], v[140:141], v[132:133], v[124:125] op_sel:[1,1,0] op_sel_hi:[0,1,1] neg_hi:[1,0,0]
    v_pk_fma_f32 v[126:127], v[142:143], v[134:135], v[126:127] op_sel:[1,1,0] op_sel_hi:[0,1,1] neg_hi:[1,0,0]
    v_pk_fma_f32 v[128:129], v[144:145], v[136:137], v[128:129] op_sel:[1,1,0] op_sel_hi:[0,1,1] neg_hi:[1,0,0]
    v_pk_fma_f32 v[130:131], v[146:147], v[138:139], v[130:131] op_sel:[1,1,0] op_sel_hi:[0,1,1] neg_hi:[1,0,0]
    v_cvt_pk_bf16_f32 v172, v124, v125
    v_cvt_pk_bf16_f32 v173, v126, v127
    v_cvt_pk_bf16_f32 v174, v128, v129
    v_cvt_pk_bf16_f32 v175, v130, v131
    v_pk_mul_f32 v[124:125], v[68:69], v[6:7] op_sel:[0,1] op_sel_hi:[1,1]
    v_pk_mul_f32 v[126:127], v[72:73], v[6:7] op_sel:[0,1] op_sel_hi:[1,1]
    v_pk_mul_f32 v[128:129], v[76:77], v[6:7] op_sel:[0,1] op_sel_hi:[1,1]
    v_pk_mul_f32 v[130:131], v[80:81], v[6:7] op_sel:[0,1] op_sel_hi:[1,1]
    v_exp_f32 v124, v124
    v_exp_f32 v126, v126
    v_exp_f32 v128, v128
    v_exp_f32 v130, v130
    v_cos_f32 v132, v125
    v_cos_f32 v134, v127
    v_cos_f32 v136, v129
    v_cos_f32 v138, v131
    v_sin_f32 v133, v125
    v_sin_f32 v135, v127
    v_sin_f32 v137, v129
    v_sin_f32 v139, v131
    v_pk_mul_f32 v[132:133], v[132:133], v[124:125] op_sel:[0,0] op_sel_hi:[1,0]
    v_pk_mul_f32 v[134:135], v[134:135], v[126:127] op_sel:[0,0] op_sel_hi:[1,0]
    v_pk_mul_f32 v[136:137], v[136:137], v[128:129] op_sel:[0,0] op_sel_hi:[1,0]
    v_pk_mul_f32 v[138:139], v[138:139], v[130:131] op_sel:[0,0] op_sel_hi:[1,0]
    v_cvt_pk_bf16_f32 v88, v132, v133
    v_cvt_pk_bf16_f32 v89, v134, v135
    v_cvt_pk_bf16_f32 v90, v136, v137
    v_cvt_pk_bf16_f32 v91, v138, v139
    v_pk_mul_f32 v[124:125], v[68:69], v[8:9] op_sel:[0,0] op_sel_hi:[1,0]
    v_pk_mul_f32 v[126:127], v[72:73], v[8:9] op_sel:[0,0] op_sel_hi:[1,0]
    v_pk_mul_f32 v[128:129], v[76:77], v[8:9] op_sel:[0,0] op_sel_hi:[1,0]
    v_pk_mul_f32 v[130:131], v[80:81], v[8:9] op_sel:[0,0] op_sel_hi:[1,0]
    v_exp_f32 v124, v124
    v_exp_f32 v126, v126
    v_exp_f32 v128, v128
    v_exp_f32 v130, v130
    v_fract_f32 v125, v125
    v_fract_f32 v127, v127
    v_fract_f32 v129, v129
    v_fract_f32 v131, v131
    v_cos_f32 v132, v125
    v_cos_f32 v134, v127
    v_cos_f32 v136, v129
    v_cos_f32 v138, v131
    v_sin_f32 v133, v125
    v_sin_f32 v135, v127
    v_sin_f32 v137, v129
    v_sin_f32 v139, v131
    v_pk_mul_f32 v[132:133], v[132:133], v[124:125] op_sel:[0,0] op_sel_hi:[1,0]
    v_pk_mul_f32 v[134:135], v[134:135], v[126:127] op_sel:[0,0] op_sel_hi:[1,0]
    v_pk_mul_f32 v[136:137], v[136:137], v[128:129] op_sel:[0,0] op_sel_hi:[1,0]
    v_pk_mul_f32 v[138:139], v[138:139], v[130:131] op_sel:[0,0] op_sel_hi:[1,0]
    v_pk_mul_f32 v[140:141], v[132:133], v[132:133] op_sel:[0,0] op_sel_hi:[0,1]
    v_pk_mul_f32 v[142:143], v[134:135], v[134:135] op_sel:[0,0] op_sel_hi:[0,1]
    v_pk_mul_f32 v[144:145], v[136:137], v[136:137] op_sel:[0,0] op_sel_hi:[0,1]
    v_pk_mul_f32 v[146:147], v[138:139], v[138:139] op_sel:[0,0] op_sel_hi:[0,1]
    v_cvt_pk_bf16_f32 v92, v132, v133
    v_cvt_pk_bf16_f32 v93, v134, v135
    v_cvt_pk_bf16_f32 v94, v136, v137
    v_cvt_pk_bf16_f32 v95, v138, v139
    v_pk_fma_f32 v[140:141], v[132:133], v[132:133], v[140:141] op_sel:[1,1,0] op_sel_hi:[0,1,1] neg_lo:[1,0,0]
    v_pk_fma_f32 v[142:143], v[134:135], v[134:135], v[142:143] op_sel:[1,1,0] op_sel_hi:[0,1,1] neg_lo:[1,0,0]
    v_pk_fma_f32 v[144:145], v[136:137], v[136:137], v[144:145] op_sel:[1,1,0] op_sel_hi:[0,1,1] neg_lo:[1,0,0]
    v_pk_fma_f32 v[146:147], v[138:139], v[138:139], v[146:147] op_sel:[1,1,0] op_sel_hi:[0,1,1] neg_lo:[1,0,0]
    v_cvt_pk_bf16_f32 v96, v140, v141
    v_cvt_pk_bf16_f32 v97, v142, v143
    v_cvt_pk_bf16_f32 v98, v144, v145
    v_cvt_pk_bf16_f32 v99, v146, v147
    v_mfma_f32_16x16x32_bf16 v[100:103], v[88:91], v[84:87], v[100:103]
    v_mfma_f32_16x16x32_bf16 v[104:107], v[92:95], v[84:87], v[104:107]
    v_mfma_f32_16x16x32_bf16 v[108:111], v[96:99], v[172:175], v[108:111]
    s_waitcnt lgkmcnt(0)
    ds_read_b128 v[68:71], v5 offset:1792
    ds_read_b128 v[72:75], v5 offset:1808
    ds_read_b128 v[76:79], v5 offset:1824
    ds_read_b128 v[80:83], v5 offset:1840
    buffer_load_dword v2, v28, s[12:15], 0 offen offset:384
    v_pk_mul_f32 v[124:125], v[52:53], v[6:7] op_sel:[0,0] op_sel_hi:[1,0]
    v_pk_mul_f32 v[126:127], v[56:57], v[6:7] op_sel:[0,0] op_sel_hi:[1,0]
    v_pk_mul_f32 v[128:129], v[60:61], v[6:7] op_sel:[0,0] op_sel_hi:[1,0]
    v_pk_mul_f32 v[130:131], v[64:65], v[6:7] op_sel:[0,0] op_sel_hi:[1,0]
    v_exp_f32 v124, v124
    v_exp_f32 v126, v126
    v_exp_f32 v128, v128
    v_exp_f32 v130, v130
    v_cos_f32 v132, v125
    v_cos_f32 v134, v127
    v_cos_f32 v136, v129
    v_cos_f32 v138, v131
    v_sin_f32 v133, v125
    v_sin_f32 v135, v127
    v_sin_f32 v137, v129
    v_sin_f32 v139, v131
    v_pk_mul_f32 v[132:133], v[132:133], v[124:125] op_sel:[0,0] op_sel_hi:[1,0]
    v_pk_mul_f32 v[134:135], v[134:135], v[126:127] op_sel:[0,0] op_sel_hi:[1,0]
    v_pk_mul_f32 v[136:137], v[136:137], v[128:129] op_sel:[0,0] op_sel_hi:[1,0]
    v_pk_mul_f32 v[138:139], v[138:139], v[130:131] op_sel:[0,0] op_sel_hi:[1,0]
    v_pk_mul_f32 v[140:141], v[132:133], v[54:55] op_sel:[0,0] op_sel_hi:[0,1]
    v_pk_mul_f32 v[142:143], v[134:135], v[58:59] op_sel:[0,0] op_sel_hi:[0,1]
    v_pk_mul_f32 v[144:145], v[136:137], v[62:63] op_sel:[0,0] op_sel_hi:[0,1]
    v_pk_mul_f32 v[146:147], v[138:139], v[66:67] op_sel:[0,0] op_sel_hi:[0,1]
    v_pk_fma_f32 v[140:141], v[132:133], v[54:55], v[140:141] op_sel:[1,1,0] op_sel_hi:[1,0,1] neg_lo:[1,0,0] neg_hi:[1,0,1]
    v_pk_fma_f32 v[142:143], v[134:135], v[58:59], v[142:143] op_sel:[1,1,0] op_sel_hi:[1,0,1] neg_lo:[1,0,0] neg_hi:[1,0,1]
    v_pk_fma_f32 v[144:145], v[136:137], v[62:63], v[144:145] op_sel:[1,1,0] op_sel_hi:[1,0,1] neg_lo:[1,0,0] neg_hi:[1,0,1]
    v_pk_fma_f32 v[146:147], v[138:139], v[66:67], v[146:147] op_sel:[1,1,0] op_sel_hi:[1,0,1] neg_lo:[1,0,0] neg_hi:[1,0,1]
    v_pk_mul_f32 v[124:125], v[140:141], v[132:133] op_sel:[0,0] op_sel_hi:[1,0]
    v_pk_mul_f32 v[126:127], v[142:143], v[134:135] op_sel:[0,0] op_sel_hi:[1,0]
    v_pk_mul_f32 v[128:129], v[144:145], v[136:137] op_sel:[0,0] op_sel_hi:[1,0]
    v_pk_mul_f32 v[130:131], v[146:147], v[138:139] op_sel:[0,0] op_sel_hi:[1,0]
    v_cvt_pk_bf16_f32 v84, v140, v141
    v_cvt_pk_bf16_f32 v85, v142, v143
    v_cvt_pk_bf16_f32 v86, v144, v145
    v_cvt_pk_bf16_f32 v87, v146, v147
    v_pk_fma_f32 v[124:125], v[140:141], v[132:133], v[124:125] op_sel:[1,1,0] op_sel_hi:[0,1,1] neg_hi:[1,0,0]
    v_pk_fma_f32 v[126:127], v[142:143], v[134:135], v[126:127] op_sel:[1,1,0] op_sel_hi:[0,1,1] neg_hi:[1,0,0]
    v_pk_fma_f32 v[128:129], v[144:145], v[136:137], v[128:129] op_sel:[1,1,0] op_sel_hi:[0,1,1] neg_hi:[1,0,0]
    v_pk_fma_f32 v[130:131], v[146:147], v[138:139], v[130:131] op_sel:[1,1,0] op_sel_hi:[0,1,1] neg_hi:[1,0,0]
    v_cvt_pk_bf16_f32 v172, v124, v125
    v_cvt_pk_bf16_f32 v173, v126, v127
    v_cvt_pk_bf16_f32 v174, v128, v129
    v_cvt_pk_bf16_f32 v175, v130, v131
    v_pk_mul_f32 v[124:125], v[52:53], v[6:7] op_sel:[0,1] op_sel_hi:[1,1]
    v_pk_mul_f32 v[126:127], v[56:57], v[6:7] op_sel:[0,1] op_sel_hi:[1,1]
    v_pk_mul_f32 v[128:129], v[60:61], v[6:7] op_sel:[0,1] op_sel_hi:[1,1]
    v_pk_mul_f32 v[130:131], v[64:65], v[6:7] op_sel:[0,1] op_sel_hi:[1,1]
    v_exp_f32 v124, v124
    v_exp_f32 v126, v126
    v_exp_f32 v128, v128
    v_exp_f32 v130, v130
    v_cos_f32 v132, v125
    v_cos_f32 v134, v127
    v_cos_f32 v136, v129
    v_cos_f32 v138, v131
    v_sin_f32 v133, v125
    v_sin_f32 v135, v127
    v_sin_f32 v137, v129
    v_sin_f32 v139, v131
    v_pk_mul_f32 v[132:133], v[132:133], v[124:125] op_sel:[0,0] op_sel_hi:[1,0]
    v_pk_mul_f32 v[134:135], v[134:135], v[126:127] op_sel:[0,0] op_sel_hi:[1,0]
    v_pk_mul_f32 v[136:137], v[136:137], v[128:129] op_sel:[0,0] op_sel_hi:[1,0]
    v_pk_mul_f32 v[138:139], v[138:139], v[130:131] op_sel:[0,0] op_sel_hi:[1,0]
    v_cvt_pk_bf16_f32 v88, v132, v133
    v_cvt_pk_bf16_f32 v89, v134, v135
    v_cvt_pk_bf16_f32 v90, v136, v137
    v_cvt_pk_bf16_f32 v91, v138, v139
    v_pk_mul_f32 v[124:125], v[52:53], v[8:9] op_sel:[0,0] op_sel_hi:[1,0]
    v_pk_mul_f32 v[126:127], v[56:57], v[8:9] op_sel:[0,0] op_sel_hi:[1,0]
    v_pk_mul_f32 v[128:129], v[60:61], v[8:9] op_sel:[0,0] op_sel_hi:[1,0]
    v_pk_mul_f32 v[130:131], v[64:65], v[8:9] op_sel:[0,0] op_sel_hi:[1,0]
    v_exp_f32 v124, v124
    v_exp_f32 v126, v126
    v_exp_f32 v128, v128
    v_exp_f32 v130, v130
    v_fract_f32 v125, v125
    v_fract_f32 v127, v127
    v_fract_f32 v129, v129
    v_fract_f32 v131, v131
    v_cos_f32 v132, v125
    v_cos_f32 v134, v127
    v_cos_f32 v136, v129
    v_cos_f32 v138, v131
    v_sin_f32 v133, v125
    v_sin_f32 v135, v127
    v_sin_f32 v137, v129
    v_sin_f32 v139, v131
    v_pk_mul_f32 v[132:133], v[132:133], v[124:125] op_sel:[0,0] op_sel_hi:[1,0]
    v_pk_mul_f32 v[134:135], v[134:135], v[126:127] op_sel:[0,0] op_sel_hi:[1,0]
    v_pk_mul_f32 v[136:137], v[136:137], v[128:129] op_sel:[0,0] op_sel_hi:[1,0]
    v_pk_mul_f32 v[138:139], v[138:139], v[130:131] op_sel:[0,0] op_sel_hi:[1,0]
    v_pk_mul_f32 v[140:141], v[132:133], v[132:133] op_sel:[0,0] op_sel_hi:[0,1]
    v_pk_mul_f32 v[142:143], v[134:135], v[134:135] op_sel:[0,0] op_sel_hi:[0,1]
    v_pk_mul_f32 v[144:145], v[136:137], v[136:137] op_sel:[0,0] op_sel_hi:[0,1]
    v_pk_mul_f32 v[146:147], v[138:139], v[138:139] op_sel:[0,0] op_sel_hi:[0,1]
    v_cvt_pk_bf16_f32 v92, v132, v133
    v_cvt_pk_bf16_f32 v93, v134, v135
    v_cvt_pk_bf16_f32 v94, v136, v137
    v_cvt_pk_bf16_f32 v95, v138, v139
    v_pk_fma_f32 v[140:141], v[132:133], v[132:133], v[140:141] op_sel:[1,1,0] op_sel_hi:[0,1,1] neg_lo:[1,0,0]
    v_pk_fma_f32 v[142:143], v[134:135], v[134:135], v[142:143] op_sel:[1,1,0] op_sel_hi:[0,1,1] neg_lo:[1,0,0]
    v_pk_fma_f32 v[144:145], v[136:137], v[136:137], v[144:145] op_sel:[1,1,0] op_sel_hi:[0,1,1] neg_lo:[1,0,0]
    v_pk_fma_f32 v[146:147], v[138:139], v[138:139], v[146:147] op_sel:[1,1,0] op_sel_hi:[0,1,1] neg_lo:[1,0,0]
    v_cvt_pk_bf16_f32 v96, v140, v141
    v_cvt_pk_bf16_f32 v97, v142, v143
    v_cvt_pk_bf16_f32 v98, v144, v145
    v_cvt_pk_bf16_f32 v99, v146, v147
    v_mfma_f32_16x16x32_bf16 v[100:103], v[88:91], v[84:87], v[100:103]
    v_mfma_f32_16x16x32_bf16 v[104:107], v[92:95], v[84:87], v[104:107]
    v_mfma_f32_16x16x32_bf16 v[108:111], v[96:99], v[172:175], v[108:111]
    s_waitcnt lgkmcnt(0)
    ds_read_b128 v[52:55], v11 offset:0
    ds_read_b128 v[56:59], v11 offset:16
    ds_read_b128 v[60:63], v11 offset:32
    ds_read_b128 v[64:67], v11 offset:48
    s_cmp_lg_u32 s28, 0
    s_cbranch_scc1 L_ut_ret
    s_waitcnt vmcnt(1)
    v_cmp_le_u32 vcc, 64, v1
    s_cbranch_vccz L_ut_spin
L_ut_ret:
    s_barrier
    s_add_u32 s3, s31, s28
    s_lshl_b32 s3, s3, 6
    s_mul_i32 s75, s28, 4608
    s_add_u32 m0, s75, 512
    s_add_u32 s33, s3, 30752768
    buffer_load_dwordx4 v29, s[16:19], s33 offen sc1 lds
    s_add_u32 m0, s75, 1536
    s_add_u32 s33, s3, 31342592
    buffer_load_dwordx4 v29, s[16:19], s33 offen sc1 lds
    s_add_u32 m0, s75, 2560
    s_add_u32 s33, s3, 31932416
    buffer_load_dwordx4 v29, s[16:19], s33 offen sc1 lds
    s_add_u32 m0, s75, 3584
    s_add_u32 s33, s3, 32522240
    buffer_load_dwordx4 v29, s[16:19], s33 offen sc1 lds
    s_and_b32 s3, s28, 3
    s_lshl_b32 s75, s3, 10
    s_add_u32 m0, s75, 37376
    s_mul_i32 s3, s3, 589824
    s_lshl_b32 s33, s31, 6
    s_add_u32 s3, s3, s33
    s_add_u32 s3, s3, 30753280
    buffer_load_dwordx4 v29, s[16:19], s3 offen sc1 lds
    v_pk_mul_f32 v[124:125], v[68:69], v[6:7] op_sel:[0,0] op_sel_hi:[1,0]
    v_pk_mul_f32 v[126:127], v[72:73], v[6:7] op_sel:[0,0] op_sel_hi:[1,0]
    v_pk_mul_f32 v[128:129], v[76:77], v[6:7] op_sel:[0,0] op_sel_hi:[1,0]
    v_pk_mul_f32 v[130:131], v[80:81], v[6:7] op_sel:[0,0] op_sel_hi:[1,0]
    v_exp_f32 v124, v124
    v_exp_f32 v126, v126
    v_exp_f32 v128, v128
    v_exp_f32 v130, v130
    v_cos_f32 v132, v125
    v_cos_f32 v134, v127
    v_cos_f32 v136, v129
    v_cos_f32 v138, v131
    v_sin_f32 v133, v125
    v_sin_f32 v135, v127
    v_sin_f32 v137, v129
    v_sin_f32 v139, v131
    v_pk_mul_f32 v[132:133], v[132:133], v[124:125] op_sel:[0,0] op_sel_hi:[1,0]
    v_pk_mul_f32 v[134:135], v[134:135], v[126:127] op_sel:[0,0] op_sel_hi:[1,0]
    v_pk_mul_f32 v[136:137], v[136:137], v[128:129] op_sel:[0,0] op_sel_hi:[1,0]
    v_pk_mul_f32 v[138:139], v[138:139], v[130:131] op_sel:[0,0] op_sel_hi:[1,0]
    v_pk_mul_f32 v[140:141], v[132:133], v[70:71] op_sel:[0,0] op_sel_hi:[0,1]
    v_pk_mul_f32 v[142:143], v[134:135], v[74:75] op_sel:[0,0] op_sel_hi:[0,1]
    v_pk_mul_f32 v[144:145], v[136:137], v[78:79] op_sel:[0,0] op_sel_hi:[0,1]
    v_pk_mul_f32 v[146:147], v[138:139], v[82:83] op_sel:[0,0] op_sel_hi:[0,1]
    v_pk_fma_f32 v[140:141], v[132:133], v[70:71], v[140:141] op_sel:[1,1,0] op_sel_hi:[1,0,1] neg_lo:[1,0,0] neg_hi:[1,0,1]
    v_pk_fma_f32 v[142:143], v[134:135], v[74:75], v[142:143] op_sel:[1,1,0] op_sel_hi:[1,0,1] neg_lo:[1,0,0] neg_hi:[1,0,1]
    v_pk_fma_f32 v[144:145], v[136:137], v[78:79], v[144:145] op_sel:[1,1,0] op_sel_hi:[1,0,1] neg_lo:[1,0,0] neg_hi:[1,0,1]
    v_pk_fma_f32 v[146:147], v[138:139], v[82:83], v[146:147] op_sel:[1,1,0] op_sel_hi:[1,0,1] neg_lo:[1,0,0] neg_hi:[1,0,1]
    v_pk_mul_f32 v[124:125], v[140:141], v[132:133] op_sel:[0,0] op_sel_hi:[1,0]
    v_pk_mul_f32 v[126:127], v[142:143], v[134:135] op_sel:[0,0] op_sel_hi:[1,0]
    v_pk_mul_f32 v[128:129], v[144:145], v[136:137] op_sel:[0,0] op_sel_hi:[1,0]
    v_pk_mul_f32 v[130:131], v[146:147], v[138:139] op_sel:[0,0] op_sel_hi:[1,0]
    v_cvt_pk_bf16_f32 v84, v140, v141
    v_cvt_pk_bf16_f32 v85, v142, v143
    v_cvt_pk_bf16_f32 v86, v144, v145
    v_cvt_pk_bf16_f32 v87, v146, v147
    v_pk_fma_f32 v[124:125], v[140:141], v[132:133], v[124:125] op_sel:[1,1,0] op_sel_hi:[0,1,1] neg_hi:[1,0,0]
    v_pk_fma_f32 v[126:127], v[142:143], v[134:135], v[126:127] op_sel:[1,1,0] op_sel_hi:[0,1,1] neg_hi:[1,0,0]
    v_pk_fma_f32 v[128:129], v[144:145], v[136:137], v[128:129] op_sel:[1,1,0] op_sel_hi:[0,1,1] neg_hi:[1,0,0]
    v_pk_fma_f32 v[130:131], v[146:147], v[138:139], v[130:131] op_sel:[1,1,0] op_sel_hi:[0,1,1] neg_hi:[1,0,0]
    v_cvt_pk_bf16_f32 v172, v124, v125
    v_cvt_pk_bf16_f32 v173, v126, v127
    v_cvt_pk_bf16_f32 v174, v128, v129
    v_cvt_pk_bf16_f32 v175, v130, v131
    v_pk_mul_f32 v[124:125], v[68:69], v[6:7] op_sel:[0,1] op_sel_hi:[1,1]
    v_pk_mul_f32 v[126:127], v[72:73], v[6:7] op_sel:[0,1] op_sel_hi:[1,1]
    v_pk_mul_f32 v[128:129], v[76:77], v[6:7] op_sel:[0,1] op_sel_hi:[1,1]
    v_pk_mul_f32 v[130:131], v[80:81], v[6:7] op_sel:[0,1] op_sel_hi:[1,1]
    v_exp_f32 v124, v124
    v_exp_f32 v126, v126
    v_exp_f32 v128, v128
    v_exp_f32 v130, v130
    v_cos_f32 v132, v125
    v_cos_f32 v134, v127
    v_cos_f32 v136, v129
    v_cos_f32 v138, v131
    v_sin_f32 v133, v125
    v_sin_f32 v135, v127
    v_sin_f32 v137, v129
    v_sin_f32 v139, v131
    v_pk_mul_f32 v[132:133], v[132:133], v[124:125] op_sel:[0,0] op_sel_hi:[1,0]
    v_pk_mul_f32 v[134:135], v[134:135], v[126:127] op_sel:[0,0] op_sel_hi:[1,0]
    v_pk_mul_f32 v[136:137], v[136:137], v[128:129] op_sel:[0,0] op_sel_hi:[1,0]
    v_pk_mul_f32 v[138:139], v[138:139], v[130:131] op_sel:[0,0] op_sel_hi:[1,0]
    v_cvt_pk_bf16_f32 v88, v132, v133
    v_cvt_pk_bf16_f32 v89, v134, v135
    v_cvt_pk_bf16_f32 v90, v136, v137
    v_cvt_pk_bf16_f32 v91, v138, v139
    v_pk_mul_f32 v[124:125], v[68:69], v[8:9] op_sel:[0,0] op_sel_hi:[1,0]
    v_pk_mul_f32 v[126:127], v[72:73], v[8:9] op_sel:[0,0] op_sel_hi:[1,0]
    v_pk_mul_f32 v[128:129], v[76:77], v[8:9] op_sel:[0,0] op_sel_hi:[1,0]
    v_pk_mul_f32 v[130:131], v[80:81], v[8:9] op_sel:[0,0] op_sel_hi:[1,0]
    v_exp_f32 v124, v124
    v_exp_f32 v126, v126
    v_exp_f32 v128, v128
    v_exp_f32 v130, v130
    v_fract_f32 v125, v125
    v_fract_f32 v127, v127
    v_fract_f32 v129, v129
    v_fract_f32 v131, v131
    v_cos_f32 v132, v125
    v_cos_f32 v134, v127
    v_cos_f32 v136, v129
    v_cos_f32 v138, v131
    v_sin_f32 v133, v125
    v_sin_f32 v135, v127
    v_sin_f32 v137, v129
    v_sin_f32 v139, v131
    v_pk_mul_f32 v[132:133], v[132:133], v[124:125] op_sel:[0,0] op_sel_hi:[1,0]
    v_pk_mul_f32 v[134:135], v[134:135], v[126:127] op_sel:[0,0] op_sel_hi:[1,0]
    v_pk_mul_f32 v[136:137], v[136:137], v[128:129] op_sel:[0,0] op_sel_hi:[1,0]
    v_pk_mul_f32 v[138:139], v[138:139], v[130:131] op_sel:[0,0] op_sel_hi:[1,0]
    v_pk_mul_f32 v[140:141], v[132:133], v[132:133] op_sel:[0,0] op_sel_hi:[0,1]
    v_pk_mul_f32 v[142:143], v[134:135], v[134:135] op_sel:[0,0] op_sel_hi:[0,1]
    v_pk_mul_f32 v[144:145], v[136:137], v[136:137] op_sel:[0,0] op_sel_hi:[0,1]
    v_pk_mul_f32 v[146:147], v[138:139], v[138:139] op_sel:[0,0] op_sel_hi:[0,1]
    v_cvt_pk_bf16_f32 v92, v132, v133
    v_cvt_pk_bf16_f32 v93, v134, v135
    v_cvt_pk_bf16_f32 v94, v136, v137
    v_cvt_pk_bf16_f32 v95, v138, v139
    v_pk_fma_f32 v[140:141], v[132:133], v[132:133], v[140:141] op_sel:[1,1,0] op_sel_hi:[0,1,1] neg_lo:[1,0,0]
    v_pk_fma_f32 v[142:143], v[134:135], v[134:135], v[142:143] op_sel:[1,1,0] op_sel_hi:[0,1,1] neg_lo:[1,0,0]
    v_pk_fma_f32 v[144:145], v[136:137], v[136:137], v[144:145] op_sel:[1,1,0] op_sel_hi:[0,1,1] neg_lo:[1,0,0]
    v_pk_fma_f32 v[146:147], v[138:139], v[138:139], v[146:147] op_sel:[1,1,0] op_sel_hi:[0,1,1] neg_lo:[1,0,0]
    v_cvt_pk_bf16_f32 v96, v140, v141
    v_cvt_pk_bf16_f32 v97, v142, v143
    v_cvt_pk_bf16_f32 v98, v144, v145
    v_cvt_pk_bf16_f32 v99, v146, v147
    v_mfma_f32_16x16x32_bf16 v[100:103], v[88:91], v[84:87], v[100:103]
    v_mfma_f32_16x16x32_bf16 v[104:107], v[92:95], v[84:87], v[104:107]
    v_mfma_f32_16x16x32_bf16 v[108:111], v[96:99], v[172:175], v[108:111]
    s_nop 4
    s_waitcnt lgkmcnt(0)
    buffer_load_dword v2, v28, s[12:15], 0 offen offset:768
    v_pk_mul_f32 v[124:125], v[52:53], v[6:7] op_sel:[0,0] op_sel_hi:[1,0]
    v_pk_mul_f32 v[126:127], v[56:57], v[6:7] op_sel:[0,0] op_sel_hi:[1,0]
    v_pk_mul_f32 v[128:129], v[60:61], v[6:7] op_sel:[0,0] op_sel_hi:[1,0]
    v_pk_mul_f32 v[130:131], v[64:65], v[6:7] op_sel:[0,0] op_sel_hi:[1,0]
    v_exp_f32 v124, v124
    v_exp_f32 v126, v126
    v_exp_f32 v128, v128
    v_exp_f32 v130, v130
    v_cos_f32 v132, v125
    v_cos_f32 v134, v127
    v_cos_f32 v136, v129
    v_cos_f32 v138, v131
    v_sin_f32 v133, v125
    v_sin_f32 v135, v127
    v_sin_f32 v137, v129
    v_sin_f32 v139, v131
    v_pk_mul_f32 v[132:133], v[132:133], v[124:125] op_sel:[0,0] op_sel_hi:[1,0]
    v_pk_mul_f32 v[134:135], v[134:135], v[126:127] op_sel:[0,0] op_sel_hi:[1,0]
    v_pk_mul_f32 v[136:137], v[136:137], v[128:129] op_sel:[0,0] op_sel_hi:[1,0]
    v_pk_mul_f32 v[138:139], v[138:139], v[130:131] op_sel:[0,0] op_sel_hi:[1,0]
    v_pk_mul_f32 v[140:141], v[132:133], v[54:55] op_sel:[0,0] op_sel_hi:[0,1]
    v_pk_mul_f32 v[142:143], v[134:135], v[58:59] op_sel:[0,0] op_sel_hi:[0,1]
    v_pk_mul_f32 v[144:145], v[136:137], v[62:63] op_sel:[0,0] op_sel_hi:[0,1]
    v_pk_mul_f32 v[146:147], v[138:139], v[66:67] op_sel:[0,0] op_sel_hi:[0,1]
    v_pk_fma_f32 v[140:141], v[132:133], v[54:55], v[140:141] op_sel:[1,1,0] op_sel_hi:[1,0,1] neg_lo:[1,0,0] neg_hi:[1,0,1]
    v_pk_fma_f32 v[142:143], v[134:135], v[58:59], v[142:143] op_sel:[1,1,0] op_sel_hi:[1,0,1] neg_lo:[1,0,0] neg_hi:[1,0,1]
    v_pk_fma_f32 v[144:145], v[136:137], v[62:63], v[144:145] op_sel:[1,1,0] op_sel_hi:[1,0,1] neg_lo:[1,0,0] neg_hi:[1,0,1]
    v_pk_fma_f32 v[146:147], v[138:139], v[66:67], v[146:147] op_sel:[1,1,0] op_sel_hi:[1,0,1] neg_lo:[1,0,0] neg_hi:[1,0,1]
    v_pk_mul_f32 v[124:125], v[140:141], v[132:133] op_sel:[0,0] op_sel_hi:[1,0]
    v_pk_mul_f32 v[126:127], v[142:143], v[134:135] op_sel:[0,0] op_sel_hi:[1,0]
    v_pk_mul_f32 v[128:129], v[144:145], v[136:137] op_sel:[0,0] op_sel_hi:[1,0]
    v_pk_mul_f32 v[130:131], v[146:147], v[138:139] op_sel:[0,0] op_sel_hi:[1,0]
    v_cvt_pk_bf16_f32 v84, v140, v141
    v_cvt_pk_bf16_f32 v85, v142, v143
    v_cvt_pk_bf16_f32 v86, v144, v145
    v_cvt_pk_bf16_f32 v87, v146, v147
    v_pk_fma_f32 v[124:125], v[140:141], v[132:133], v[124:125] op_sel:[1,1,0] op_sel_hi:[0,1,1] neg_hi:[1,0,0]
    v_pk_fma_f32 v[126:127], v[142:143], v[134:135], v[126:127] op_sel:[1,1,0] op_sel_hi:[0,1,1] neg_hi:[1,0,0]
    v_pk_fma_f32 v[128:129], v[144:145], v[136:137], v[128:129] op_sel:[1,1,0] op_sel_hi:[0,1,1] neg_hi:[1,0,0]
    v_pk_fma_f32 v[130:131], v[146:147], v[138:139], v[130:131] op_sel:[1,1,0] op_sel_hi:[0,1,1] neg_hi:[1,0,0]
    v_cvt_pk_bf16_f32 v172, v124, v125
    v_cvt_pk_bf16_f32 v173, v126, v127
    v_cvt_pk_bf16_f32 v174, v128, v129
    v_cvt_pk_bf16_f32 v175, v130, v131
    v_pk_mul_f32 v[124:125], v[52:53], v[6:7] op_sel:[0,1] op_sel_hi:[1,1]
    v_pk_mul_f32 v[126:127], v[56:57], v[6:7] op_sel:[0,1] op_sel_hi:[1,1]
    v_pk_mul_f32 v[128:129], v[60:61], v[6:7] op_sel:[0,1] op_sel_hi:[1,1]
    v_pk_mul_f32 v[130:131], v[64:65], v[6:7] op_sel:[0,1] op_sel_hi:[1,1]
    v_exp_f32 v124, v124
    v_exp_f32 v126, v126
    v_exp_f32 v128, v128
    v_exp_f32 v130, v130
    v_cos_f32 v132, v125
    v_cos_f32 v134, v127
    v_cos_f32 v136, v129
    v_cos_f32 v138, v131
    v_sin_f32 v133, v125
    v_sin_f32 v135, v127
    v_sin_f32 v137, v129
    v_sin_f32 v139, v131
    v_pk_mul_f32 v[132:133], v[132:133], v[124:125] op_sel:[0,0] op_sel_hi:[1,0]
    v_pk_mul_f32 v[134:135], v[134:135], v[126:127] op_sel:[0,0] op_sel_hi:[1,0]
    v_pk_mul_f32 v[136:137], v[136:137], v[128:129] op_sel:[0,0] op_sel_hi:[1,0]
    v_pk_mul_f32 v[138:139], v[138:139], v[130:131] op_sel:[0,0] op_sel_hi:[1,0]
    v_cvt_pk_bf16_f32 v88, v132, v133
    v_cvt_pk_bf16_f32 v89, v134, v135
    v_cvt_pk_bf16_f32 v90, v136, v137
    v_cvt_pk_bf16_f32 v91, v138, v139
    v_pk_mul_f32 v[124:125], v[52:53], v[8:9] op_sel:[0,0] op_sel_hi:[1,0]
    v_pk_mul_f32 v[126:127], v[56:57], v[8:9] op_sel:[0,0] op_sel_hi:[1,0]
    v_pk_mul_f32 v[128:129], v[60:61], v[8:9] op_sel:[0,0] op_sel_hi:[1,0]
    v_pk_mul_f32 v[130:131], v[64:65], v[8:9] op_sel:[0,0] op_sel_hi:[1,0]
    v_exp_f32 v124, v124
    v_exp_f32 v126, v126
    v_exp_f32 v128, v128
    v_exp_f32 v130, v130
    v_fract_f32 v125, v125
    v_fract_f32 v127, v127
    v_fract_f32 v129, v129
    v_fract_f32 v131, v131
    v_cos_f32 v132, v125
    v_cos_f32 v134, v127
    v_cos_f32 v136, v129
    v_cos_f32 v138, v131
    v_sin_f32 v133, v125
    v_sin_f32 v135, v127
    v_sin_f32 v137, v129
    v_sin_f32 v139, v131
    v_pk_mul_f32 v[132:133], v[132:133], v[124:125] op_sel:[0,0] op_sel_hi:[1,0]
    v_pk_mul_f32 v[134:135], v[134:135], v[126:127] op_sel:[0,0] op_sel_hi:[1,0]
    v_pk_mul_f32 v[136:137], v[136:137], v[128:129] op_sel:[0,0] op_sel_hi:[1,0]
    v_pk_mul_f32 v[138:139], v[138:139], v[130:131] op_sel:[0,0] op_sel_hi:[1,0]
    v_pk_mul_f32 v[140:141], v[132:133], v[132:133] op_sel:[0,0] op_sel_hi:[0,1]
    v_pk_mul_f32 v[142:143], v[134:135], v[134:135] op_sel:[0,0] op_sel_hi:[0,1]
    v_pk_mul_f32 v[144:145], v[136:137], v[136:137] op_sel:[0,0] op_sel_hi:[0,1]
    v_pk_mul_f32 v[146:147], v[138:139], v[138:139] op_sel:[0,0] op_sel_hi:[0,1]
    v_cvt_pk_bf16_f32 v92, v132, v133
    v_cvt_pk_bf16_f32 v93, v134, v135
    v_cvt_pk_bf16_f32 v94, v136, v137
    v_cvt_pk_bf16_f32 v95, v138, v139
    v_pk_fma_f32 v[140:141], v[132:133], v[132:133], v[140:141] op_sel:[1,1,0] op_sel_hi:[0,1,1] neg_lo:[1,0,0]
    v_pk_fma_f32 v[142:143], v[134:135], v[134:135], v[142:143] op_sel:[1,1,0] op_sel_hi:[0,1,1] neg_lo:[1,0,0]
    v_pk_fma_f32 v[144:145], v[136:137], v[136:137], v[144:145] op_sel:[1,1,0] op_sel_hi:[0,1,1] neg_lo:[1,0,0]
    v_pk_fma_f32 v[146:147], v[138:139], v[138:139], v[146:147] op_sel:[1,1,0] op_sel_hi:[0,1,1] neg_lo:[1,0,0]
    v_cvt_pk_bf16_f32 v96, v140, v141
    v_cvt_pk_bf16_f32 v97, v142, v143
    v_cvt_pk_bf16_f32 v98, v144, v145
    v_cvt_pk_bf16_f32 v99, v146, v147
    v_mfma_f32_16x16x32_bf16 v[112:115], v[88:91], v[84:87], 0
    v_mfma_f32_16x16x32_bf16 v[116:119], v[92:95], v[84:87], 0
    v_mfma_f32_16x16x32_bf16 v[120:123], v[96:99], v[172:175], 0
    s_nop 4
    v_cmp_eq_u32 vcc, 0, v0
    v_lshlrev_b32 v124, 16, v43
    s_nop 0
    v_cndmask_b32 v124, 0, v124, vcc
    v_add_f32 v100, v100, v124
    v_cvt_pk_bf16_f32 v124, v100, v101
    v_cvt_pk_bf16_f32 v125, v102, v103
    v_cvt_pk_bf16_f32 v126, v104, v105
    v_cvt_pk_bf16_f32 v127, v106, v107
    v_cvt_pk_bf16_f32 v128, v108, v109
    v_cvt_pk_bf16_f32 v129, v110, v111
    ds_write_b64 v12, v[124:125]
    ds_write_b16 v13, v126
    ds_write_b16_d16_hi v14, v126
    ds_write_b16 v13, v127 offset:64
    ds_write_b16_d16_hi v14, v127 offset:64
    v_cvt_pk_bf16_f32 v130, v42, v42
    s_mov_b64 exec, 1
    ds_write_b16 v21, v130 offset:256
    s_mov_b64 exec, -1
    ds_write_b16 v15, v128
    ds_write_b16_d16_hi v15, v128 offset:32
    ds_write_b16 v15, v129 offset:64
    ds_write_b16_d16_hi v15, v129 offset:96
    s_waitcnt lgkmcnt(0)
    ds_read2_b64 v[52:55], v16 offset0:0 offset1:1
    ds_read_u16 v56, v17
    ds_read2_b64 v[58:61], v18 offset0:0 offset1:1
    ds_read_u16 v62, v19
    ds_read2_b32 v[64:65], v20 offset0:0 offset1:1
    ds_read_u16 v66, v21
    ds_read_u16 v67, v21 offset:2
    ds_read_u16 v68, v21 offset:128
    ds_read_u16 v69, v21 offset:130
    v_mov_b32 v132, 0
    v_mov_b32 v133, 0
    v_mov_b32 v134, 0
    v_mov_b32 v135, 0
    s_waitcnt lgkmcnt(0)
    s_mov_b64 exec, 3
    ds_write_b128 v22, v[132:135]
    ds_write_b128 v22, v[132:135] offset:4160
    s_mov_b32 exec_lo, -1
    v_lshlrev_b32 v56, 16, v56
    v_lshlrev_b32 v62, 16, v62
    v_cndmask_b32 v56, v56, 0, vcc
    v_alignbit_b32 v128, v52, v56, 16
    v_alignbit_b32 v129, v53, v52, 16
    v_alignbit_b32 v130, v54, v53, 16
    v_alignbit_b32 v131, v55, v54, 16
    ds_write_b128 v22, v[52:55] offset:32
    ds_write_b128 v22, v[128:131] offset:4192
    v_perm_b32 v124, v58, v58, s36
    v_perm_b32 v125, v59, v58, s37
    v_perm_b32 v126, v59, v59, s36
    v_perm_b32 v127, v60, v59, s37
    v_alignbit_b32 v128, v124, v62, 16
    v_alignbit_b32 v129, v125, v124, 16
    v_alignbit_b32 v130, v126, v125, 16
    v_alignbit_b32 v131, v127, v126, 16
    ds_write_b128 v22, v[124:127] offset:544
    ds_write_b128 v22, v[128:131] offset:4704
    s_mov_b64 exec, -1
    v_perm_b32 v124, v64, v64, s36
    v_mov_b32 v125, v64
    v_perm_b32 v126, v64, v64, s38
    v_perm_b32 v127, v65, v65, s36
    v_alignbit_b32 v128, v124, v124, 16
    v_alignbit_b32 v129, v125, v124, 16
    v_alignbit_b32 v130, v126, v125, 16
    v_alignbit_b32 v131, v127, v126, 16
    ds_write_b128 v22, v[124:127] offset:1056
    ds_write_b128 v22, v[128:131] offset:5216
    v_perm_b32 v124, v66, v66, s36
    v_perm_b32 v125, v66, v66, s36
    v_perm_b32 v126, v67, v66, v23
    v_perm_b32 v127, v67, v67, s36
    v_alignbit_b32 v128, v124, v124, 16
    v_alignbit_b32 v129, v125, v124, 16
    v_alignbit_b32 v130, v126, v125, 16
    v_alignbit_b32 v131, v127, v126, 16
    ds_write_b128 v22, v[124:127] offset:2080
    ds_write_b128 v22, v[128:131] offset:6240
    v_perm_b32 v124, v68, v68, s36
    v_perm_b32 v125, v68, v68, s36
    v_perm_b32 v126, v69, v68, v23
    v_perm_b32 v127, v69, v69, s36
    v_alignbit_b32 v128, v124, v124, 16
    v_alignbit_b32 v129, v125, v124, 16
    v_alignbit_b32 v130, v126, v125, 16
    v_alignbit_b32 v131, v127, v126, 16
    ds_write_b128 v22, v[124:127] offset:3104
    ds_write_b128 v22, v[128:131] offset:7264
    s_mul_i32 s3, s28, 3072
    s_add_u32 s3, s3, 116352
    v_lshl_add_u32 v136, v0, 4, s3
    ds_write_b128 v136, v[112:115] offset:0
    ds_write_b128 v136, v[116:119] offset:1024
    ds_write_b128 v136, v[120:123] offset:2048
    s_waitcnt vmcnt(1)
    s_waitcnt lgkmcnt(0)
    s_barrier
    s_cmp_lg_u32 s28, 7
    s_cbranch_scc1 L_conv_own
    v_add_u32 v136, -21504, v136
    v_add_u32 v12, 8320, v12
    v_add_u32 v13, 8320, v13
    v_add_u32 v14, 8320, v14
    v_add_u32 v15, 8320, v15
    v_add_u32 v16, 8320, v16
    v_add_u32 v17, 8320, v17
    v_add_u32 v18, 8320, v18
    v_add_u32 v19, 8320, v19
    v_add_u32 v20, 8320, v20
    v_add_u32 v21, 8320, v21
    v_add_u32 v22, 8320, v22
    ds_read_b128 v[148:151], v136 offset:0
    ds_read_b128 v[152:155], v136 offset:1024
    ds_read_b128 v[156:159], v136 offset:2048
    ds_read_b128 v[160:163], v136 offset:3072
    ds_read_b128 v[164:167], v136 offset:4096
    ds_read_b128 v[168:171], v136 offset:5120
    ds_read_b128 v[172:175], v136 offset:6144
    ds_read_b128 v[176:179], v136 offset:7168
    ds_read_b128 v[180:183], v136 offset:8192
    ds_read_b128 v[184:187], v136 offset:9216
    ds_read_b128 v[188:191], v136 offset:10240
    ds_read_b128 v[192:195], v136 offset:11264
    s_waitcnt lgkmcnt(9)
    v_add_f32 v112, v112, v148
    v_add_f32 v113, v113, v149
    v_add_f32 v114, v114, v150
    v_add_f32 v115, v115, v151
    v_add_f32 v116, v116, v152
    v_add_f32 v117, v117, v153
    v_add_f32 v118, v118, v154
    v_add_f32 v119, v119, v155
    v_add_f32 v120, v120, v156
    v_add_f32 v121, v121, v157
    v_add_f32 v122, v122, v158
    v_add_f32 v123, v123, v159
    s_waitcnt lgkmcnt(6)
    v_add_f32 v112, v112, v160
    v_add_f32 v113, v113, v161
    v_add_f32 v114, v114, v162
    v_add_f32 v115, v115, v163
    v_add_f32 v116, v116, v164
    v_add_f32 v117, v117, v165
    v_add_f32 v118, v118, v166
    v_add_f32 v119, v119, v167
    v_add_f32 v120, v120, v168
    v_add_f32 v121, v121, v169
    v_add_f32 v122, v122, v170
    v_add_f32 v123, v123, v171
    s_waitcnt lgkmcnt(3)
    v_add_f32 v112, v112, v172
    v_add_f32 v113, v113, v173
    v_add_f32 v114, v114, v174
    v_add_f32 v115, v115, v175
    v_add_f32 v116, v116, v176
    v_add_f32 v117, v117, v177
    v_add_f32 v118, v118, v178
    v_add_f32 v119, v119, v179
    v_add_f32 v120, v120, v180
    v_add_f32 v121, v121, v181
    v_add_f32 v122, v122, v182
    v_add_f32 v123, v123, v183
    s_waitcnt lgkmcnt(0)
    v_add_f32 v112, v112, v184
    v_add_f32 v113, v113, v185
    v_add_f32 v114, v114, v186
    v_add_f32 v115, v115, v187
    v_add_f32 v116, v116, v188
    v_add_f32 v117, v117, v189
    v_add_f32 v118, v118, v190
    v_add_f32 v119, v119, v191
    v_add_f32 v120, v120, v192
    v_add_f32 v121, v121, v193
    v_add_f32 v122, v122, v194
    v_add_f32 v123, v123, v195
    ds_read_b128 v[148:151], v136 offset:12288
    ds_read_b128 v[152:155], v136 offset:13312
    ds_read_b128 v[156:159], v136 offset:14336
    ds_read_b128 v[160:163], v136 offset:15360
    ds_read_b128 v[164:167], v136 offset:16384
    ds_read_b128 v[168:171], v136 offset:17408
    ds_read_b128 v[172:175], v136 offset:18432
    ds_read_b128 v[176:179], v136 offset:19456
    ds_read_b128 v[180:183], v136 offset:20480
    s_waitcnt lgkmcnt(6)
    v_add_f32 v112, v112, v148
    v_add_f32 v113, v113, v149
    v_add_f32 v114, v114, v150
    v_add_f32 v115, v115, v151
    v_add_f32 v116, v116, v152
    v_add_f32 v117, v117, v153
    v_add_f32 v118, v118, v154
    v_add_f32 v119, v119, v155
    v_add_f32 v120, v120, v156
    v_add_f32 v121, v121, v157
    v_add_f32 v122, v122, v158
    v_add_f32 v123, v123, v159
    s_waitcnt lgkmcnt(3)
    v_add_f32 v112, v112, v160
    v_add_f32 v113, v113, v161
    v_add_f32 v114, v114, v162
    v_add_f32 v115, v115, v163
    v_add_f32 v116, v116, v164
    v_add_f32 v117, v117, v165
    v_add_f32 v118, v118, v166
    v_add_f32 v119, v119, v167
    v_add_f32 v120, v120, v168
    v_add_f32 v121, v121, v169
    v_add_f32 v122, v122, v170
    v_add_f32 v123, v123, v171
    s_waitcnt lgkmcnt(0)
    v_add_f32 v112, v112, v172
    v_add_f32 v113, v113, v173
    v_add_f32 v114, v114, v174
    v_add_f32 v115, v115, v175
    v_add_f32 v116, v116, v176
    v_add_f32 v117, v117, v177
    v_add_f32 v118, v118, v178
    v_add_f32 v119, v119, v179
    v_add_f32 v120, v120, v180
    v_add_f32 v121, v121, v181
    v_add_f32 v122, v122, v182
    v_add_f32 v123, v123, v183
    v_cmp_eq_u32 vcc, 0, v0
    v_lshlrev_b32 v124, 16, v51
    s_nop 0
    v_cndmask_b32 v124, 0, v124, vcc
    v_add_f32 v112, v112, v124
    v_cvt_pk_bf16_f32 v124, v112, v113
    v_cvt_pk_bf16_f32 v125, v114, v115
    v_cvt_pk_bf16_f32 v126, v116, v117
    v_cvt_pk_bf16_f32 v127, v118, v119
    v_cvt_pk_bf16_f32 v128, v120, v121
    v_cvt_pk_bf16_f32 v129, v122, v123
    ds_write_b64 v12, v[124:125]
    ds_write_b16 v13, v126
    ds_write_b16_d16_hi v14, v126
    ds_write_b16 v13, v127 offset:64
    ds_write_b16_d16_hi v14, v127 offset:64
    v_cvt_pk_bf16_f32 v130, v50, v50
    s_mov_b64 exec, 1
    ds_write_b16 v21, v130 offset:256
    s_mov_b64 exec, -1
    ds_write_b16 v15, v128
    ds_write_b16_d16_hi v15, v128 offset:32
    ds_write_b16 v15, v129 offset:64
    ds_write_b16_d16_hi v15, v129 offset:96
    s_waitcnt lgkmcnt(0)
    ds_read2_b64 v[52:55], v16 offset0:0 offset1:1
    ds_read_u16 v56, v17
    ds_read2_b64 v[58:61], v18 offset0:0 offset1:1
    ds_read_u16 v62, v19
    ds_read2_b32 v[64:65], v20 offset0:0 offset1:1
    ds_read_u16 v66, v21
    ds_read_u16 v67, v21 offset:2
    ds_read_u16 v68, v21 offset:128
    ds_read_u16 v69, v21 offset:130
    v_mov_b32 v132, 0
    v_mov_b32 v133, 0
    v_mov_b32 v134, 0
    v_mov_b32 v135, 0
    s_waitcnt lgkmcnt(0)
    s_mov_b64 exec, 3
    ds_write_b128 v22, v[132:135]
    ds_write_b128 v22, v[132:135] offset:4160
    s_mov_b32 exec_lo, -1
    v_lshlrev_b32 v56, 16, v56
    v_lshlrev_b32 v62, 16, v62
    v_cndmask_b32 v56, v56, 0, vcc
    v_alignbit_b32 v128, v52, v56, 16
    v_alignbit_b32 v129, v53, v52, 16
    v_alignbit_b32 v130, v54, v53, 16
    v_alignbit_b32 v131, v55, v54, 16
    ds_write_b128 v22, v[52:55] offset:32
    ds_write_b128 v22, v[128:131] offset:4192
    v_perm_b32 v124, v58, v58, s36
    v_perm_b32 v125, v59, v58, s37
    v_perm_b32 v126, v59, v59, s36
    v_perm_b32 v127, v60, v59, s37
    v_alignbit_b32 v128, v124, v62, 16
    v_alignbit_b32 v129, v125, v124, 16
    v_alignbit_b32 v130, v126, v125, 16
    v_alignbit_b32 v131, v127, v126, 16
    ds_write_b128 v22, v[124:127] offset:544
    ds_write_b128 v22, v[128:131] offset:4704
    s_mov_b64 exec, -1
    v_perm_b32 v124, v64, v64, s36
    v_mov_b32 v125, v64
    v_perm_b32 v126, v64, v64, s38
    v_perm_b32 v127, v65, v65, s36
    v_alignbit_b32 v128, v124, v124, 16
    v_alignbit_b32 v129, v125, v124, 16
    v_alignbit_b32 v130, v126, v125, 16
    v_alignbit_b32 v131, v127, v126, 16
    ds_write_b128 v22, v[124:127] offset:1056
    ds_write_b128 v22, v[128:131] offset:5216
    v_perm_b32 v124, v66, v66, s36
    v_perm_b32 v125, v66, v66, s36
    v_perm_b32 v126, v67, v66, v23
    v_perm_b32 v127, v67, v67, s36
    v_alignbit_b32 v128, v124, v124, 16
    v_alignbit_b32 v129, v125, v124, 16
    v_alignbit_b32 v130, v126, v125, 16
    v_alignbit_b32 v131, v127, v126, 16
    ds_write_b128 v22, v[124:127] offset:2080
    ds_write_b128 v22, v[128:131] offset:6240
    v_perm_b32 v124, v68, v68, s36
    v_perm_b32 v125, v68, v68, s36
    v_perm_b32 v126, v69, v68, v23
    v_perm_b32 v127, v69, v69, s36
    v_alignbit_b32 v128, v124, v124, 16
    v_alignbit_b32 v129, v125, v124, 16
    v_alignbit_b32 v130, v126, v125, 16
    v_alignbit_b32 v131, v127, v126, 16
    ds_write_b128 v22, v[124:127] offset:3104
    ds_write_b128 v22, v[128:131] offset:7264
    s_waitcnt lgkmcnt(0)
L_conv_own:
    ds_read2_b32 v[56:57], v30 offset0:0 offset1:1
    ds_read2_b32 v[58:59], v30 offset0:2 offset1:3
    ds_read_b128 v[120:123], v34 offset:480
    ds_read2_b32 v[60:61], v30 offset0:128 offset1:129
    ds_read2_b32 v[62:63], v30 offset0:130 offset1:131
    ds_read_b128 v[124:127], v34 offset:992
    ds_read2_b32 v[64:65], v31 offset0:0 offset1:1
    ds_read2_b32 v[66:67], v31 offset0:2 offset1:3
    ds_read_b128 v[128:131], v34 offset:1504
    ds_read2_b32 v[68:69], v31 offset0:128 offset1:129
    ds_read2_b32 v[70:71], v31 offset0:130 offset1:131
    ds_read_b128 v[132:135], v34 offset:2016
    s_waitcnt lgkmcnt(9)
    v_mfma_f32_16x16x32_bf16 v[184:187], v[56:59], v[120:123], 0
    ds_read2_b32 v[72:73], v32 offset0:0 offset1:1
    s_waitcnt lgkmcnt(7)
    v_mfma_f32_16x16x32_bf16 v[188:191], v[56:59], v[124:127], 0
    ds_read2_b32 v[74:75], v32 offset0:2 offset1:3
    v_mfma_f32_16x16x32_bf16 v[188:191], v[60:63], v[120:123], v[188:191]
    ds_read_b128 v[136:139], v34 offset:2528
    s_waitcnt lgkmcnt(6)
    v_mfma_f32_16x16x32_bf16 v[192:195], v[56:59], v[128:131], 0
    ds_read2_b32 v[76:77], v32 offset0:128 offset1:129
    v_mfma_f32_16x16x32_bf16 v[192:195], v[60:63], v[124:127], v[192:195]
    ds_read2_b32 v[78:79], v32 offset0:130 offset1:131
    v_mfma_f32_16x16x32_bf16 v[192:195], v[64:67], v[120:123], v[192:195]
    ds_read_b128 v[140:143], v34 offset:3040
    s_waitcnt lgkmcnt(6)
    v_mfma_f32_16x16x32_bf16 v[196:199], v[56:59], v[132:135], 0
    ds_read2_b32 v[80:81], v33 offset0:0 offset1:1
    v_mfma_f32_16x16x32_bf16 v[196:199], v[60:63], v[128:131], v[196:199]
    ds_read2_b32 v[82:83], v33 offset0:2 offset1:3
    v_mfma_f32_16x16x32_bf16 v[196:199], v[64:67], v[124:127], v[196:199]
    ds_read_b128 v[144:147], v34 offset:3552
    v_mfma_f32_16x16x32_bf16 v[196:199], v[68:71], v[120:123], v[196:199]
    ds_read2_b32 v[84:85], v33 offset0:128 offset1:129
    s_waitcnt lgkmcnt(7)
    v_mfma_f32_16x16x32_bf16 v[200:203], v[56:59], v[136:139], 0
    ds_read2_b32 v[86:87], v33 offset0:130 offset1:131
    v_mfma_f32_16x16x32_bf16 v[200:203], v[60:63], v[132:135], v[200:203]
    ds_read_b128 v[148:151], v34 offset:4064
    v_mfma_f32_16x16x32_bf16 v[200:203], v[64:67], v[128:131], v[200:203]
    ds_read2_b32 v[88:89], v30 offset0:16 offset1:17
    v_mfma_f32_16x16x32_bf16 v[200:203], v[68:71], v[124:127], v[200:203]
    ds_read2_b32 v[90:91], v30 offset0:18 offset1:19
    v_mfma_f32_16x16x32_bf16 v[200:203], v[72:75], v[120:123], v[200:203]
    ds_read_b128 v[152:155], v34 offset:416
    s_waitcnt lgkmcnt(9)
    v_mfma_f32_16x16x32_bf16 v[204:207], v[56:59], v[140:143], 0
    ds_read2_b32 v[92:93], v30 offset0:144 offset1:145
    v_mfma_f32_16x16x32_bf16 v[204:207], v[60:63], v[136:139], v[204:207]
    ds_read2_b32 v[94:95], v30 offset0:146 offset1:147
    v_mfma_f32_16x16x32_bf16 v[204:207], v[64:67], v[132:135], v[204:207]
    ds_read_b128 v[156:159], v34 offset:928
    v_mfma_f32_16x16x32_bf16 v[204:207], v[68:71], v[128:131], v[204:207]
    ds_read2_b32 v[96:97], v31 offset0:16 offset1:17
    v_mfma_f32_16x16x32_bf16 v[204:207], v[72:75], v[124:127], v[204:207]
    ds_read2_b32 v[98:99], v31 offset0:18 offset1:19
    v_mfma_f32_16x16x32_bf16 v[204:207], v[76:79], v[120:123], v[204:207]
    ds_read_b128 v[160:163], v34 offset:1440
    s_waitcnt lgkmcnt(12)
    v_mfma_f32_16x16x32_bf16 v[208:211], v[56:59], v[144:147], 0
    ds_read2_b32 v[100:101], v31 offset0:144 offset1:145
    v_mfma_f32_16x16x32_bf16 v[208:211], v[60:63], v[140:143], v[208:211]
    ds_read2_b32 v[102:103], v31 offset0:146 offset1:147
    v_mfma_f32_16x16x32_bf16 v[208:211], v[64:67], v[136:139], v[208:211]
    ds_read_b128 v[164:167], v34 offset:1952
    v_mfma_f32_16x16x32_bf16 v[208:211], v[68:71], v[132:135], v[208:211]
    ds_read2_b32 v[104:105], v32 offset0:16 offset1:17
    v_mfma_f32_16x16x32_bf16 v[208:211], v[72:75], v[128:131], v[208:211]
    ds_read2_b32 v[106:107], v32 offset0:18 offset1:19
    v_mfma_f32_16x16x32_bf16 v[208:211], v[76:79], v[124:127], v[208:211]
    ds_read_b128 v[168:171], v34 offset:2464
    v_mfma_f32_16x16x32_bf16 v[208:211], v[80:83], v[120:123], v[208:211]
    ds_read2_b32 v[108:109], v32 offset0:144 offset1:145
    s_waitcnt lgkmcnt(15)
    v_mfma_f32_16x16x32_bf16 v[212:215], v[56:59], v[148:151], 0
    ds_read2_b32 v[110:111], v32 offset0:146 offset1:147
    v_mfma_f32_16x16x32_bf16 v[212:215], v[60:63], v[144:147], v[212:215]
    ds_read_b128 v[172:175], v34 offset:2976
    v_mfma_f32_16x16x32_bf16 v[212:215], v[64:67], v[140:143], v[212:215]
    ds_read2_b32 v[112:113], v33 offset0:16 offset1:17
    v_mfma_f32_16x16x32_bf16 v[212:215], v[68:71], v[136:139], v[212:215]
    ds_read2_b32 v[114:115], v33 offset0:18 offset1:19
    v_mfma_f32_16x16x32_bf16 v[212:215], v[72:75], v[132:135], v[212:215]
    ds_read_b128 v[176:179], v34 offset:3488
    v_mfma_f32_16x16x32_bf16 v[212:215], v[76:79], v[128:131], v[212:215]
    ds_read2_b32 v[116:117], v33 offset0:144 offset1:145
    v_mfma_f32_16x16x32_bf16 v[212:215], v[80:83], v[124:127], v[212:215]
    ds_read2_b32 v[118:119], v33 offset0:146 offset1:147
    v_mfma_f32_16x16x32_bf16 v[212:215], v[84:87], v[120:123], v[212:215]
    ds_read_b128 v[180:183], v34 offset:4000
    s_waitcnt lgkmcnt(15)
    v_mfma_f32_16x16x32_bf16 v[184:187], v[88:91], v[152:155], v[184:187]
    ds_read2_b32 v[56:57], v30 offset0:32 offset1:33
    v_lshlrev_b32 v52, 16, v216
    v_mfma_f32_16x16x32_bf16 v[188:191], v[88:91], v[156:159], v[188:191]
    ds_read2_b32 v[58:59], v30 offset0:34 offset1:35
    v_lshlrev_b32 v53, 16, v234
    v_mfma_f32_16x16x32_bf16 v[188:191], v[92:95], v[152:155], v[188:191]
    ds_read_b128 v[120:123], v34 offset:352
    v_and_b32 v54, 0xffff0000, v216
    v_mfma_f32_16x16x32_bf16 v[192:195], v[88:91], v[160:163], v[192:195]
    ds_read2_b32 v[60:61], v30 offset0:160 offset1:161
    v_and_b32 v55, 0xffff0000, v234
    v_mfma_f32_16x16x32_bf16 v[192:195], v[92:95], v[156:159], v[192:195]
    ds_read2_b32 v[62:63], v30 offset0:162 offset1:163
    v_mul_f32 v52, v52, v53
    v_mfma_f32_16x16x32_bf16 v[192:195], v[96:99], v[152:155], v[192:195]
    ds_read_b128 v[124:127], v34 offset:864
    v_mul_f32 v54, v54, v55
    s_waitcnt lgkmcnt(15)
    v_mfma_f32_16x16x32_bf16 v[196:199], v[88:91], v[164:167], v[196:199]
    ds_read2_b32 v[64:65], v31 offset0:32 offset1:33
    v_cvt_pk_bf16_f32 v52, v52, v54
    v_mfma_f32_16x16x32_bf16 v[196:199], v[92:95], v[160:163], v[196:199]
    ds_read2_b32 v[66:67], v31 offset0:34 offset1:35
    v_lshlrev_b32 v252, 16, v52
    v_mfma_f32_16x16x32_bf16 v[196:199], v[96:99], v[156:159], v[196:199]
    ds_read_b128 v[128:131], v34 offset:1376
    v_and_b32 v253, 0xffff0000, v52
    v_mfma_f32_16x16x32_bf16 v[196:199], v[100:103], v[152:155], v[196:199]
    ds_read2_b32 v[68:69], v31 offset0:160 offset1:161
    v_lshlrev_b32 v52, 16, v217
    v_mfma_f32_16x16x32_bf16 v[200:203], v[88:91], v[168:171], v[200:203]
    ds_read2_b32 v[70:71], v31 offset0:162 offset1:163
    v_lshlrev_b32 v53, 16, v235
    v_mfma_f32_16x16x32_bf16 v[200:203], v[92:95], v[164:167], v[200:203]
    ds_read_b128 v[132:135], v34 offset:1888
    v_and_b32 v54, 0xffff0000, v217
    v_mfma_f32_16x16x32_bf16 v[200:203], v[96:99], v[160:163], v[200:203]
    ds_read2_b32 v[72:73], v32 offset0:32 offset1:33
    v_and_b32 v55, 0xffff0000, v235
    v_mfma_f32_16x16x32_bf16 v[200:203], v[100:103], v[156:159], v[200:203]
    ds_read2_b32 v[74:75], v32 offset0:34 offset1:35
    v_mul_f32 v52, v52, v53
    v_mfma_f32_16x16x32_bf16 v[200:203], v[104:107], v[152:155], v[200:203]
    ds_read_b128 v[136:139], v34 offset:2400
    v_mul_f32 v54, v54, v55
    s_waitcnt lgkmcnt(15)
    v_mfma_f32_16x16x32_bf16 v[204:207], v[88:91], v[172:175], v[204:207]
    ds_read2_b32 v[76:77], v32 offset0:160 offset1:161
    v_cvt_pk_bf16_f32 v52, v52, v54
    v_mfma_f32_16x16x32_bf16 v[204:207], v[92:95], v[168:171], v[204:207]
    ds_read2_b32 v[78:79], v32 offset0:162 offset1:163
    v_lshlrev_b32 v53, 16, v52
    v_mfma_f32_16x16x32_bf16 v[204:207], v[96:99], v[164:167], v[204:207]
    ds_read_b128 v[140:143], v34 offset:2912
    v_and_b32 v52, 0xffff0000, v52
    v_mfma_f32_16x16x32_bf16 v[204:207], v[100:103], v[160:163], v[204:207]
    ds_read2_b32 v[80:81], v33 offset0:32 offset1:33
    v_add_f32 v252, v252, v53
    v_mfma_f32_16x16x32_bf16 v[204:207], v[104:107], v[156:159], v[204:207]
    ds_read2_b32 v[82:83], v33 offset0:34 offset1:35
    v_add_f32 v253, v253, v52
    v_mfma_f32_16x16x32_bf16 v[204:207], v[108:111], v[152:155], v[204:207]
    ds_read_b128 v[144:147], v34 offset:3424
    v_lshlrev_b32 v52, 16, v218
    v_mfma_f32_16x16x32_bf16 v[208:211], v[88:91], v[176:179], v[208:211]
    ds_read2_b32 v[84:85], v33 offset0:160 offset1:161
    v_lshlrev_b32 v53, 16, v236
    v_mfma_f32_16x16x32_bf16 v[208:211], v[92:95], v[172:175], v[208:211]
    ds_read2_b32 v[86:87], v33 offset0:162 offset1:163
    v_and_b32 v54, 0xffff0000, v218
    v_mfma_f32_16x16x32_bf16 v[208:211], v[96:99], v[168:171], v[208:211]
    ds_read_b128 v[148:151], v34 offset:3936
    v_and_b32 v55, 0xffff0000, v236
    v_mfma_f32_16x16x32_bf16 v[208:211], v[100:103], v[164:167], v[208:211]
    v_mul_f32 v52, v52, v53
    v_mfma_f32_16x16x32_bf16 v[208:211], v[104:107], v[160:163], v[208:211]
    v_mul_f32 v54, v54, v55
    v_mfma_f32_16x16x32_bf16 v[208:211], v[108:111], v[156:159], v[208:211]
    v_cvt_pk_bf16_f32 v52, v52, v54
    v_mfma_f32_16x16x32_bf16 v[208:211], v[112:115], v[152:155], v[208:211]
    v_lshlrev_b32 v53, 16, v52
    v_mfma_f32_16x16x32_bf16 v[212:215], v[88:91], v[180:183], v[212:215]
    v_and_b32 v52, 0xffff0000, v52
    v_mfma_f32_16x16x32_bf16 v[212:215], v[92:95], v[176:179], v[212:215]
    v_add_f32 v252, v252, v53
    v_mfma_f32_16x16x32_bf16 v[212:215], v[96:99], v[172:175], v[212:215]
    v_add_f32 v253, v253, v52
    v_mfma_f32_16x16x32_bf16 v[212:215], v[100:103], v[168:171], v[212:215]
    v_lshlrev_b32 v52, 16, v219
    v_mfma_f32_16x16x32_bf16 v[212:215], v[104:107], v[164:167], v[212:215]
    v_lshlrev_b32 v53, 16, v237
    v_mfma_f32_16x16x32_bf16 v[212:215], v[108:111], v[160:163], v[212:215]
    v_and_b32 v54, 0xffff0000, v219
    v_mfma_f32_16x16x32_bf16 v[212:215], v[112:115], v[156:159], v[212:215]
    v_and_b32 v55, 0xffff0000, v237
    v_mfma_f32_16x16x32_bf16 v[212:215], v[116:119], v[152:155], v[212:215]
    v_mul_f32 v52, v52, v53
    s_waitcnt lgkmcnt(15)
    v_mfma_f32_16x16x32_bf16 v[184:187], v[56:59], v[120:123], v[184:187]
    ds_read2_b32 v[88:89], v30 offset0:48 offset1:49
    v_mul_f32 v54, v54, v55
    v_mfma_f32_16x16x32_bf16 v[188:191], v[56:59], v[124:127], v[188:191]
    ds_read2_b32 v[90:91], v30 offset0:50 offset1:51
    v_cvt_pk_bf16_f32 v52, v52, v54
    v_mfma_f32_16x16x32_bf16 v[188:191], v[60:63], v[120:123], v[188:191]
    ds_read_b128 v[152:155], v34 offset:288
    v_lshlrev_b32 v53, 16, v52
    v_mfma_f32_16x16x32_bf16 v[192:195], v[56:59], v[128:131], v[192:195]
    ds_read2_b32 v[92:93], v30 offset0:176 offset1:177
    v_and_b32 v52, 0xffff0000, v52
    v_mfma_f32_16x16x32_bf16 v[192:195], v[60:63], v[124:127], v[192:195]
    ds_read2_b32 v[94:95], v30 offset0:178 offset1:179
    v_add_f32 v252, v252, v53
    v_mfma_f32_16x16x32_bf16 v[192:195], v[64:67], v[120:123], v[192:195]
    ds_read_b128 v[156:159], v34 offset:800
    v_add_f32 v253, v253, v52
    s_waitcnt lgkmcnt(15)
    v_mfma_f32_16x16x32_bf16 v[196:199], v[56:59], v[132:135], v[196:199]
    ds_read2_b32 v[96:97], v31 offset0:48 offset1:49
    v_lshlrev_b32 v52, 16, v220
    v_mfma_f32_16x16x32_bf16 v[196:199], v[60:63], v[128:131], v[196:199]
    ds_read2_b32 v[98:99], v31 offset0:50 offset1:51
    v_lshlrev_b32 v53, 16, v238
    v_mfma_f32_16x16x32_bf16 v[196:199], v[64:67], v[124:127], v[196:199]
    ds_read_b128 v[160:163], v34 offset:1312
    v_and_b32 v54, 0xffff0000, v220
    v_mfma_f32_16x16x32_bf16 v[196:199], v[68:71], v[120:123], v[196:199]
    ds_read2_b32 v[100:101], v31 offset0:176 offset1:177
    v_and_b32 v55, 0xffff0000, v238
    v_mfma_f32_16x16x32_bf16 v[200:203], v[56:59], v[136:139], v[200:203]
    ds_read2_b32 v[102:103], v31 offset0:178 offset1:179
    v_mul_f32 v52, v52, v53
    v_mfma_f32_16x16x32_bf16 v[200:203], v[60:63], v[132:135], v[200:203]
    ds_read_b128 v[164:167], v34 offset:1824
    v_mul_f32 v54, v54, v55
    v_mfma_f32_16x16x32_bf16 v[200:203], v[64:67], v[128:131], v[200:203]
    ds_read2_b32 v[104:105], v32 offset0:48 offset1:49
    v_cvt_pk_bf16_f32 v52, v52, v54
    v_mfma_f32_16x16x32_bf16 v[200:203], v[68:71], v[124:127], v[200:203]
    ds_read2_b32 v[106:107], v32 offset0:50 offset1:51
    v_lshlrev_b32 v53, 16, v52
    v_mfma_f32_16x16x32_bf16 v[200:203], v[72:75], v[120:123], v[200:203]
    ds_read_b128 v[168:171], v34 offset:2336
    v_and_b32 v52, 0xffff0000, v52
    s_waitcnt lgkmcnt(15)
    v_mfma_f32_16x16x32_bf16 v[204:207], v[56:59], v[140:143], v[204:207]
    ds_read2_b32 v[108:109], v32 offset0:176 offset1:177
    v_add_f32 v252, v252, v53
    v_mfma_f32_16x16x32_bf16 v[204:207], v[60:63], v[136:139], v[204:207]
    ds_read2_b32 v[110:111], v32 offset0:178 offset1:179
    v_add_f32 v253, v253, v52
    v_mfma_f32_16x16x32_bf16 v[204:207], v[64:67], v[132:135], v[204:207]
    ds_read_b128 v[172:175], v34 offset:2848
    v_lshlrev_b32 v52, 16, v221
    v_mfma_f32_16x16x32_bf16 v[204:207], v[68:71], v[128:131], v[204:207]
    ds_read2_b32 v[112:113], v33 offset0:48 offset1:49
    v_lshlrev_b32 v53, 16, v239
    v_mfma_f32_16x16x32_bf16 v[204:207], v[72:75], v[124:127], v[204:207]
    ds_read2_b32 v[114:115], v33 offset0:50 offset1:51
    v_and_b32 v54, 0xffff0000, v221
    v_mfma_f32_16x16x32_bf16 v[204:207], v[76:79], v[120:123], v[204:207]
    ds_read_b128 v[176:179], v34 offset:3360
    v_and_b32 v55, 0xffff0000, v239
    v_mfma_f32_16x16x32_bf16 v[208:211], v[56:59], v[144:147], v[208:211]
    ds_read2_b32 v[116:117], v33 offset0:176 offset1:177
    v_mul_f32 v52, v52, v53
    v_mfma_f32_16x16x32_bf16 v[208:211], v[60:63], v[140:143], v[208:211]
    ds_read2_b32 v[118:119], v33 offset0:178 offset1:179
    v_mul_f32 v54, v54, v55
    v_mfma_f32_16x16x32_bf16 v[208:211], v[64:67], v[136:139], v[208:211]
    ds_read_b128 v[180:183], v34 offset:3872
    v_cvt_pk_bf16_f32 v52, v52, v54
    v_mfma_f32_16x16x32_bf16 v[208:211], v[68:71], v[132:135], v[208:211]
    v_lshlrev_b32 v53, 16, v52
    v_mfma_f32_16x16x32_bf16 v[208:211], v[72:75], v[128:131], v[208:211]
    v_and_b32 v52, 0xffff0000, v52
    v_mfma_f32_16x16x32_bf16 v[208:211], v[76:79], v[124:127], v[208:211]
    v_add_f32 v252, v252, v53
    v_mfma_f32_16x16x32_bf16 v[208:211], v[80:83], v[120:123], v[208:211]
    v_add_f32 v253, v253, v52
    v_mfma_f32_16x16x32_bf16 v[212:215], v[56:59], v[148:151], v[212:215]
    v_lshlrev_b32 v52, 16, v222
    v_mfma_f32_16x16x32_bf16 v[212:215], v[60:63], v[144:147], v[212:215]
    v_lshlrev_b32 v53, 16, v240
    v_mfma_f32_16x16x32_bf16 v[212:215], v[64:67], v[140:143], v[212:215]
    v_and_b32 v54, 0xffff0000, v222
    v_mfma_f32_16x16x32_bf16 v[212:215], v[68:71], v[136:139], v[212:215]
    v_and_b32 v55, 0xffff0000, v240
    v_mfma_f32_16x16x32_bf16 v[212:215], v[72:75], v[132:135], v[212:215]
    v_mul_f32 v52, v52, v53
    v_mfma_f32_16x16x32_bf16 v[212:215], v[76:79], v[128:131], v[212:215]
    v_mul_f32 v54, v54, v55
    v_mfma_f32_16x16x32_bf16 v[212:215], v[80:83], v[124:127], v[212:215]
    v_cvt_pk_bf16_f32 v52, v52, v54
    v_mfma_f32_16x16x32_bf16 v[212:215], v[84:87], v[120:123], v[212:215]
    v_lshlrev_b32 v53, 16, v52
    s_waitcnt lgkmcnt(15)
    v_mfma_f32_16x16x32_bf16 v[184:187], v[88:91], v[152:155], v[184:187]
    ds_read2_b32 v[56:57], v30 offset0:64 offset1:65
    v_and_b32 v52, 0xffff0000, v52
    v_mfma_f32_16x16x32_bf16 v[188:191], v[88:91], v[156:159], v[188:191]
    ds_read2_b32 v[58:59], v30 offset0:66 offset1:67
    v_add_f32 v252, v252, v53
    v_mfma_f32_16x16x32_bf16 v[188:191], v[92:95], v[152:155], v[188:191]
    ds_read_b128 v[120:123], v34 offset:224
    v_add_f32 v253, v253, v52
    v_mfma_f32_16x16x32_bf16 v[192:195], v[88:91], v[160:163], v[192:195]
    ds_read2_b32 v[60:61], v30 offset0:192 offset1:193
    v_lshlrev_b32 v52, 16, v223
    v_mfma_f32_16x16x32_bf16 v[192:195], v[92:95], v[156:159], v[192:195]
    ds_read2_b32 v[62:63], v30 offset0:194 offset1:195
    v_lshlrev_b32 v53, 16, v241
    v_mfma_f32_16x16x32_bf16 v[192:195], v[96:99], v[152:155], v[192:195]
    ds_read_b128 v[124:127], v34 offset:736
    v_and_b32 v54, 0xffff0000, v223
    s_waitcnt lgkmcnt(15)
    v_mfma_f32_16x16x32_bf16 v[196:199], v[88:91], v[164:167], v[196:199]
    ds_read2_b32 v[64:65], v31 offset0:64 offset1:65
    v_and_b32 v55, 0xffff0000, v241
    v_mfma_f32_16x16x32_bf16 v[196:199], v[92:95], v[160:163], v[196:199]
    ds_read2_b32 v[66:67], v31 offset0:66 offset1:67
    v_mul_f32 v52, v52, v53
    v_mfma_f32_16x16x32_bf16 v[196:199], v[96:99], v[156:159], v[196:199]
    ds_read_b128 v[128:131], v34 offset:1248
    v_mul_f32 v54, v54, v55
    v_mfma_f32_16x16x32_bf16 v[196:199], v[100:103], v[152:155], v[196:199]
    ds_read2_b32 v[68:69], v31 offset0:192 offset1:193
    v_cvt_pk_bf16_f32 v52, v52, v54
    v_mfma_f32_16x16x32_bf16 v[200:203], v[88:91], v[168:171], v[200:203]
    ds_read2_b32 v[70:71], v31 offset0:194 offset1:195
    v_lshlrev_b32 v53, 16, v52
    v_mfma_f32_16x16x32_bf16 v[200:203], v[92:95], v[164:167], v[200:203]
    ds_read_b128 v[132:135], v34 offset:1760
    v_and_b32 v52, 0xffff0000, v52
    v_mfma_f32_16x16x32_bf16 v[200:203], v[96:99], v[160:163], v[200:203]
    ds_read2_b32 v[72:73], v32 offset0:64 offset1:65
    v_add_f32 v252, v252, v53
    v_mfma_f32_16x16x32_bf16 v[200:203], v[100:103], v[156:159], v[200:203]
    ds_read2_b32 v[74:75], v32 offset0:66 offset1:67
    v_add_f32 v253, v253, v52
    v_mfma_f32_16x16x32_bf16 v[200:203], v[104:107], v[152:155], v[200:203]
    ds_read_b128 v[136:139], v34 offset:2272
    v_lshlrev_b32 v52, 16, v224
    s_waitcnt lgkmcnt(15)
    v_mfma_f32_16x16x32_bf16 v[204:207], v[88:91], v[172:175], v[204:207]
    ds_read2_b32 v[76:77], v32 offset0:192 offset1:193
    v_lshlrev_b32 v53, 16, v242
    v_mfma_f32_16x16x32_bf16 v[204:207], v[92:95], v[168:171], v[204:207]
    ds_read2_b32 v[78:79], v32 offset0:194 offset1:195
    v_and_b32 v54, 0xffff0000, v224
    v_mfma_f32_16x16x32_bf16 v[204:207], v[96:99], v[164:167], v[204:207]
    ds_read_b128 v[140:143], v34 offset:2784
    v_and_b32 v55, 0xffff0000, v242
    v_mfma_f32_16x16x32_bf16 v[204:207], v[100:103], v[160:163], v[204:207]
    ds_read2_b32 v[80:81], v33 offset0:64 offset1:65
    v_mul_f32 v52, v52, v53
    v_mfma_f32_16x16x32_bf16 v[204:207], v[104:107], v[156:159], v[204:207]
    ds_read2_b32 v[82:83], v33 offset0:66 offset1:67
    v_mul_f32 v54, v54, v55
    v_mfma_f32_16x16x32_bf16 v[204:207], v[108:111], v[152:155], v[204:207]
    ds_read_b128 v[144:147], v34 offset:3296
    v_cvt_pk_bf16_f32 v52, v52, v54
    v_mfma_f32_16x16x32_bf16 v[208:211], v[88:91], v[176:179], v[208:211]
    ds_read2_b32 v[84:85], v33 offset0:192 offset1:193
    v_lshlrev_b32 v53, 16, v52
    v_mfma_f32_16x16x32_bf16 v[208:211], v[92:95], v[172:175], v[208:211]
    ds_read2_b32 v[86:87], v33 offset0:194 offset1:195
    v_and_b32 v52, 0xffff0000, v52
    v_mfma_f32_16x16x32_bf16 v[208:211], v[96:99], v[168:171], v[208:211]
    ds_read_b128 v[148:151], v34 offset:3808
    v_add_f32 v252, v252, v53
    v_mfma_f32_16x16x32_bf16 v[208:211], v[100:103], v[164:167], v[208:211]
    v_add_f32 v253, v253, v52
    v_mfma_f32_16x16x32_bf16 v[208:211], v[104:107], v[160:163], v[208:211]
    v_lshlrev_b32 v52, 16, v225
    v_mfma_f32_16x16x32_bf16 v[208:211], v[108:111], v[156:159], v[208:211]
    v_lshlrev_b32 v53, 16, v243
    v_mfma_f32_16x16x32_bf16 v[208:211], v[112:115], v[152:155], v[208:211]
    v_and_b32 v54, 0xffff0000, v225
    v_mfma_f32_16x16x32_bf16 v[212:215], v[88:91], v[180:183], v[212:215]
    v_and_b32 v55, 0xffff0000, v243
    v_mfma_f32_16x16x32_bf16 v[212:215], v[92:95], v[176:179], v[212:215]
    v_mul_f32 v52, v52, v53
    v_mfma_f32_16x16x32_bf16 v[212:215], v[96:99], v[172:175], v[212:215]
    v_mul_f32 v54, v54, v55
    v_mfma_f32_16x16x32_bf16 v[212:215], v[100:103], v[168:171], v[212:215]
    v_cvt_pk_bf16_f32 v52, v52, v54
    v_mfma_f32_16x16x32_bf16 v[212:215], v[104:107], v[164:167], v[212:215]
    v_lshlrev_b32 v53, 16, v52
    v_mfma_f32_16x16x32_bf16 v[212:215], v[108:111], v[160:163], v[212:215]
    v_and_b32 v52, 0xffff0000, v52
    v_mfma_f32_16x16x32_bf16 v[212:215], v[112:115], v[156:159], v[212:215]
    v_add_f32 v252, v252, v53
    v_mfma_f32_16x16x32_bf16 v[212:215], v[116:119], v[152:155], v[212:215]
    v_add_f32 v253, v253, v52
    s_waitcnt lgkmcnt(15)
    v_mfma_f32_16x16x32_bf16 v[184:187], v[56:59], v[120:123], v[184:187]
    ds_read2_b32 v[88:89], v30 offset0:80 offset1:81
    v_lshlrev_b32 v52, 16, v226
    v_mfma_f32_16x16x32_bf16 v[188:191], v[56:59], v[124:127], v[188:191]
    ds_read2_b32 v[90:91], v30 offset0:82 offset1:83
    v_lshlrev_b32 v53, 16, v244
    v_mfma_f32_16x16x32_bf16 v[188:191], v[60:63], v[120:123], v[188:191]
    ds_read_b128 v[152:155], v34 offset:160
    v_and_b32 v54, 0xffff0000, v226
    v_mfma_f32_16x16x32_bf16 v[192:195], v[56:59], v[128:131], v[192:195]
    ds_read2_b32 v[92:93], v30 offset0:208 offset1:209
    v_and_b32 v55, 0xffff0000, v244
    v_mfma_f32_16x16x32_bf16 v[192:195], v[60:63], v[124:127], v[192:195]
    ds_read2_b32 v[94:95], v30 offset0:210 offset1:211
    v_mul_f32 v52, v52, v53
    v_mfma_f32_16x16x32_bf16 v[192:195], v[64:67], v[120:123], v[192:195]
    ds_read_b128 v[156:159], v34 offset:672
    v_mul_f32 v54, v54, v55
    s_waitcnt lgkmcnt(15)
    v_mfma_f32_16x16x32_bf16 v[196:199], v[56:59], v[132:135], v[196:199]
    ds_read2_b32 v[96:97], v31 offset0:80 offset1:81
    v_cvt_pk_bf16_f32 v52, v52, v54
    v_mfma_f32_16x16x32_bf16 v[196:199], v[60:63], v[128:131], v[196:199]
    ds_read2_b32 v[98:99], v31 offset0:82 offset1:83
    v_lshlrev_b32 v53, 16, v52
    v_mfma_f32_16x16x32_bf16 v[196:199], v[64:67], v[124:127], v[196:199]
    ds_read_b128 v[160:163], v34 offset:1184
    v_and_b32 v52, 0xffff0000, v52
    v_mfma_f32_16x16x32_bf16 v[196:199], v[68:71], v[120:123], v[196:199]
    ds_read2_b32 v[100:101], v31 offset0:208 offset1:209
    v_add_f32 v252, v252, v53
    v_mfma_f32_16x16x32_bf16 v[200:203], v[56:59], v[136:139], v[200:203]
    ds_read2_b32 v[102:103], v31 offset0:210 offset1:211
    v_add_f32 v253, v253, v52
    v_mfma_f32_16x16x32_bf16 v[200:203], v[60:63], v[132:135], v[200:203]
    ds_read_b128 v[164:167], v34 offset:1696
    v_lshlrev_b32 v52, 16, v227
    v_mfma_f32_16x16x32_bf16 v[200:203], v[64:67], v[128:131], v[200:203]
    ds_read2_b32 v[104:105], v32 offset0:80 offset1:81
    v_lshlrev_b32 v53, 16, v245
    v_mfma_f32_16x16x32_bf16 v[200:203], v[68:71], v[124:127], v[200:203]
    ds_read2_b32 v[106:107], v32 offset0:82 offset1:83
    v_and_b32 v54, 0xffff0000, v227
    v_mfma_f32_16x16x32_bf16 v[200:203], v[72:75], v[120:123], v[200:203]
    ds_read_b128 v[168:171], v34 offset:2208
    v_and_b32 v55, 0xffff0000, v245
    s_waitcnt lgkmcnt(15)
    v_mfma_f32_16x16x32_bf16 v[204:207], v[56:59], v[140:143], v[204:207]
    ds_read2_b32 v[108:109], v32 offset0:208 offset1:209
    v_mul_f32 v52, v52, v53
    v_mfma_f32_16x16x32_bf16 v[204:207], v[60:63], v[136:139], v[204:207]
    ds_read2_b32 v[110:111], v32 offset0:210 offset1:211
    v_mul_f32 v54, v54, v55
    v_mfma_f32_16x16x32_bf16 v[204:207], v[64:67], v[132:135], v[204:207]
    ds_read_b128 v[172:175], v34 offset:2720
    v_cvt_pk_bf16_f32 v52, v52, v54
    v_mfma_f32_16x16x32_bf16 v[204:207], v[68:71], v[128:131], v[204:207]
    ds_read2_b32 v[112:113], v33 offset0:80 offset1:81
    v_lshlrev_b32 v53, 16, v52
    v_mfma_f32_16x16x32_bf16 v[204:207], v[72:75], v[124:127], v[204:207]
    ds_read2_b32 v[114:115], v33 offset0:82 offset1:83
    v_and_b32 v52, 0xffff0000, v52
    v_mfma_f32_16x16x32_bf16 v[204:207], v[76:79], v[120:123], v[204:207]
    ds_read_b128 v[176:179], v34 offset:3232
    v_add_f32 v252, v252, v53
    v_mfma_f32_16x16x32_bf16 v[208:211], v[56:59], v[144:147], v[208:211]
    ds_read2_b32 v[116:117], v33 offset0:208 offset1:209
    v_add_f32 v253, v253, v52
    v_mfma_f32_16x16x32_bf16 v[208:211], v[60:63], v[140:143], v[208:211]
    ds_read2_b32 v[118:119], v33 offset0:210 offset1:211
    v_lshlrev_b32 v52, 16, v228
    v_mfma_f32_16x16x32_bf16 v[208:211], v[64:67], v[136:139], v[208:211]
    ds_read_b128 v[180:183], v34 offset:3744
    v_lshlrev_b32 v53, 16, v246
    v_mfma_f32_16x16x32_bf16 v[208:211], v[68:71], v[132:135], v[208:211]
    v_and_b32 v54, 0xffff0000, v228
    v_mfma_f32_16x16x32_bf16 v[208:211], v[72:75], v[128:131], v[208:211]
    v_and_b32 v55, 0xffff0000, v246
    v_mfma_f32_16x16x32_bf16 v[208:211], v[76:79], v[124:127], v[208:211]
    v_mul_f32 v52, v52, v53
    v_mfma_f32_16x16x32_bf16 v[208:211], v[80:83], v[120:123], v[208:211]
    v_mul_f32 v54, v54, v55
    v_mfma_f32_16x16x32_bf16 v[212:215], v[56:59], v[148:151], v[212:215]
    v_cvt_pk_bf16_f32 v52, v52, v54
    v_mfma_f32_16x16x32_bf16 v[212:215], v[60:63], v[144:147], v[212:215]
    v_lshlrev_b32 v53, 16, v52
    v_mfma_f32_16x16x32_bf16 v[212:215], v[64:67], v[140:143], v[212:215]
    v_and_b32 v52, 0xffff0000, v52
    v_mfma_f32_16x16x32_bf16 v[212:215], v[68:71], v[136:139], v[212:215]
    v_add_f32 v252, v252, v53
    v_mfma_f32_16x16x32_bf16 v[212:215], v[72:75], v[132:135], v[212:215]
    v_add_f32 v253, v253, v52
    v_mfma_f32_16x16x32_bf16 v[212:215], v[76:79], v[128:131], v[212:215]
    v_lshlrev_b32 v52, 16, v229
    v_mfma_f32_16x16x32_bf16 v[212:215], v[80:83], v[124:127], v[212:215]
    v_lshlrev_b32 v53, 16, v247
    v_mfma_f32_16x16x32_bf16 v[212:215], v[84:87], v[120:123], v[212:215]
    v_and_b32 v54, 0xffff0000, v229
    s_waitcnt lgkmcnt(15)
    v_mfma_f32_16x16x32_bf16 v[184:187], v[88:91], v[152:155], v[184:187]
    ds_read2_b32 v[56:57], v30 offset0:96 offset1:97
    v_and_b32 v55, 0xffff0000, v247
    v_mfma_f32_16x16x32_bf16 v[188:191], v[88:91], v[156:159], v[188:191]
    ds_read2_b32 v[58:59], v30 offset0:98 offset1:99
    v_mul_f32 v52, v52, v53
    v_mfma_f32_16x16x32_bf16 v[188:191], v[92:95], v[152:155], v[188:191]
    ds_read_b128 v[120:123], v34 offset:96
    v_mul_f32 v54, v54, v55
    v_mfma_f32_16x16x32_bf16 v[192:195], v[88:91], v[160:163], v[192:195]
    ds_read2_b32 v[60:61], v30 offset0:224 offset1:225
    v_cvt_pk_bf16_f32 v52, v52, v54
    v_mfma_f32_16x16x32_bf16 v[192:195], v[92:95], v[156:159], v[192:195]
    ds_read2_b32 v[62:63], v30 offset0:226 offset1:227
    v_lshlrev_b32 v53, 16, v52
    v_mfma_f32_16x16x32_bf16 v[192:195], v[96:99], v[152:155], v[192:195]
    ds_read_b128 v[124:127], v34 offset:608
    v_and_b32 v52, 0xffff0000, v52
    s_waitcnt lgkmcnt(15)
    v_mfma_f32_16x16x32_bf16 v[196:199], v[88:91], v[164:167], v[196:199]
    ds_read2_b32 v[64:65], v31 offset0:96 offset1:97
    v_add_f32 v252, v252, v53
    v_mfma_f32_16x16x32_bf16 v[196:199], v[92:95], v[160:163], v[196:199]
    ds_read2_b32 v[66:67], v31 offset0:98 offset1:99
    v_add_f32 v253, v253, v52
    v_mfma_f32_16x16x32_bf16 v[196:199], v[96:99], v[156:159], v[196:199]
    ds_read_b128 v[128:131], v34 offset:1120
    v_lshlrev_b32 v52, 16, v230
    v_mfma_f32_16x16x32_bf16 v[196:199], v[100:103], v[152:155], v[196:199]
    ds_read2_b32 v[68:69], v31 offset0:224 offset1:225
    v_lshlrev_b32 v53, 16, v248
    v_mfma_f32_16x16x32_bf16 v[200:203], v[88:91], v[168:171], v[200:203]
    ds_read2_b32 v[70:71], v31 offset0:226 offset1:227
    v_and_b32 v54, 0xffff0000, v230
    v_mfma_f32_16x16x32_bf16 v[200:203], v[92:95], v[164:167], v[200:203]
    ds_read_b128 v[132:135], v34 offset:1632
    v_and_b32 v55, 0xffff0000, v248
    v_mfma_f32_16x16x32_bf16 v[200:203], v[96:99], v[160:163], v[200:203]
    ds_read2_b32 v[72:73], v32 offset0:96 offset1:97
    v_mul_f32 v52, v52, v53
    v_mfma_f32_16x16x32_bf16 v[200:203], v[100:103], v[156:159], v[200:203]
    ds_read2_b32 v[74:75], v32 offset0:98 offset1:99
    v_mul_f32 v54, v54, v55
    v_mfma_f32_16x16x32_bf16 v[200:203], v[104:107], v[152:155], v[200:203]
    ds_read_b128 v[136:139], v34 offset:2144
    v_cvt_pk_bf16_f32 v52, v52, v54
    s_waitcnt lgkmcnt(15)
    v_mfma_f32_16x16x32_bf16 v[204:207], v[88:91], v[172:175], v[204:207]
    ds_read2_b32 v[76:77], v32 offset0:224 offset1:225
    v_lshlrev_b32 v53, 16, v52
    v_mfma_f32_16x16x32_bf16 v[204:207], v[92:95], v[168:171], v[204:207]
    ds_read2_b32 v[78:79], v32 offset0:226 offset1:227
    v_and_b32 v52, 0xffff0000, v52
    v_mfma_f32_16x16x32_bf16 v[204:207], v[96:99], v[164:167], v[204:207]
    ds_read_b128 v[140:143], v34 offset:2656
    v_add_f32 v252, v252, v53
    v_mfma_f32_16x16x32_bf16 v[204:207], v[100:103], v[160:163], v[204:207]
    ds_read2_b32 v[80:81], v33 offset0:96 offset1:97
    v_add_f32 v253, v253, v52
    v_mfma_f32_16x16x32_bf16 v[204:207], v[104:107], v[156:159], v[204:207]
    ds_read2_b32 v[82:83], v33 offset0:98 offset1:99
    v_lshlrev_b32 v52, 16, v231
    v_mfma_f32_16x16x32_bf16 v[204:207], v[108:111], v[152:155], v[204:207]
    ds_read_b128 v[144:147], v34 offset:3168
    v_lshlrev_b32 v53, 16, v249
    v_mfma_f32_16x16x32_bf16 v[208:211], v[88:91], v[176:179], v[208:211]
    ds_read2_b32 v[84:85], v33 offset0:224 offset1:225
    v_and_b32 v54, 0xffff0000, v231
    v_mfma_f32_16x16x32_bf16 v[208:211], v[92:95], v[172:175], v[208:211]
    ds_read2_b32 v[86:87], v33 offset0:226 offset1:227
    v_and_b32 v55, 0xffff0000, v249
    v_mfma_f32_16x16x32_bf16 v[208:211], v[96:99], v[168:171], v[208:211]
    ds_read_b128 v[148:151], v34 offset:3680
    v_mul_f32 v52, v52, v53
    v_mfma_f32_16x16x32_bf16 v[208:211], v[100:103], v[164:167], v[208:211]
    v_mul_f32 v54, v54, v55
    v_mfma_f32_16x16x32_bf16 v[208:211], v[104:107], v[160:163], v[208:211]
    v_cvt_pk_bf16_f32 v52, v52, v54
    v_mfma_f32_16x16x32_bf16 v[208:211], v[108:111], v[156:159], v[208:211]
    v_lshlrev_b32 v53, 16, v52
    v_mfma_f32_16x16x32_bf16 v[208:211], v[112:115], v[152:155], v[208:211]
    v_and_b32 v52, 0xffff0000, v52
    v_mfma_f32_16x16x32_bf16 v[212:215], v[88:91], v[180:183], v[212:215]
    v_add_f32 v252, v252, v53
    v_mfma_f32_16x16x32_bf16 v[212:215], v[92:95], v[176:179], v[212:215]
    v_add_f32 v253, v253, v52
    v_mfma_f32_16x16x32_bf16 v[212:215], v[96:99], v[172:175], v[212:215]
    v_lshlrev_b32 v52, 16, v232
    v_mfma_f32_16x16x32_bf16 v[212:215], v[100:103], v[168:171], v[212:215]
    v_lshlrev_b32 v53, 16, v250
    v_mfma_f32_16x16x32_bf16 v[212:215], v[104:107], v[164:167], v[212:215]
    v_and_b32 v54, 0xffff0000, v232
    v_mfma_f32_16x16x32_bf16 v[212:215], v[108:111], v[160:163], v[212:215]
    v_and_b32 v55, 0xffff0000, v250
    v_mfma_f32_16x16x32_bf16 v[212:215], v[112:115], v[156:159], v[212:215]
    v_mul_f32 v52, v52, v53
    v_mfma_f32_16x16x32_bf16 v[212:215], v[116:119], v[152:155], v[212:215]
    v_mul_f32 v54, v54, v55
    s_waitcnt lgkmcnt(15)
    v_mfma_f32_16x16x32_bf16 v[184:187], v[56:59], v[120:123], v[184:187]
    ds_read2_b32 v[88:89], v30 offset0:112 offset1:113
    v_cvt_pk_bf16_f32 v52, v52, v54
    v_mfma_f32_16x16x32_bf16 v[188:191], v[56:59], v[124:127], v[188:191]
    ds_read2_b32 v[90:91], v30 offset0:114 offset1:115
    v_lshlrev_b32 v53, 16, v52
    v_mfma_f32_16x16x32_bf16 v[188:191], v[60:63], v[120:123], v[188:191]
    ds_read_b128 v[152:155], v34 offset:32
    v_and_b32 v52, 0xffff0000, v52
    v_mfma_f32_16x16x32_bf16 v[192:195], v[56:59], v[128:131], v[192:195]
    ds_read2_b32 v[92:93], v30 offset0:240 offset1:241
    v_add_f32 v252, v252, v53
    v_mfma_f32_16x16x32_bf16 v[192:195], v[60:63], v[124:127], v[192:195]
    ds_read2_b32 v[94:95], v30 offset0:242 offset1:243
    v_add_f32 v253, v253, v52
    v_mfma_f32_16x16x32_bf16 v[192:195], v[64:67], v[120:123], v[192:195]
    ds_read_b128 v[156:159], v34 offset:544
    v_lshlrev_b32 v52, 16, v233
    s_waitcnt lgkmcnt(15)
    v_mfma_f32_16x16x32_bf16 v[196:199], v[56:59], v[132:135], v[196:199]
    ds_read2_b32 v[96:97], v31 offset0:112 offset1:113
    v_lshlrev_b32 v53, 16, v251
    v_mfma_f32_16x16x32_bf16 v[196:199], v[60:63], v[128:131], v[196:199]
    ds_read2_b32 v[98:99], v31 offset0:114 offset1:115
    v_and_b32 v54, 0xffff0000, v233
    v_mfma_f32_16x16x32_bf16 v[196:199], v[64:67], v[124:127], v[196:199]
    ds_read_b128 v[160:163], v34 offset:1056
    v_and_b32 v55, 0xffff0000, v251
    v_mfma_f32_16x16x32_bf16 v[196:199], v[68:71], v[120:123], v[196:199]
    ds_read2_b32 v[100:101], v31 offset0:240 offset1:241
    v_mul_f32 v52, v52, v53
    v_mfma_f32_16x16x32_bf16 v[200:203], v[56:59], v[136:139], v[200:203]
    ds_read2_b32 v[102:103], v31 offset0:242 offset1:243
    v_mul_f32 v54, v54, v55
    v_mfma_f32_16x16x32_bf16 v[200:203], v[60:63], v[132:135], v[200:203]
    ds_read_b128 v[164:167], v34 offset:1568
    v_cvt_pk_bf16_f32 v52, v52, v54
    v_mfma_f32_16x16x32_bf16 v[200:203], v[64:67], v[128:131], v[200:203]
    ds_read2_b32 v[104:105], v32 offset0:112 offset1:113
    v_lshlrev_b32 v53, 16, v52
    v_mfma_f32_16x16x32_bf16 v[200:203], v[68:71], v[124:127], v[200:203]
    ds_read2_b32 v[106:107], v32 offset0:114 offset1:115
    v_and_b32 v52, 0xffff0000, v52
    v_mfma_f32_16x16x32_bf16 v[200:203], v[72:75], v[120:123], v[200:203]
    ds_read_b128 v[168:171], v34 offset:2080
    v_add_f32 v252, v252, v53
    s_waitcnt lgkmcnt(15)
    v_mfma_f32_16x16x32_bf16 v[204:207], v[56:59], v[140:143], v[204:207]
    ds_read2_b32 v[108:109], v32 offset0:240 offset1:241
    v_add_f32 v253, v253, v52
    v_mfma_f32_16x16x32_bf16 v[204:207], v[60:63], v[136:139], v[204:207]
    ds_read2_b32 v[110:111], v32 offset0:242 offset1:243
    v_add_f32 v252, v252, v253
    v_mfma_f32_16x16x32_bf16 v[204:207], v[64:67], v[132:135], v[204:207]
    ds_read_b128 v[172:175], v34 offset:2592
    s_nop 1
    v_mfma_f32_16x16x32_bf16 v[204:207], v[68:71], v[128:131], v[204:207]
    ds_read2_b32 v[112:113], v33 offset0:112 offset1:113
    v_add_f32_dpp v252, v252, v252 quad_perm:[1,0,3,2] row_mask:0xf bank_mask:0xf
    v_mfma_f32_16x16x32_bf16 v[204:207], v[72:75], v[124:127], v[204:207]
    ds_read2_b32 v[114:115], v33 offset0:114 offset1:115
    s_nop 1
    v_mfma_f32_16x16x32_bf16 v[204:207], v[76:79], v[120:123], v[204:207]
    ds_read_b128 v[176:179], v34 offset:3104
    v_add_f32_dpp v252, v252, v252 quad_perm:[2,3,0,1] row_mask:0xf bank_mask:0xf
    v_mfma_f32_16x16x32_bf16 v[208:211], v[56:59], v[144:147], v[208:211]
    ds_read2_b32 v[116:117], v33 offset0:240 offset1:241
    s_nop 1
    v_mfma_f32_16x16x32_bf16 v[208:211], v[60:63], v[140:143], v[208:211]
    ds_read2_b32 v[118:119], v33 offset0:242 offset1:243
    v_add_f32_dpp v252, v252, v252 row_half_mirror row_mask:0xf bank_mask:0xf
    v_mfma_f32_16x16x32_bf16 v[208:211], v[64:67], v[136:139], v[208:211]
    ds_read_b128 v[180:183], v34 offset:3616
    s_nop 1
    v_mfma_f32_16x16x32_bf16 v[208:211], v[68:71], v[132:135], v[208:211]
    v_add_f32_dpp v252, v252, v252 row_mirror row_mask:0xf bank_mask:0xf
    v_mfma_f32_16x16x32_bf16 v[208:211], v[72:75], v[128:131], v[208:211]
    v_cvt_pk_bf16_f32 v252, v252, v252
    v_mfma_f32_16x16x32_bf16 v[208:211], v[76:79], v[124:127], v[208:211]
    v_and_b32 v252, 0xffff0000, v252
    v_mfma_f32_16x16x32_bf16 v[208:211], v[80:83], v[120:123], v[208:211]
    v_mul_f32 v252, 0xbfb8aa3b, v252
    v_mfma_f32_16x16x32_bf16 v[212:215], v[56:59], v[148:151], v[212:215]
    v_exp_f32 v252, v252
    v_mfma_f32_16x16x32_bf16 v[212:215], v[60:63], v[144:147], v[212:215]
    v_lshlrev_b32 v54, 3, v4
    v_mfma_f32_16x16x32_bf16 v[212:215], v[64:67], v[140:143], v[212:215]
    v_add_f32 v252, 1.0, v252
    v_mfma_f32_16x16x32_bf16 v[212:215], v[68:71], v[136:139], v[212:215]
    v_rcp_f32 v252, v252
    v_mfma_f32_16x16x32_bf16 v[212:215], v[72:75], v[132:135], v[212:215]
    s_nop 0
    v_mfma_f32_16x16x32_bf16 v[212:215], v[76:79], v[128:131], v[212:215]
    v_cvt_pk_bf16_f32 v52, v252, v252
    v_mfma_f32_16x16x32_bf16 v[212:215], v[80:83], v[124:127], v[212:215]
    v_and_b32 v52, 0xffff0000, v52
    v_mfma_f32_16x16x32_bf16 v[212:215], v[84:87], v[120:123], v[212:215]
    v_sub_f32 v53, 1.0, v52
    s_waitcnt lgkmcnt(15)
    v_mfma_f32_16x16x32_bf16 v[184:187], v[88:91], v[152:155], v[184:187]
    v_cvt_pk_bf16_f32 v53, v53, v53
    v_mfma_f32_16x16x32_bf16 v[188:191], v[88:91], v[156:159], v[188:191]
    v_and_b32 v53, 0xffff0000, v53
    v_mfma_f32_16x16x32_bf16 v[188:191], v[92:95], v[152:155], v[188:191]
    v_mfma_f32_16x16x32_bf16 v[192:195], v[88:91], v[160:163], v[192:195]
    v_mfma_f32_16x16x32_bf16 v[192:195], v[92:95], v[156:159], v[192:195]
    v_mfma_f32_16x16x32_bf16 v[192:195], v[96:99], v[152:155], v[192:195]
    s_waitcnt lgkmcnt(12)
    v_mfma_f32_16x16x32_bf16 v[196:199], v[88:91], v[164:167], v[196:199]
    v_mfma_f32_16x16x32_bf16 v[196:199], v[92:95], v[160:163], v[196:199]
    v_mfma_f32_16x16x32_bf16 v[196:199], v[96:99], v[156:159], v[196:199]
    v_mfma_f32_16x16x32_bf16 v[196:199], v[100:103], v[152:155], v[196:199]
    s_waitcnt lgkmcnt(9)
    v_mfma_f32_16x16x32_bf16 v[200:203], v[88:91], v[168:171], v[200:203]
    v_mfma_f32_16x16x32_bf16 v[200:203], v[92:95], v[164:167], v[200:203]
    v_mfma_f32_16x16x32_bf16 v[200:203], v[96:99], v[160:163], v[200:203]
    v_mfma_f32_16x16x32_bf16 v[200:203], v[100:103], v[156:159], v[200:203]
    v_mfma_f32_16x16x32_bf16 v[200:203], v[104:107], v[152:155], v[200:203]
    s_waitcnt lgkmcnt(6)
    v_mfma_f32_16x16x32_bf16 v[204:207], v[88:91], v[172:175], v[204:207]
    v_mfma_f32_16x16x32_bf16 v[204:207], v[92:95], v[168:171], v[204:207]
    v_mfma_f32_16x16x32_bf16 v[204:207], v[96:99], v[164:167], v[204:207]
    v_mfma_f32_16x16x32_bf16 v[204:207], v[100:103], v[160:163], v[204:207]
    v_mfma_f32_16x16x32_bf16 v[204:207], v[104:107], v[156:159], v[204:207]
    v_mfma_f32_16x16x32_bf16 v[204:207], v[108:111], v[152:155], v[204:207]
    s_waitcnt lgkmcnt(3)
    v_mfma_f32_16x16x32_bf16 v[208:211], v[88:91], v[176:179], v[208:211]
    v_mfma_f32_16x16x32_bf16 v[208:211], v[92:95], v[172:175], v[208:211]
    v_mfma_f32_16x16x32_bf16 v[208:211], v[96:99], v[168:171], v[208:211]
    v_mfma_f32_16x16x32_bf16 v[208:211], v[100:103], v[164:167], v[208:211]
    v_mfma_f32_16x16x32_bf16 v[208:211], v[104:107], v[160:163], v[208:211]
    v_mfma_f32_16x16x32_bf16 v[208:211], v[108:111], v[156:159], v[208:211]
    v_mfma_f32_16x16x32_bf16 v[208:211], v[112:115], v[152:155], v[208:211]
    s_waitcnt lgkmcnt(0)
    v_mfma_f32_16x16x32_bf16 v[212:215], v[88:91], v[180:183], v[212:215]
    v_mfma_f32_16x16x32_bf16 v[212:215], v[92:95], v[176:179], v[212:215]
    v_mfma_f32_16x16x32_bf16 v[212:215], v[96:99], v[172:175], v[212:215]
    v_mfma_f32_16x16x32_bf16 v[212:215], v[100:103], v[168:171], v[212:215]
    v_mfma_f32_16x16x32_bf16 v[212:215], v[104:107], v[164:167], v[212:215]
    v_mfma_f32_16x16x32_bf16 v[212:215], v[108:111], v[160:163], v[212:215]
    v_mfma_f32_16x16x32_bf16 v[212:215], v[112:115], v[156:159], v[212:215]
    v_mfma_f32_16x16x32_bf16 v[212:215], v[116:119], v[152:155], v[212:215]
    s_mov_b32 exec_lo, 0x00010001
    s_mov_b32 exec_hi, 0x00010001
    buffer_store_dwordx2 v[52:53], v54, s[16:19], s98 offen sc1
    s_mov_b64 exec, -1
    s_mul_i32 s3, s28, 4294959040
    s_add_u32 s3, s3, 66560
    v_add_u32 v30, s3, v30
    v_add_u32 v31, s3, v31
    v_add_u32 v32, s3, v32
    v_add_u32 v33, s3, v33
    s_mul_i32 s3, s28, 4294962624
    s_add_u32 s3, s3, 36864
    v_add_u32 v34, s3, v34
    v_cvt_pk_bf16_f32 v36, v184, v185
    v_cvt_pk_bf16_f32 v37, v186, v187
    buffer_store_dwordx2 v[36:37], v35, s[16:19], s30 offen offset:0 sc1
    v_cvt_pk_bf16_f32 v38, v188, v189
    v_cvt_pk_bf16_f32 v39, v190, v191
    buffer_store_dwordx2 v[38:39], v35, s[16:19], s30 offen offset:512 sc1
    v_cvt_pk_bf16_f32 v40, v192, v193
    v_cvt_pk_bf16_f32 v41, v194, v195
    buffer_store_dwordx2 v[40:41], v35, s[16:19], s30 offen offset:1024 sc1
    v_cvt_pk_bf16_f32 v42, v196, v197
    v_cvt_pk_bf16_f32 v43, v198, v199
    buffer_store_dwordx2 v[42:43], v35, s[16:19], s30 offen offset:1536 sc1
    v_cvt_pk_bf16_f32 v44, v200, v201
    v_cvt_pk_bf16_f32 v45, v202, v203
    buffer_store_dwordx2 v[44:45], v35, s[16:19], s30 offen offset:2048 sc1
    v_cvt_pk_bf16_f32 v46, v204, v205
    v_cvt_pk_bf16_f32 v47, v206, v207
    buffer_store_dwordx2 v[46:47], v35, s[16:19], s30 offen offset:2560 sc1
    v_cvt_pk_bf16_f32 v48, v208, v209
    v_cvt_pk_bf16_f32 v49, v210, v211
    buffer_store_dwordx2 v[48:49], v35, s[16:19], s30 offen offset:3072 sc1
    v_cvt_pk_bf16_f32 v50, v212, v213
    v_cvt_pk_bf16_f32 v51, v214, v215
    buffer_store_dwordx2 v[50:51], v35, s[16:19], s30 offen offset:3584 sc1
    s_barrier
    ds_read2_b32 v[56:57], v30 offset0:0 offset1:1
    ds_read2_b32 v[58:59], v30 offset0:2 offset1:3
    ds_read_b128 v[120:123], v34 offset:480
    ds_read2_b32 v[60:61], v30 offset0:128 offset1:129
    ds_read2_b32 v[62:63], v30 offset0:130 offset1:131
    ds_read_b128 v[124:127], v34 offset:992
    ds_read2_b32 v[64:65], v31 offset0:0 offset1:1
    ds_read2_b32 v[66:67], v31 offset0:2 offset1:3
    ds_read_b128 v[128:131], v34 offset:1504
    ds_read2_b32 v[68:69], v31 offset0:128 offset1:129
    ds_read2_b32 v[70:71], v31 offset0:130 offset1:131
    ds_read_b128 v[132:135], v34 offset:2016
    s_waitcnt lgkmcnt(9)
    v_mfma_f32_16x16x32_bf16 v[184:187], v[56:59], v[120:123], 0
    ds_read2_b32 v[72:73], v32 offset0:0 offset1:1
    s_waitcnt lgkmcnt(7)
    v_mfma_f32_16x16x32_bf16 v[188:191], v[56:59], v[124:127], 0
    ds_read2_b32 v[74:75], v32 offset0:2 offset1:3
    v_mfma_f32_16x16x32_bf16 v[188:191], v[60:63], v[120:123], v[188:191]
    ds_read_b128 v[136:139], v34 offset:2528
    s_waitcnt lgkmcnt(6)
    v_mfma_f32_16x16x32_bf16 v[192:195], v[56:59], v[128:131], 0
    ds_read2_b32 v[76:77], v32 offset0:128 offset1:129
    v_mfma_f32_16x16x32_bf16 v[192:195], v[60:63], v[124:127], v[192:195]
    ds_read2_b32 v[78:79], v32 offset0:130 offset1:131
    v_mfma_f32_16x16x32_bf16 v[192:195], v[64:67], v[120:123], v[192:195]
    ds_read_b128 v[140:143], v34 offset:3040
    s_waitcnt lgkmcnt(6)
    v_mfma_f32_16x16x32_bf16 v[196:199], v[56:59], v[132:135], 0
    ds_read2_b32 v[80:81], v33 offset0:0 offset1:1
    v_mfma_f32_16x16x32_bf16 v[196:199], v[60:63], v[128:131], v[196:199]
    ds_read2_b32 v[82:83], v33 offset0:2 offset1:3
    v_mfma_f32_16x16x32_bf16 v[196:199], v[64:67], v[124:127], v[196:199]
    ds_read_b128 v[144:147], v34 offset:3552
    v_mfma_f32_16x16x32_bf16 v[196:199], v[68:71], v[120:123], v[196:199]
    ds_read2_b32 v[84:85], v33 offset0:128 offset1:129
    s_waitcnt lgkmcnt(7)
    v_mfma_f32_16x16x32_bf16 v[200:203], v[56:59], v[136:139], 0
    ds_read2_b32 v[86:87], v33 offset0:130 offset1:131
    v_mfma_f32_16x16x32_bf16 v[200:203], v[60:63], v[132:135], v[200:203]
    ds_read_b128 v[148:151], v34 offset:4064
    v_mfma_f32_16x16x32_bf16 v[200:203], v[64:67], v[128:131], v[200:203]
    v_mfma_f32_16x16x32_bf16 v[200:203], v[68:71], v[124:127], v[200:203]
    v_mfma_f32_16x16x32_bf16 v[200:203], v[72:75], v[120:123], v[200:203]
    s_waitcnt lgkmcnt(6)
    v_mfma_f32_16x16x32_bf16 v[204:207], v[56:59], v[140:143], 0
    v_mfma_f32_16x16x32_bf16 v[204:207], v[60:63], v[136:139], v[204:207]
    v_mfma_f32_16x16x32_bf16 v[204:207], v[64:67], v[132:135], v[204:207]
    v_mfma_f32_16x16x32_bf16 v[204:207], v[68:71], v[128:131], v[204:207]
    v_mfma_f32_16x16x32_bf16 v[204:207], v[72:75], v[124:127], v[204:207]
    v_mfma_f32_16x16x32_bf16 v[204:207], v[76:79], v[120:123], v[204:207]
    s_waitcnt lgkmcnt(3)
    v_mfma_f32_16x16x32_bf16 v[208:211], v[56:59], v[144:147], 0
    v_mfma_f32_16x16x32_bf16 v[208:211], v[60:63], v[140:143], v[208:211]
    v_mfma_f32_16x16x32_bf16 v[208:211], v[64:67], v[136:139], v[208:211]
    v_mfma_f32_16x16x32_bf16 v[208:211], v[68:71], v[132:135], v[208:211]
    v_mfma_f32_16x16x32_bf16 v[208:211], v[72:75], v[128:131], v[208:211]
    v_mfma_f32_16x16x32_bf16 v[208:211], v[76:79], v[124:127], v[208:211]
    v_mfma_f32_16x16x32_bf16 v[208:211], v[80:83], v[120:123], v[208:211]
    s_waitcnt lgkmcnt(0)
    v_mfma_f32_16x16x32_bf16 v[212:215], v[56:59], v[148:151], 0
    v_mfma_f32_16x16x32_bf16 v[212:215], v[60:63], v[144:147], v[212:215]
    v_mfma_f32_16x16x32_bf16 v[212:215], v[64:67], v[140:143], v[212:215]
    v_mfma_f32_16x16x32_bf16 v[212:215], v[68:71], v[136:139], v[212:215]
    v_mfma_f32_16x16x32_bf16 v[212:215], v[72:75], v[132:135], v[212:215]
    v_mfma_f32_16x16x32_bf16 v[212:215], v[76:79], v[128:131], v[212:215]
    v_mfma_f32_16x16x32_bf16 v[212:215], v[80:83], v[124:127], v[212:215]
    v_mfma_f32_16x16x32_bf16 v[212:215], v[84:87], v[120:123], v[212:215]
    v_lshl_add_u32 v5, v0, 4, s32
    s_lshl_b32 s3, s28, 10
    s_add_u32 s3, s3, 41472
    v_lshl_add_u32 v12, v0, 4, s3
    s_add_u32 s3, s31, 8
    s_lshl_b32 s3, s3, 12
    s_lshl_b32 s30, s28, 9
    s_add_u32 s30, s30, s3
    s_add_u32 s30, s30, 28311552
    ds_write_b128 v5, v[184:187] offset:0
    ds_write_b128 v5, v[188:191] offset:1024
    ds_write_b128 v5, v[192:195] offset:2048
    ds_write_b128 v5, v[196:199] offset:3072
    ds_write_b128 v5, v[200:203] offset:4096
    ds_write_b128 v5, v[204:207] offset:5120
    ds_write_b128 v5, v[208:211] offset:6144
    ds_write_b128 v5, v[212:215] offset:7168
    s_waitcnt lgkmcnt(0)
    s_barrier
    ds_read_b128 v[8:11], v12 offset:0
    ds_read_b128 v[68:71], v12 offset:8320
    ds_read_b128 v[72:75], v12 offset:16640
    ds_read_b128 v[76:79], v12 offset:24960
    ds_read_b128 v[80:83], v12 offset:33280
    ds_read_b128 v[84:87], v12 offset:41600
    ds_read_b128 v[88:91], v12 offset:49920
    ds_read_b128 v[92:95], v12 offset:58240
    s_waitcnt lgkmcnt(6)
    v_add_f32 v8, v8, v68
    v_add_f32 v9, v9, v69
    v_add_f32 v10, v10, v70
    v_add_f32 v11, v11, v71
    s_waitcnt lgkmcnt(5)
    v_add_f32 v8, v8, v72
    v_add_f32 v9, v9, v73
    v_add_f32 v10, v10, v74
    v_add_f32 v11, v11, v75
    s_waitcnt lgkmcnt(4)
    v_add_f32 v8, v8, v76
    v_add_f32 v9, v9, v77
    v_add_f32 v10, v10, v78
    v_add_f32 v11, v11, v79
    s_waitcnt lgkmcnt(3)
    v_add_f32 v8, v8, v80
    v_add_f32 v9, v9, v81
    v_add_f32 v10, v10, v82
    v_add_f32 v11, v11, v83
    s_waitcnt lgkmcnt(2)
    v_add_f32 v8, v8, v84
    v_add_f32 v9, v9, v85
    v_add_f32 v10, v10, v86
    v_add_f32 v11, v11, v87
    s_waitcnt lgkmcnt(1)
    v_add_f32 v8, v8, v88
    v_add_f32 v9, v9, v89
    v_add_f32 v10, v10, v90
    v_add_f32 v11, v11, v91
    s_waitcnt lgkmcnt(0)
    v_add_f32 v8, v8, v92
    v_add_f32 v9, v9, v93
    v_add_f32 v10, v10, v94
    v_add_f32 v11, v11, v95
    v_cvt_pk_bf16_f32 v8, v8, v9
    v_cvt_pk_bf16_f32 v9, v10, v11
    buffer_store_dwordx2 v[8:9], v35, s[16:19], s30 offen sc1
    v_lshrrev_b32 v5, 5, v0
    v_and_b32 v6, 31, v0
    v_mul_u32_u24 v184, 147456, v5
    v_lshl_add_u32 v184, v6, 4, v184
    v_mul_u32_u24 v187, 144, v6
    v_lshl_add_u32 v187, v5, 3, v187
    s_lshl_b32 s3, s28, 4
    s_add_u32 s3, s3, 41472
    v_add_u32 v187, s3, v187
    v_lshrrev_b32 v7, 3, v0
    s_and_b32 s3, s28, 3
    s_lshl_b32 s3, s3, 3
    v_add_u32 v7, s3, v7
    v_and_b32 v13, 7, v0
    v_lshlrev_b32 v13, 4, v13
    v_mul_u32_u24 v14, 1152, v7
    v_add_u32 v14, v14, v13
    v_mul_u32_u24 v7, 144, v7
    s_lshr_b32 s3, s28, 2
    s_mul_i32 s3, s3, 4608
    s_add_u32 s3, s3, 41472
    v_add3_u32 v13, v7, v13, s3
    v_lshlrev_b32 v182, 3, v6
    v_lshlrev_b32 v185, 18, v5
    v_bfe_u32 v7, v0, 2, 3
    v_lshl_add_u32 v185, v7, 12, v185
    v_and_b32 v7, 3, v0
    v_lshl_add_u32 v185, v7, 4, v185
    v_lshlrev_b32 v186, 3, v7
    v_bfe_u32 v7, v0, 2, 2
    v_lshl_add_u32 v186, v7, 6, v186
    v_bfe_u32 v7, v0, 4, 1
    v_lshl_add_u32 v186, v7, 5, v186
    v_lshl_add_u32 v186, v5, 8, v186
    s_lshl_b32 s75, s28, 12
    v_add_u32 v186, s75, v186
    s_lshr_b32 s33, s29, 2
    s_and_b32 s3, s29, 3
    s_and_b32 s37, s28, 4
    s_add_u32 s3, s3, s37
    s_lshl_b32 s34, s33, 3
    s_add_u32 s34, s34, s3
    s_lshl_b32 s34, s34, 7
    s_add_u32 s34, s34, 30687232
    s_mul_i32 s33, s33, 96
    s_add_u32 s33, s33, s3
    s_mul_i32 s33, s33, 36
    s_and_b32 s3, s28, 3
    s_add_u32 s33, s33, s3
    s_lshl_b32 s33, s33, 9
    s_lshl_b32 s35, s28, 15
    s_lshl_b32 s3, s29, 6
    s_add_u32 s35, s35, s3
    s_add_u32 s35, s35, 28311552
    s_mul_i32 s36, s29, 36864
    s_lshr_b32 s3, s28, 2
    s_lshl_b32 s3, s3, 7
    s_add_u32 s36, s36, s3
    s_mov_b32 s4, s68
    s_mov_b32 s5, s69
    s_mov_b32 s6, 2359296
    s_mov_b32 s7, 0x20000
    v_mov_b32 v188, 0
    s_mov_b64 exec, 1
    buffer_atomic_add v188, off, s[16:19], s34 sc0 sc1
    s_mov_b64 exec, -1
    s_waitcnt vmcnt(0)
    s_barrier
    s_cmp_lg_u32 s28, 0
    s_cbranch_scc1 L_cnt2821
    v_mov_b32 v2, 1
    s_mov_b64 exec, 1
    buffer_atomic_add v2, off, s[20:23], 0 offset:128 sc1
    s_mov_b64 exec, -1
L_cnt2821:
    v_readfirstlane_b32 s99, v188
    s_cmp_ge_u32 s99, 12
    s_cbranch_scc1 L_crf0_ok
    s_mov_b32 s38, 0
L_crf0:
    v_mov_b32 v188, 0
    s_mov_b64 exec, 1
    buffer_atomic_add v188, off, s[16:19], s34 offset:20 sc0 sc1
    s_mov_b64 exec, -1
    s_add_u32 s38, s38, 1
    s_waitcnt vmcnt(0)
    v_readfirstlane_b32 s3, v188
    s_cmp_ge_u32 s3, 12
    s_cbranch_scc1 L_crf0_ok
    s_sleep 4
    s_cmp_lt_u32 s38, 65536
    s_cbranch_scc1 L_crf0
L_crf0_ok:
    s_add_u32 s37, s33, 0
    buffer_load_dwordx4 v[64:67], v184, s[16:19], s37 offen sc1
    s_add_u32 s37, s33, 294912
    buffer_load_dwordx4 v[68:71], v184, s[16:19], s37 offen sc1
    s_add_u32 s37, s33, 589824
    buffer_load_dwordx4 v[72:75], v184, s[16:19], s37 offen sc1
    s_add_u32 s37, s33, 884736
    buffer_load_dwordx4 v[76:79], v184, s[16:19], s37 offen sc1
    s_add_u32 s37, s33, 1179648
    buffer_load_dwordx4 v[80:83], v184, s[16:19], s37 offen sc1
    s_add_u32 s37, s33, 1474560
    buffer_load_dwordx4 v[84:87], v184, s[16:19], s37 offen sc1
    s_cmp_ge_u32 s99, 12
    s_cbranch_scc1 L_crf1_ok
    s_mov_b32 s38, 0
L_crf1:
    v_mov_b32 v188, 0
    s_mov_b64 exec, 1
    buffer_atomic_add v188, off, s[16:19], s34 offset:24 sc0 sc1
    s_mov_b64 exec, -1
    s_add_u32 s38, s38, 1
    s_waitcnt vmcnt(0)
    v_readfirstlane_b32 s3, v188
    s_cmp_ge_u32 s3, 12
    s_cbranch_scc1 L_crf1_ok
    s_sleep 4
    s_cmp_lt_u32 s38, 65536
    s_cbranch_scc1 L_crf1
L_crf1_ok:
    s_add_u32 s37, s33, 2048
    buffer_load_dwordx4 v[88:91], v184, s[16:19], s37 offen sc1
    s_add_u32 s37, s33, 296960
    buffer_load_dwordx4 v[92:95], v184, s[16:19], s37 offen sc1
    s_add_u32 s37, s33, 591872
    buffer_load_dwordx4 v[96:99], v184, s[16:19], s37 offen sc1
    s_add_u32 s37, s33, 886784
    buffer_load_dwordx4 v[100:103], v184, s[16:19], s37 offen sc1
    s_add_u32 s37, s33, 1181696
    buffer_load_dwordx4 v[104:107], v184, s[16:19], s37 offen sc1
    s_add_u32 s37, s33, 1476608
    buffer_load_dwordx4 v[108:111], v184, s[16:19], s37 offen sc1
    s_cmp_ge_u32 s99, 12
    s_cbranch_scc1 L_crf2_ok
    s_mov_b32 s38, 0
L_crf2:
    v_mov_b32 v188, 0
    s_mov_b64 exec, 1
    buffer_atomic_add v188, off, s[16:19], s34 offset:0 sc0 sc1
    s_mov_b64 exec, -1
    s_add_u32 s38, s38, 1
    s_waitcnt vmcnt(0)
    v_readfirstlane_b32 s3, v188
    s_cmp_ge_u32 s3, 12
    s_cbranch_scc1 L_crf2_ok
    s_sleep 4
    s_cmp_lt_u32 s38, 65536
    s_cbranch_scc1 L_crf2
L_crf2_ok:
    v_mov_b32 v188, 0
    s_mov_b64 exec, 1
    buffer_atomic_add v188, off, s[16:19], s34 offset:12 sc0 sc1
    s_mov_b64 exec, -1
    buffer_load_dword v189, off, s[20:23], 0 offset:128 sc1
    s_add_u32 s37, s33, 4096
    buffer_load_dwordx4 v[112:115], v184, s[16:19], s37 offen sc1
    s_add_u32 s37, s33, 299008
    buffer_load_dwordx4 v[116:119], v184, s[16:19], s37 offen sc1
    s_add_u32 s37, s33, 593920
    buffer_load_dwordx4 v[120:123], v184, s[16:19], s37 offen sc1
    s_add_u32 s37, s33, 888832
    buffer_load_dwordx4 v[124:127], v184, s[16:19], s37 offen sc1
    s_add_u32 s37, s33, 1183744
    buffer_load_dwordx4 v[128:131], v184, s[16:19], s37 offen sc1
    s_add_u32 s37, s33, 1478656
    buffer_load_dwordx4 v[132:135], v184, s[16:19], s37 offen sc1
    s_waitcnt vmcnt(19)
    v_lshlrev_b32 v216, 16, v64
    v_and_b32 v217, 0xffff0000, v64
    v_lshlrev_b32 v218, 16, v65
    v_and_b32 v219, 0xffff0000, v65
    v_lshlrev_b32 v140, 16, v66
    v_and_b32 v141, 0xffff0000, v66
    v_lshlrev_b32 v142, 16, v67
    v_and_b32 v143, 0xffff0000, v67
    s_waitcnt vmcnt(18)
    v_lshlrev_b32 v164, 16, v68
    v_and_b32 v165, 0xffff0000, v68
    v_lshlrev_b32 v166, 16, v69
    v_and_b32 v167, 0xffff0000, v69
    v_add_f32 v216, v216, v164
    v_add_f32 v217, v217, v165
    v_add_f32 v218, v218, v166
    v_add_f32 v219, v219, v167
    v_lshlrev_b32 v164, 16, v70
    v_and_b32 v165, 0xffff0000, v70
    v_lshlrev_b32 v166, 16, v71
    v_and_b32 v167, 0xffff0000, v71
    v_add_f32 v140, v140, v164
    v_add_f32 v141, v141, v165
    v_add_f32 v142, v142, v166
    v_add_f32 v143, v143, v167
    s_waitcnt vmcnt(17)
    v_lshlrev_b32 v164, 16, v72
    v_and_b32 v165, 0xffff0000, v72
    v_lshlrev_b32 v166, 16, v73
    v_and_b32 v167, 0xffff0000, v73
    v_add_f32 v216, v216, v164
    v_add_f32 v217, v217, v165
    v_add_f32 v218, v218, v166
    v_add_f32 v219, v219, v167
    v_lshlrev_b32 v164, 16, v74
    v_and_b32 v165, 0xffff0000, v74
    v_lshlrev_b32 v166, 16, v75
    v_and_b32 v167, 0xffff0000, v75
    v_add_f32 v140, v140, v164
    v_add_f32 v141, v141, v165
    v_add_f32 v142, v142, v166
    v_add_f32 v143, v143, v167
    s_waitcnt vmcnt(16)
    v_lshlrev_b32 v164, 16, v76
    v_and_b32 v165, 0xffff0000, v76
    v_lshlrev_b32 v166, 16, v77
    v_and_b32 v167, 0xffff0000, v77
    v_add_f32 v216, v216, v164
    v_add_f32 v217, v217, v165
    v_add_f32 v218, v218, v166
    v_add_f32 v219, v219, v167
    v_lshlrev_b32 v164, 16, v78
    v_and_b32 v165, 0xffff0000, v78
    v_lshlrev_b32 v166, 16, v79
    v_and_b32 v167, 0xffff0000, v79
    v_add_f32 v140, v140, v164
    v_add_f32 v141, v141, v165
    v_add_f32 v142, v142, v166
    v_add_f32 v143, v143, v167
    s_waitcnt vmcnt(15)
    v_lshlrev_b32 v164, 16, v80
    v_and_b32 v165, 0xffff0000, v80
    v_lshlrev_b32 v166, 16, v81
    v_and_b32 v167, 0xffff0000, v81
    v_add_f32 v216, v216, v164
    v_add_f32 v217, v217, v165
    v_add_f32 v218, v218, v166
    v_add_f32 v219, v219, v167
    v_lshlrev_b32 v164, 16, v82
    v_and_b32 v165, 0xffff0000, v82
    v_lshlrev_b32 v166, 16, v83
    v_and_b32 v167, 0xffff0000, v83
    v_add_f32 v140, v140, v164
    v_add_f32 v141, v141, v165
    v_add_f32 v142, v142, v166
    v_add_f32 v143, v143, v167
    s_waitcnt vmcnt(14)
    v_lshlrev_b32 v164, 16, v84
    v_and_b32 v165, 0xffff0000, v84
    v_lshlrev_b32 v166, 16, v85
    v_and_b32 v167, 0xffff0000, v85
    v_add_f32 v216, v216, v164
    v_add_f32 v217, v217, v165
    v_add_f32 v218, v218, v166
    v_add_f32 v219, v219, v167
    v_lshlrev_b32 v164, 16, v86
    v_and_b32 v165, 0xffff0000, v86
    v_lshlrev_b32 v166, 16, v87
    v_and_b32 v167, 0xffff0000, v87
    v_add_f32 v140, v140, v164
    v_add_f32 v141, v141, v165
    v_add_f32 v142, v142, v166
    v_add_f32 v143, v143, v167
    s_nop 1
    v_permlane32_swap_b32 v216, v140
    v_permlane32_swap_b32 v217, v141
    v_permlane32_swap_b32 v218, v142
    v_permlane32_swap_b32 v219, v143
    v_add_f32 v216, v216, v140
    v_add_f32 v217, v217, v141
    v_add_f32 v218, v218, v142
    v_add_f32 v219, v219, v143
    s_waitcnt vmcnt(13)
    v_lshlrev_b32 v220, 16, v88
    v_and_b32 v221, 0xffff0000, v88
    v_lshlrev_b32 v222, 16, v89
    v_and_b32 v223, 0xffff0000, v89
    v_lshlrev_b32 v140, 16, v90
    v_and_b32 v141, 0xffff0000, v90
    v_lshlrev_b32 v142, 16, v91
    v_and_b32 v143, 0xffff0000, v91
    s_waitcnt vmcnt(12)
    v_lshlrev_b32 v164, 16, v92
    v_and_b32 v165, 0xffff0000, v92
    v_lshlrev_b32 v166, 16, v93
    v_and_b32 v167, 0xffff0000, v93
    v_add_f32 v220, v220, v164
    v_add_f32 v221, v221, v165
    v_add_f32 v222, v222, v166
    v_add_f32 v223, v223, v167
    v_lshlrev_b32 v164, 16, v94
    v_and_b32 v165, 0xffff0000, v94
    v_lshlrev_b32 v166, 16, v95
    v_and_b32 v167, 0xffff0000, v95
    v_add_f32 v140, v140, v164
    v_add_f32 v141, v141, v165
    v_add_f32 v142, v142, v166
    v_add_f32 v143, v143, v167
    s_waitcnt vmcnt(11)
    v_lshlrev_b32 v164, 16, v96
    v_and_b32 v165, 0xffff0000, v96
    v_lshlrev_b32 v166, 16, v97
    v_and_b32 v167, 0xffff0000, v97
    v_add_f32 v220, v220, v164
    v_add_f32 v221, v221, v165
    v_add_f32 v222, v222, v166
    v_add_f32 v223, v223, v167
    v_lshlrev_b32 v164, 16, v98
    v_and_b32 v165, 0xffff0000, v98
    v_lshlrev_b32 v166, 16, v99
    v_and_b32 v167, 0xffff0000, v99
    v_add_f32 v140, v140, v164
    v_add_f32 v141, v141, v165
    v_add_f32 v142, v142, v166
    v_add_f32 v143, v143, v167
    s_waitcnt vmcnt(10)
    v_lshlrev_b32 v164, 16, v100
    v_and_b32 v165, 0xffff0000, v100
    v_lshlrev_b32 v166, 16, v101
    v_and_b32 v167, 0xffff0000, v101
    v_add_f32 v220, v220, v164
    v_add_f32 v221, v221, v165
    v_add_f32 v222, v222, v166
    v_add_f32 v223, v223, v167
    v_lshlrev_b32 v164, 16, v102
    v_and_b32 v165, 0xffff0000, v102
    v_lshlrev_b32 v166, 16, v103
    v_and_b32 v167, 0xffff0000, v103
    v_add_f32 v140, v140, v164
    v_add_f32 v141, v141, v165
    v_add_f32 v142, v142, v166
    v_add_f32 v143, v143, v167
    s_waitcnt vmcnt(9)
    v_lshlrev_b32 v164, 16, v104
    v_and_b32 v165, 0xffff0000, v104
    v_lshlrev_b32 v166, 16, v105
    v_and_b32 v167, 0xffff0000, v105
    v_add_f32 v220, v220, v164
    v_add_f32 v221, v221, v165
    v_add_f32 v222, v222, v166
    v_add_f32 v223, v223, v167
    v_lshlrev_b32 v164, 16, v106
    v_and_b32 v165, 0xffff0000, v106
    v_lshlrev_b32 v166, 16, v107
    v_and_b32 v167, 0xffff0000, v107
    v_add_f32 v140, v140, v164
    v_add_f32 v141, v141, v165
    v_add_f32 v142, v142, v166
    v_add_f32 v143, v143, v167
    s_waitcnt vmcnt(8)
    v_lshlrev_b32 v164, 16, v108
    v_and_b32 v165, 0xffff0000, v108
    v_lshlrev_b32 v166, 16, v109
    v_and_b32 v167, 0xffff0000, v109
    v_add_f32 v220, v220, v164
    v_add_f32 v221, v221, v165
    v_add_f32 v222, v222, v166
    v_add_f32 v223, v223, v167
    v_lshlrev_b32 v164, 16, v110
    v_and_b32 v165, 0xffff0000, v110
    v_lshlrev_b32 v166, 16, v111
    v_and_b32 v167, 0xffff0000, v111
    v_add_f32 v140, v140, v164
    v_add_f32 v141, v141, v165
    v_add_f32 v142, v142, v166
    v_add_f32 v143, v143, v167
    s_nop 1
    v_permlane32_swap_b32 v220, v140
    v_permlane32_swap_b32 v221, v141
    v_permlane32_swap_b32 v222, v142
    v_permlane32_swap_b32 v223, v143
    v_add_f32 v220, v220, v140
    v_add_f32 v221, v221, v141
    v_add_f32 v222, v222, v142
    v_add_f32 v223, v223, v143
    s_waitcnt vmcnt(7)
    v_readfirstlane_b32 s3, v188
    s_cmp_ge_u32 s3, 12
    s_cbranch_scc1 L_cr3_ok
    s_mov_b32 s38, 0
L_cr3:
    v_mov_b32 v188, 0
    s_mov_b64 exec, 1
    buffer_atomic_add v188, off, s[16:19], s34 offset:12 sc0 sc1
    s_mov_b64 exec, -1
    s_add_u32 s38, s38, 1
    s_waitcnt vmcnt(0)
    v_readfirstlane_b32 s3, v188
    s_cmp_ge_u32 s3, 12
    s_cbranch_scc1 L_cr3_ok
    s_sleep 4
    s_cmp_lt_u32 s38, 65536
    s_cbranch_scc1 L_cr3
L_cr3_ok:
    v_mov_b32 v188, 0
    s_mov_b64 exec, 1
    buffer_atomic_add v188, off, s[16:19], s34 offset:16 sc0 sc1
    s_mov_b64 exec, -1
    s_add_u32 s37, s33, 6144
    buffer_load_dwordx4 v[64:67], v184, s[16:19], s37 offen sc1
    s_add_u32 s37, s33, 301056
    buffer_load_dwordx4 v[68:71], v184, s[16:19], s37 offen sc1
    s_add_u32 s37, s33, 595968
    buffer_load_dwordx4 v[72:75], v184, s[16:19], s37 offen sc1
    s_add_u32 s37, s33, 890880
    buffer_load_dwordx4 v[76:79], v184, s[16:19], s37 offen sc1
    s_add_u32 s37, s33, 1185792
    buffer_load_dwordx4 v[80:83], v184, s[16:19], s37 offen sc1
    s_add_u32 s37, s33, 1480704
    buffer_load_dwordx4 v[84:87], v184, s[16:19], s37 offen sc1
    s_waitcnt vmcnt(13)
    v_readfirstlane_b32 s3, v189
    s_cmp_ge_u32 s3, 64
    s_cbranch_scc1 L_crd_ok
    s_mov_b32 s38, 0
L_crd:
    buffer_load_dword v189, off, s[20:23], 0 offset:128 sc1
    s_add_u32 s38, s38, 1
    s_waitcnt vmcnt(0)
    v_readfirstlane_b32 s3, v189
    s_cmp_ge_u32 s3, 64
    s_cbranch_scc1 L_crd_ok
    s_sleep 4
    s_cmp_lt_u32 s38, 65536
    s_cbranch_scc1 L_crd
L_crd_ok:
    s_lshl_b32 s37, s29, 8
    s_add_u32 s37, s37, 30670848
    buffer_load_dwordx2 v[182:183], v182, s[16:19], s37 offen sc1
    s_add_u32 m0, s75, 0
    s_add_u32 s37, s35, 0
    buffer_load_dwordx4 v185, s[16:19], s37 offen sc1 lds
    s_add_u32 m0, s75, 1024
    s_add_u32 s37, s35, 524288
    buffer_load_dwordx4 v185, s[16:19], s37 offen sc1 lds
    s_add_u32 m0, s75, 2048
    s_add_u32 s37, s35, 1048576
    buffer_load_dwordx4 v185, s[16:19], s37 offen sc1 lds
    s_waitcnt vmcnt(16)
    v_lshlrev_b32 v224, 16, v112
    v_and_b32 v225, 0xffff0000, v112
    v_lshlrev_b32 v226, 16, v113
    v_and_b32 v227, 0xffff0000, v113
    v_lshlrev_b32 v140, 16, v114
    v_and_b32 v141, 0xffff0000, v114
    v_lshlrev_b32 v142, 16, v115
    v_and_b32 v143, 0xffff0000, v115
    s_waitcnt vmcnt(15)
    v_lshlrev_b32 v164, 16, v116
    v_and_b32 v165, 0xffff0000, v116
    v_lshlrev_b32 v166, 16, v117
    v_and_b32 v167, 0xffff0000, v117
    v_add_f32 v224, v224, v164
    v_add_f32 v225, v225, v165
    v_add_f32 v226, v226, v166
    v_add_f32 v227, v227, v167
    v_lshlrev_b32 v164, 16, v118
    v_and_b32 v165, 0xffff0000, v118
    v_lshlrev_b32 v166, 16, v119
    v_and_b32 v167, 0xffff0000, v119
    v_add_f32 v140, v140, v164
    v_add_f32 v141, v141, v165
    v_add_f32 v142, v142, v166
    v_add_f32 v143, v143, v167
    s_waitcnt vmcnt(14)
    v_lshlrev_b32 v164, 16, v120
    v_and_b32 v165, 0xffff0000, v120
    v_lshlrev_b32 v166, 16, v121
    v_and_b32 v167, 0xffff0000, v121
    v_add_f32 v224, v224, v164
    v_add_f32 v225, v225, v165
    v_add_f32 v226, v226, v166
    v_add_f32 v227, v227, v167
    v_lshlrev_b32 v164, 16, v122
    v_and_b32 v165, 0xffff0000, v122
    v_lshlrev_b32 v166, 16, v123
    v_and_b32 v167, 0xffff0000, v123
    v_add_f32 v140, v140, v164
    v_add_f32 v141, v141, v165
    v_add_f32 v142, v142, v166
    v_add_f32 v143, v143, v167
    s_waitcnt vmcnt(13)
    v_lshlrev_b32 v164, 16, v124
    v_and_b32 v165, 0xffff0000, v124
    v_lshlrev_b32 v166, 16, v125
    v_and_b32 v167, 0xffff0000, v125
    v_add_f32 v224, v224, v164
    v_add_f32 v225, v225, v165
    v_add_f32 v226, v226, v166
    v_add_f32 v227, v227, v167
    v_lshlrev_b32 v164, 16, v126
    v_and_b32 v165, 0xffff0000, v126
    v_lshlrev_b32 v166, 16, v127
    v_and_b32 v167, 0xffff0000, v127
    v_add_f32 v140, v140, v164
    v_add_f32 v141, v141, v165
    v_add_f32 v142, v142, v166
    v_add_f32 v143, v143, v167
    s_waitcnt vmcnt(12)
    v_lshlrev_b32 v164, 16, v128
    v_and_b32 v165, 0xffff0000, v128
    v_lshlrev_b32 v166, 16, v129
    v_and_b32 v167, 0xffff0000, v129
    v_add_f32 v224, v224, v164
    v_add_f32 v225, v225, v165
    v_add_f32 v226, v226, v166
    v_add_f32 v227, v227, v167
    v_lshlrev_b32 v164, 16, v130
    v_and_b32 v165, 0xffff0000, v130
    v_lshlrev_b32 v166, 16, v131
    v_and_b32 v167, 0xffff0000, v131
    v_add_f32 v140, v140, v164
    v_add_f32 v141, v141, v165
    v_add_f32 v142, v142, v166
    v_add_f32 v143, v143, v167
    s_waitcnt vmcnt(11)
    v_lshlrev_b32 v164, 16, v132
    v_and_b32 v165, 0xffff0000, v132
    v_lshlrev_b32 v166, 16, v133
    v_and_b32 v167, 0xffff0000, v133
    v_add_f32 v224, v224, v164
    v_add_f32 v225, v225, v165
    v_add_f32 v226, v226, v166
    v_add_f32 v227, v227, v167
    v_lshlrev_b32 v164, 16, v134
    v_and_b32 v165, 0xffff0000, v134
    v_lshlrev_b32 v166, 16, v135
    v_and_b32 v167, 0xffff0000, v135
    v_add_f32 v140, v140, v164
    v_add_f32 v141, v141, v165
    v_add_f32 v142, v142, v166
    v_add_f32 v143, v143, v167
    s_nop 1
    v_permlane32_swap_b32 v224, v140
    v_permlane32_swap_b32 v225, v141
    v_permlane32_swap_b32 v226, v142
    v_permlane32_swap_b32 v227, v143
    v_add_f32 v224, v224, v140
    v_add_f32 v225, v225, v141
    v_add_f32 v226, v226, v142
    v_add_f32 v227, v227, v143
    s_waitcnt vmcnt(10)
    v_readfirstlane_b32 s3, v188
    s_cmp_ge_u32 s3, 12
    s_cbranch_scc1 L_cr4_ok
    s_mov_b32 s38, 0
L_cr4:
    v_mov_b32 v188, 0
    s_mov_b64 exec, 1
    buffer_atomic_add v188, off, s[16:19], s34 offset:16 sc0 sc1
    s_mov_b64 exec, -1
    s_add_u32 s38, s38, 1
    s_waitcnt vmcnt(0)
    v_readfirstlane_b32 s3, v188
    s_cmp_ge_u32 s3, 12
    s_cbranch_scc1 L_cr4_ok
    s_sleep 4
    s_cmp_lt_u32 s38, 65536
    s_cbranch_scc1 L_cr4
L_cr4_ok:
    v_mov_b32 v188, 0
    s_mov_b64 exec, 1
    buffer_atomic_add v188, off, s[16:19], s34 offset:4 sc0 sc1
    s_mov_b64 exec, -1
    s_add_u32 s37, s33, 8192
    buffer_load_dwordx4 v[88:91], v184, s[16:19], s37 offen sc1
    s_add_u32 s37, s33, 303104
    buffer_load_dwordx4 v[92:95], v184, s[16:19], s37 offen sc1
    s_add_u32 s37, s33, 598016
    buffer_load_dwordx4 v[96:99], v184, s[16:19], s37 offen sc1
    s_add_u32 s37, s33, 892928
    buffer_load_dwordx4 v[100:103], v184, s[16:19], s37 offen sc1
    s_add_u32 s37, s33, 1187840
    buffer_load_dwordx4 v[104:107], v184, s[16:19], s37 offen sc1
    s_add_u32 s37, s33, 1482752
    buffer_load_dwordx4 v[108:111], v184, s[16:19], s37 offen sc1
    s_waitcnt vmcnt(16)
    v_lshlrev_b32 v228, 16, v64
    v_and_b32 v229, 0xffff0000, v64
    v_lshlrev_b32 v230, 16, v65
    v_and_b32 v231, 0xffff0000, v65
    v_lshlrev_b32 v140, 16, v66
    v_and_b32 v141, 0xffff0000, v66
    v_lshlrev_b32 v142, 16, v67
    v_and_b32 v143, 0xffff0000, v67
    s_waitcnt vmcnt(15)
    v_lshlrev_b32 v164, 16, v68
    v_and_b32 v165, 0xffff0000, v68
    v_lshlrev_b32 v166, 16, v69
    v_and_b32 v167, 0xffff0000, v69
    v_add_f32 v228, v228, v164
    v_add_f32 v229, v229, v165
    v_add_f32 v230, v230, v166
    v_add_f32 v231, v231, v167
    v_lshlrev_b32 v164, 16, v70
    v_and_b32 v165, 0xffff0000, v70
    v_lshlrev_b32 v166, 16, v71
    v_and_b32 v167, 0xffff0000, v71
    v_add_f32 v140, v140, v164
    v_add_f32 v141, v141, v165
    v_add_f32 v142, v142, v166
    v_add_f32 v143, v143, v167
    s_waitcnt vmcnt(14)
    v_lshlrev_b32 v164, 16, v72
    v_and_b32 v165, 0xffff0000, v72
    v_lshlrev_b32 v166, 16, v73
    v_and_b32 v167, 0xffff0000, v73
    v_add_f32 v228, v228, v164
    v_add_f32 v229, v229, v165
    v_add_f32 v230, v230, v166
    v_add_f32 v231, v231, v167
    v_lshlrev_b32 v164, 16, v74
    v_and_b32 v165, 0xffff0000, v74
    v_lshlrev_b32 v166, 16, v75
    v_and_b32 v167, 0xffff0000, v75
    v_add_f32 v140, v140, v164
    v_add_f32 v141, v141, v165
    v_add_f32 v142, v142, v166
    v_add_f32 v143, v143, v167
    s_waitcnt vmcnt(13)
    v_lshlrev_b32 v164, 16, v76
    v_and_b32 v165, 0xffff0000, v76
    v_lshlrev_b32 v166, 16, v77
    v_and_b32 v167, 0xffff0000, v77
    v_add_f32 v228, v228, v164
    v_add_f32 v229, v229, v165
    v_add_f32 v230, v230, v166
    v_add_f32 v231, v231, v167
    v_lshlrev_b32 v164, 16, v78
    v_and_b32 v165, 0xffff0000, v78
    v_lshlrev_b32 v166, 16, v79
    v_and_b32 v167, 0xffff0000, v79
    v_add_f32 v140, v140, v164
    v_add_f32 v141, v141, v165
    v_add_f32 v142, v142, v166
    v_add_f32 v143, v143, v167
    s_waitcnt vmcnt(12)
    v_lshlrev_b32 v164, 16, v80
    v_and_b32 v165, 0xffff0000, v80
    v_lshlrev_b32 v166, 16, v81
    v_and_b32 v167, 0xffff0000, v81
    v_add_f32 v228, v228, v164
    v_add_f32 v229, v229, v165
    v_add_f32 v230, v230, v166
    v_add_f32 v231, v231, v167
    v_lshlrev_b32 v164, 16, v82
    v_and_b32 v165, 0xffff0000, v82
    v_lshlrev_b32 v166, 16, v83
    v_and_b32 v167, 0xffff0000, v83
    v_add_f32 v140, v140, v164
    v_add_f32 v141, v141, v165
    v_add_f32 v142, v142, v166
    v_add_f32 v143, v143, v167
    s_waitcnt vmcnt(11)
    v_lshlrev_b32 v164, 16, v84
    v_and_b32 v165, 0xffff0000, v84
    v_lshlrev_b32 v166, 16, v85
    v_and_b32 v167, 0xffff0000, v85
    v_add_f32 v228, v228, v164
    v_add_f32 v229, v229, v165
    v_add_f32 v230, v230, v166
    v_add_f32 v231, v231, v167
    v_lshlrev_b32 v164, 16, v86
    v_and_b32 v165, 0xffff0000, v86
    v_lshlrev_b32 v166, 16, v87
    v_and_b32 v167, 0xffff0000, v87
    v_add_f32 v140, v140, v164
    v_add_f32 v141, v141, v165
    v_add_f32 v142, v142, v166
    v_add_f32 v143, v143, v167
    s_nop 1
    v_permlane32_swap_b32 v228, v140
    v_permlane32_swap_b32 v229, v141
    v_permlane32_swap_b32 v230, v142
    v_permlane32_swap_b32 v231, v143
    v_add_f32 v228, v228, v140
    v_add_f32 v229, v229, v141
    v_add_f32 v230, v230, v142
    v_add_f32 v231, v231, v143
    s_waitcnt vmcnt(6)
    v_readfirstlane_b32 s3, v188
    s_cmp_ge_u32 s3, 12
    s_cbranch_scc1 L_cr5_ok
    s_mov_b32 s38, 0
L_cr5:
    v_mov_b32 v188, 0
    s_mov_b64 exec, 1
    buffer_atomic_add v188, off, s[16:19], s34 offset:4 sc0 sc1
    s_mov_b64 exec, -1
    s_add_u32 s38, s38, 1
    s_waitcnt vmcnt(0)
    v_readfirstlane_b32 s3, v188
    s_cmp_ge_u32 s3, 12
    s_cbranch_scc1 L_cr5_ok
    s_sleep 4
    s_cmp_lt_u32 s38, 65536
    s_cbranch_scc1 L_cr5
L_cr5_ok:
    s_add_u32 s37, s33, 10240
    buffer_load_dwordx4 v[112:115], v184, s[16:19], s37 offen sc1
    s_add_u32 s37, s33, 305152
    buffer_load_dwordx4 v[116:119], v184, s[16:19], s37 offen sc1
    s_add_u32 s37, s33, 600064
    buffer_load_dwordx4 v[120:123], v184, s[16:19], s37 offen sc1
    s_add_u32 s37, s33, 894976
    buffer_load_dwordx4 v[124:127], v184, s[16:19], s37 offen sc1
    s_add_u32 s37, s33, 1189888
    buffer_load_dwordx4 v[128:131], v184, s[16:19], s37 offen sc1
    s_add_u32 s37, s33, 1484800
    buffer_load_dwordx4 v[132:135], v184, s[16:19], s37 offen sc1
    ds_read_b64_tr_b16 v[192:193], v186 offset:0
    ds_read_b64_tr_b16 v[196:197], v186 offset:512
    ds_read_b64_tr_b16 v[200:201], v186 offset:1024
    ds_read_b64_tr_b16 v[204:205], v186 offset:1536
    ds_read_b64_tr_b16 v[208:209], v186 offset:2048
    ds_read_b64_tr_b16 v[212:213], v186 offset:2560
    s_waitcnt lgkmcnt(0)
    v_and_b32 v195, 0xffff0000, v193
    v_lshlrev_b32 v194, 16, v193
    v_and_b32 v193, 0xffff0000, v192
    v_lshlrev_b32 v192, 16, v192
    v_mul_f32 v216, v183, v216
    v_mul_f32 v217, v183, v217
    v_mul_f32 v218, v183, v218
    v_mul_f32 v219, v183, v219
    v_fmac_f32 v216, v182, v192
    v_fmac_f32 v217, v182, v193
    v_fmac_f32 v218, v182, v194
    v_fmac_f32 v219, v182, v195
    v_cvt_pk_bf16_f32 v216, v216, v217
    v_cvt_pk_bf16_f32 v217, v218, v219
    ds_write_b64 v187, v[216:217] offset:0
    v_and_b32 v199, 0xffff0000, v197
    v_lshlrev_b32 v198, 16, v197
    v_and_b32 v197, 0xffff0000, v196
    v_lshlrev_b32 v196, 16, v196
    v_mul_f32 v220, v183, v220
    v_mul_f32 v221, v183, v221
    v_mul_f32 v222, v183, v222
    v_mul_f32 v223, v183, v223
    v_fmac_f32 v220, v182, v196
    v_fmac_f32 v221, v182, v197
    v_fmac_f32 v222, v182, v198
    v_fmac_f32 v223, v182, v199
    v_cvt_pk_bf16_f32 v220, v220, v221
    v_cvt_pk_bf16_f32 v221, v222, v223
    ds_write_b64 v187, v[220:221] offset:4608
    v_and_b32 v203, 0xffff0000, v201
    v_lshlrev_b32 v202, 16, v201
    v_and_b32 v201, 0xffff0000, v200
    v_lshlrev_b32 v200, 16, v200
    v_mul_f32 v224, v183, v224
    v_mul_f32 v225, v183, v225
    v_mul_f32 v226, v183, v226
    v_mul_f32 v227, v183, v227
    v_fmac_f32 v224, v182, v200
    v_fmac_f32 v225, v182, v201
    v_fmac_f32 v226, v182, v202
    v_fmac_f32 v227, v182, v203
    v_cvt_pk_bf16_f32 v224, v224, v225
    v_cvt_pk_bf16_f32 v225, v226, v227
    ds_write_b64 v187, v[224:225] offset:9216
    v_and_b32 v207, 0xffff0000, v205
    v_lshlrev_b32 v206, 16, v205
    v_and_b32 v205, 0xffff0000, v204
    v_lshlrev_b32 v204, 16, v204
    v_mul_f32 v228, v183, v228
    v_mul_f32 v229, v183, v229
    v_mul_f32 v230, v183, v230
    v_mul_f32 v231, v183, v231
    v_fmac_f32 v228, v182, v204
    v_fmac_f32 v229, v182, v205
    v_fmac_f32 v230, v182, v206
    v_fmac_f32 v231, v182, v207
    v_cvt_pk_bf16_f32 v228, v228, v229
    v_cvt_pk_bf16_f32 v229, v230, v231
    ds_write_b64 v187, v[228:229] offset:13824
    s_waitcnt vmcnt(11)
    v_lshlrev_b32 v232, 16, v88
    v_and_b32 v233, 0xffff0000, v88
    v_lshlrev_b32 v234, 16, v89
    v_and_b32 v235, 0xffff0000, v89
    v_lshlrev_b32 v140, 16, v90
    v_and_b32 v141, 0xffff0000, v90
    v_lshlrev_b32 v142, 16, v91
    v_and_b32 v143, 0xffff0000, v91
    s_waitcnt vmcnt(10)
    v_lshlrev_b32 v164, 16, v92
    v_and_b32 v165, 0xffff0000, v92
    v_lshlrev_b32 v166, 16, v93
    v_and_b32 v167, 0xffff0000, v93
    v_add_f32 v232, v232, v164
    v_add_f32 v233, v233, v165
    v_add_f32 v234, v234, v166
    v_add_f32 v235, v235, v167
    v_lshlrev_b32 v164, 16, v94
    v_and_b32 v165, 0xffff0000, v94
    v_lshlrev_b32 v166, 16, v95
    v_and_b32 v167, 0xffff0000, v95
    v_add_f32 v140, v140, v164
    v_add_f32 v141, v141, v165
    v_add_f32 v142, v142, v166
    v_add_f32 v143, v143, v167
    s_waitcnt vmcnt(9)
    v_lshlrev_b32 v164, 16, v96
    v_and_b32 v165, 0xffff0000, v96
    v_lshlrev_b32 v166, 16, v97
    v_and_b32 v167, 0xffff0000, v97
    v_add_f32 v232, v232, v164
    v_add_f32 v233, v233, v165
    v_add_f32 v234, v234, v166
    v_add_f32 v235, v235, v167
    v_lshlrev_b32 v164, 16, v98
    v_and_b32 v165, 0xffff0000, v98
    v_lshlrev_b32 v166, 16, v99
    v_and_b32 v167, 0xffff0000, v99
    v_add_f32 v140, v140, v164
    v_add_f32 v141, v141, v165
    v_add_f32 v142, v142, v166
    v_add_f32 v143, v143, v167
    s_waitcnt vmcnt(8)
    v_lshlrev_b32 v164, 16, v100
    v_and_b32 v165, 0xffff0000, v100
    v_lshlrev_b32 v166, 16, v101
    v_and_b32 v167, 0xffff0000, v101
    v_add_f32 v232, v232, v164
    v_add_f32 v233, v233, v165
    v_add_f32 v234, v234, v166
    v_add_f32 v235, v235, v167
    v_lshlrev_b32 v164, 16, v102
    v_and_b32 v165, 0xffff0000, v102
    v_lshlrev_b32 v166, 16, v103
    v_and_b32 v167, 0xffff0000, v103
    v_add_f32 v140, v140, v164
    v_add_f32 v141, v141, v165
    v_add_f32 v142, v142, v166
    v_add_f32 v143, v143, v167
    s_waitcnt vmcnt(7)
    v_lshlrev_b32 v164, 16, v104
    v_and_b32 v165, 0xffff0000, v104
    v_lshlrev_b32 v166, 16, v105
    v_and_b32 v167, 0xffff0000, v105
    v_add_f32 v232, v232, v164
    v_add_f32 v233, v233, v165
    v_add_f32 v234, v234, v166
    v_add_f32 v235, v235, v167
    v_lshlrev_b32 v164, 16, v106
    v_and_b32 v165, 0xffff0000, v106
    v_lshlrev_b32 v166, 16, v107
    v_and_b32 v167, 0xffff0000, v107
    v_add_f32 v140, v140, v164
    v_add_f32 v141, v141, v165
    v_add_f32 v142, v142, v166
    v_add_f32 v143, v143, v167
    s_waitcnt vmcnt(6)
    v_lshlrev_b32 v164, 16, v108
    v_and_b32 v165, 0xffff0000, v108
    v_lshlrev_b32 v166, 16, v109
    v_and_b32 v167, 0xffff0000, v109
    v_add_f32 v232, v232, v164
    v_add_f32 v233, v233, v165
    v_add_f32 v234, v234, v166
    v_add_f32 v235, v235, v167
    v_lshlrev_b32 v164, 16, v110
    v_and_b32 v165, 0xffff0000, v110
    v_lshlrev_b32 v166, 16, v111
    v_and_b32 v167, 0xffff0000, v111
    v_add_f32 v140, v140, v164
    v_add_f32 v141, v141, v165
    v_add_f32 v142, v142, v166
    v_add_f32 v143, v143, v167
    s_nop 1
    v_permlane32_swap_b32 v232, v140
    v_permlane32_swap_b32 v233, v141
    v_permlane32_swap_b32 v234, v142
    v_permlane32_swap_b32 v235, v143
    v_add_f32 v232, v232, v140
    v_add_f32 v233, v233, v141
    v_add_f32 v234, v234, v142
    v_add_f32 v235, v235, v143
    s_waitcnt lgkmcnt(0)
    s_barrier
    ds_read_b128 v[16:19], v13 offset:0
    ds_read_b128 v[20:23], v13 offset:9216
    s_waitcnt lgkmcnt(1)
    buffer_store_dwordx4 v[16:19], v14, s[4:7], s36 offen offset:0 sc1
    s_waitcnt lgkmcnt(0)
    buffer_store_dwordx4 v[20:23], v14, s[4:7], s36 offen offset:256 sc1
    v_and_b32 v211, 0xffff0000, v209
    v_lshlrev_b32 v210, 16, v209
    v_and_b32 v209, 0xffff0000, v208
    v_lshlrev_b32 v208, 16, v208
    v_mul_f32 v232, v183, v232
    v_mul_f32 v233, v183, v233
    v_mul_f32 v234, v183, v234
    v_mul_f32 v235, v183, v235
    v_fmac_f32 v232, v182, v208
    v_fmac_f32 v233, v182, v209
    v_fmac_f32 v234, v182, v210
    v_fmac_f32 v235, v182, v211
    v_cvt_pk_bf16_f32 v232, v232, v233
    v_cvt_pk_bf16_f32 v233, v234, v235
    ds_write_b64 v187, v[232:233] offset:18432
    s_waitcnt vmcnt(7)
    v_lshlrev_b32 v236, 16, v112
    v_and_b32 v237, 0xffff0000, v112
    v_lshlrev_b32 v238, 16, v113
    v_and_b32 v239, 0xffff0000, v113
    v_lshlrev_b32 v140, 16, v114
    v_and_b32 v141, 0xffff0000, v114
    v_lshlrev_b32 v142, 16, v115
    v_and_b32 v143, 0xffff0000, v115
    s_waitcnt vmcnt(6)
    v_lshlrev_b32 v164, 16, v116
    v_and_b32 v165, 0xffff0000, v116
    v_lshlrev_b32 v166, 16, v117
    v_and_b32 v167, 0xffff0000, v117
    v_add_f32 v236, v236, v164
    v_add_f32 v237, v237, v165
    v_add_f32 v238, v238, v166
    v_add_f32 v239, v239, v167
    v_lshlrev_b32 v164, 16, v118
    v_and_b32 v165, 0xffff0000, v118
    v_lshlrev_b32 v166, 16, v119
    v_and_b32 v167, 0xffff0000, v119
    v_add_f32 v140, v140, v164
    v_add_f32 v141, v141, v165
    v_add_f32 v142, v142, v166
    v_add_f32 v143, v143, v167
    s_waitcnt vmcnt(5)
    v_lshlrev_b32 v164, 16, v120
    v_and_b32 v165, 0xffff0000, v120
    v_lshlrev_b32 v166, 16, v121
    v_and_b32 v167, 0xffff0000, v121
    v_add_f32 v236, v236, v164
    v_add_f32 v237, v237, v165
    v_add_f32 v238, v238, v166
    v_add_f32 v239, v239, v167
    v_lshlrev_b32 v164, 16, v122
    v_and_b32 v165, 0xffff0000, v122
    v_lshlrev_b32 v166, 16, v123
    v_and_b32 v167, 0xffff0000, v123
    v_add_f32 v140, v140, v164
    v_add_f32 v141, v141, v165
    v_add_f32 v142, v142, v166
    v_add_f32 v143, v143, v167
    s_waitcnt vmcnt(4)
    v_lshlrev_b32 v164, 16, v124
    v_and_b32 v165, 0xffff0000, v124
    v_lshlrev_b32 v166, 16, v125
    v_and_b32 v167, 0xffff0000, v125
    v_add_f32 v236, v236, v164
    v_add_f32 v237, v237, v165
    v_add_f32 v238, v238, v166
    v_add_f32 v239, v239, v167
    v_lshlrev_b32 v164, 16, v126
    v_and_b32 v165, 0xffff0000, v126
    v_lshlrev_b32 v166, 16, v127
    v_and_b32 v167, 0xffff0000, v127
    v_add_f32 v140, v140, v164
    v_add_f32 v141, v141, v165
    v_add_f32 v142, v142, v166
    v_add_f32 v143, v143, v167
    s_waitcnt vmcnt(3)
    v_lshlrev_b32 v164, 16, v128
    v_and_b32 v165, 0xffff0000, v128
    v_lshlrev_b32 v166, 16, v129
    v_and_b32 v167, 0xffff0000, v129
    v_add_f32 v236, v236, v164
    v_add_f32 v237, v237, v165
    v_add_f32 v238, v238, v166
    v_add_f32 v239, v239, v167
    v_lshlrev_b32 v164, 16, v130
    v_and_b32 v165, 0xffff0000, v130
    v_lshlrev_b32 v166, 16, v131
    v_and_b32 v167, 0xffff0000, v131
    v_add_f32 v140, v140, v164
    v_add_f32 v141, v141, v165
    v_add_f32 v142, v142, v166
    v_add_f32 v143, v143, v167
    s_waitcnt vmcnt(2)
    v_lshlrev_b32 v164, 16, v132
    v_and_b32 v165, 0xffff0000, v132
    v_lshlrev_b32 v166, 16, v133
    v_and_b32 v167, 0xffff0000, v133
    v_add_f32 v236, v236, v164
    v_add_f32 v237, v237, v165
    v_add_f32 v238, v238, v166
    v_add_f32 v239, v239, v167
    v_lshlrev_b32 v164, 16, v134
    v_and_b32 v165, 0xffff0000, v134
    v_lshlrev_b32 v166, 16, v135
    v_and_b32 v167, 0xffff0000, v135
    v_add_f32 v140, v140, v164
    v_add_f32 v141, v141, v165
    v_add_f32 v142, v142, v166
    v_add_f32 v143, v143, v167
    s_nop 1
    v_permlane32_swap_b32 v236, v140
    v_permlane32_swap_b32 v237, v141
    v_permlane32_swap_b32 v238, v142
    v_permlane32_swap_b32 v239, v143
    v_add_f32 v236, v236, v140
    v_add_f32 v237, v237, v141
    v_add_f32 v238, v238, v142
    v_add_f32 v239, v239, v143
    v_and_b32 v215, 0xffff0000, v213
    v_lshlrev_b32 v214, 16, v213
    v_and_b32 v213, 0xffff0000, v212
    v_lshlrev_b32 v212, 16, v212
    v_mul_f32 v236, v183, v236
    v_mul_f32 v237, v183, v237
    v_mul_f32 v238, v183, v238
    v_mul_f32 v239, v183, v239
    v_fmac_f32 v236, v182, v212
    v_fmac_f32 v237, v182, v213
    v_fmac_f32 v238, v182, v214
    v_fmac_f32 v239, v182, v215
    v_cvt_pk_bf16_f32 v236, v236, v237
    v_cvt_pk_bf16_f32 v237, v238, v239
    ds_write_b64 v187, v[236:237] offset:23040
    s_waitcnt lgkmcnt(0)
    s_barrier
    ds_read_b128 v[24:27], v13 offset:18432
    s_waitcnt lgkmcnt(0)
    buffer_store_dwordx4 v[24:27], v14, s[4:7], s36 offen offset:512
    s_endpgm
L_ut_spin:
    s_mov_b32 s3, 0
L_ut_spin_l:
    s_sleep 1
    buffer_load_dword v1, off, s[20:23], 0 offset:64 sc1
    s_add_u32 s3, s3, 1
    s_waitcnt vmcnt(0)
    v_cmp_le_u32 vcc, 64, v1
    s_cbranch_vccnz L_ut_ret
    s_cmp_lt_u32 s3, 65536
    s_cbranch_scc1 L_ut_spin_l
    s_branch L_ut_ret
L_conv_end:
.section .rodata,"a"
.p2align 6
.amdhsa_kernel gated_mix__ssm_conv_s4__dense_activation_mish__prompt_kernel
  .amdhsa_next_free_vgpr 256
  .amdhsa_next_free_sgpr 102
  .amdhsa_accum_offset 256
  .amdhsa_group_segment_fixed_size 0
  .amdhsa_kernarg_size 136
  .amdhsa_user_sgpr_count 2
  .amdhsa_user_sgpr_kernarg_segment_ptr 1
  .amdhsa_system_sgpr_workgroup_id_x 1
.end_amdhsa_kernel
```
